```python
import torch

def _softmax(x, axis=-1):
    return torch.softmax(x, dim=axis)
def _gelu(x):
    return torch.nn.functional.gelu(x, approximate="tanh")
def _silu(x):
    return torch.nn.functional.silu(x)
def _sigmoid(x):
    return torch.sigmoid(x)
def _layernorm(x, axis=-1, eps=1e-5):
    m = x.mean(dim=axis, keepdim=True)
    v = x.var(dim=axis, keepdim=True, unbiased=False)
    return (x - m) / torch.sqrt(v + eps)
def _scatter_add(tgt, idx, src, axis=0):
    return tgt.clone().index_add_(axis, idx, src)
def _segment_sum(src, seg, n):
    out = torch.zeros((n,) + src.shape[1:], dtype=src.dtype)
    return out.index_add_(0, seg, src)
def _pad(x, pw):
    flat = tuple(v for pair in reversed(pw) for v in pair)
    return torch.nn.functional.pad(x, flat)

kernel_name = 'gated_mix__sliding_block__mixer_channel_mlp__prompt'

def setup_inputs():

    _w = (lambda a: (lambda t: t.to(torch.bfloat16) if t.is_floating_point() else t)(torch.as_tensor(a)))
    def _A_setup():
        B, S, D = 1, 2048, 640
        return {
            "x": _w((lambda *s: torch.randn(*s, dtype=torch.bfloat16) * 0.05)(B, S, D)),
            "wqkv": _w((lambda *s: torch.randn(*s, dtype=torch.bfloat16) * 0.8)(D, 3 * D)),
            "wo": _w((lambda *s: torch.randn(*s, dtype=torch.bfloat16) * 0.05)(D, D)),
        }
    _A_in = _A_setup()

    def _B_setup():
        B, S, D, F = 1, 2048, 640, 1728
        return {
            "x": _w((lambda *s: torch.randn(*s, dtype=torch.bfloat16) * 0.05)(B, S, D)),
            "w1": _w((lambda *s: torch.randn(*s, dtype=torch.bfloat16) * 3.2)(D, F) * (D ** -0.5)),
            "b1": _w((lambda *s: torch.randn(*s, dtype=torch.bfloat16) * 1.6)(F)),
            "w2": _w((lambda *s: torch.randn(*s, dtype=torch.bfloat16) * 0.2)(F, D) * (F ** -0.5)),
            "b2": _w((lambda *s: torch.randn(*s, dtype=torch.bfloat16) * 0.2)(D)),
        }
    _B_in = _B_setup()

    return {
        "A_x": _A_in["x"],
        "A_wqkv": _A_in["wqkv"],
        "A_wo": _A_in["wo"],
        "B_x": _B_in["x"],
        "B_w1": _B_in["w1"],
        "B_b1": _B_in["b1"],
        "B_w2": _B_in["w2"],
        "B_b2": _B_in["b2"],
        "gate_w": _w((lambda *s: torch.randn(*s, dtype=torch.bfloat16) * 0.05)(640) * 16.0),
    }

def reference(A_x, A_wqkv, A_wo, B_x, B_w1, B_b1, B_w2, B_b2, gate_w):
    def _A_ref(x, wqkv, wo):
        B, S, D = x.shape
        H = 32; Dh = D // H; W = 256
        qkv = (lambda x, *d: x.permute(*d))((x @ wqkv).reshape(B, S, 3, H, Dh), 2, 0, 3, 1, 4)
        q, k, v = qkv[0], qkv[1], qkv[2]
        scores = torch.einsum("bhqd,bhkd->bhqk", q, k) * (Dh ** -0.5)
        idx = torch.arange(S)
        mask = (idx[:, None] - idx[None, :] >= 0) & (idx[:, None] - idx[None, :] < W)
        scores = torch.where(mask[None, None], scores, -1e9)
        p = _softmax(scores, axis=-1)
        o = torch.einsum("bhqk,bhkd->bhqd", p, v)
        return (lambda x, *d: x.permute(*d))(o, 0, 2, 1, 3).reshape(B, S, D) @ wo

    def _B_ref(x, w1, b1, w2, b2):
        y = _layernorm(x, axis=-1)
        h = _gelu(torch.einsum("bsd,df->bsf", y, w1) + b1)
        return torch.einsum("bsf,fd->bsd", h, w2) + b2

    x = A_x
    g = _sigmoid((x * gate_w).sum(-1, keepdims=True))
    a = _A_ref(x, A_wqkv, A_wo)
    b = _B_ref(x, B_w1, B_b1, B_w2, B_b2)
    return g * a + (1 - g) * b
```

```asm
; @launch grid=(256,1,1) block=(512,1,1) lds=163840
.amdgcn_target "amdgcn-amd-amdhsa--gfx950"
.text
.globl gated_mix__sliding_block__mixer_channel_mlp__prompt_kernel
.p2align 8
.type gated_mix__sliding_block__mixer_channel_mlp__prompt_kernel,@function
gated_mix__sliding_block__mixer_channel_mlp__prompt_kernel:
  s_cmp_ge_u32 s2, 256
  s_cbranch_scc1 L_end
  s_load_dwordx16 s[64:79], s[0:1], 0
  s_load_dwordx8 s[80:87], s[0:1], 64
  v_lshrrev_b32 v1, 6, v0
  v_and_b32 v2, 63, v0
  v_readfirstlane_b32 s3, v1
  s_cmp_lt_u32 s2, 16
  s_cbranch_scc1 L_aux1
  s_sub_u32 s24, s2, 16
  s_and_b32 s22, s24, 7
  s_lshr_b32 s23, s24, 3
  s_lshr_b32 s57, s22, 2
  s_mul_i32 s57, s57, 30
  s_add_u32 s23, s23, s57
  s_and_b32 s56, s23, 3
  s_lshr_b32 s57, s23, 2
  s_and_b32 s22, s22, 3
  s_lshl_b32 s22, s22, 2
  s_add_u32 s56, s56, s22
  s_cmp_lt_u32 s57, 14
  s_cselect_b32 s54, 1, 0
  s_cmp_ge_u32 s3, 4
  s_cbranch_scc0 L_consumer
  s_sub_u32 s25, s3, 4
  v_lshrrev_b32 v3, 3, v2
  v_lshrrev_b32 v4, 4, v2
  v_and_b32 v5, 7, v2
  s_lshl_b32 s26, s25, 5
  v_add_u32 v6, 0, v3
  v_add_u32 v6, s26, v6
  v_mul_u32_u24 v6, 1280, v6
  v_add_u32 v7, 0, v4
  v_and_b32 v7, 7, v7
  v_xor_b32 v7, v5, v7
  v_lshl_add_u32 v8, v7, 4, v6
  v_add_u32 v6, 8, v3
  v_add_u32 v6, s26, v6
  v_mul_u32_u24 v6, 1280, v6
  v_add_u32 v7, 4, v4
  v_and_b32 v7, 7, v7
  v_xor_b32 v7, v5, v7
  v_lshl_add_u32 v9, v7, 4, v6
  v_add_u32 v6, 16, v3
  v_add_u32 v6, s26, v6
  v_mul_u32_u24 v6, 1280, v6
  v_add_u32 v7, 0, v4
  v_and_b32 v7, 7, v7
  v_xor_b32 v7, v5, v7
  v_lshl_add_u32 v10, v7, 4, v6
  v_add_u32 v6, 24, v3
  v_add_u32 v6, s26, v6
  v_mul_u32_u24 v6, 1280, v6
  v_add_u32 v7, 4, v4
  v_and_b32 v7, 7, v7
  v_xor_b32 v7, v5, v7
  v_lshl_add_u32 v11, v7, 4, v6
  v_and_b32 v6, 1, v4
  v_lshlrev_b32 v6, 2, v6
  v_xor_b32 v6, v5, v6
  v_lshlrev_b32 v6, 4, v6
  v_mul_u32_u24 v7, 3840, v3
  v_add_u32 v12, v7, v6
  v_mul_u32_u24 v7, 3456, v3
  v_add_u32 v13, v7, v6
  s_mul_i32 s28, s56, 163840
  s_lshl_b32 s30, s25, 12
  s_lshl_b32 s31, s25, 11
  s_lshl_b32 s34, s57, 8
  s_and_b32 s20, s2, 7
  s_lshr_b32 s20, s20, 2
  s_mul_i32 s20, s20, 7
  s_sub_u32 s20, s57, s20
  s_and_b32 s21, s56, 3
  s_mul_i32 s21, s21, 0
  s_mul_i32 s20, s20, 0
  s_add_u32 s20, s20, s21
  s_mul_hi_u32 s21, s20, 858993460
  s_mul_i32 s21, s21, 5
  s_sub_u32 s24, s20, s21
  s_waitcnt lgkmcnt(0)
  s_mov_b32 s12, s64
  s_mov_b32 s13, s65
  s_mov_b32 s14, 2621440
  s_mov_b32 s15, 0x20000
  s_mov_b32 s16, s66
  s_mov_b32 s17, s67
  s_mov_b32 s18, 2457600
  s_mov_b32 s19, 0x20000
  s_lshl_b32 s32, s24, 1
  s_add_u32 s32, s32, 0
  s_cmp_ge_u32 s32, 10
  s_cselect_b32 s33, 10, 0
  s_sub_u32 s32, s32, s33
  s_lshl_b32 s35, s32, 7
  s_add_u32 s35, s35, s28
  s_add_u32 m0, s30, 0
  s_nop 0
  buffer_load_dwordx4 v8, s[12:15], s35 offen lds
  s_add_u32 m0, s30, 1024
  s_nop 0
  buffer_load_dwordx4 v9, s[12:15], s35 offen lds
  s_add_u32 m0, s30, 2048
  s_nop 0
  buffer_load_dwordx4 v10, s[12:15], s35 offen lds
  s_add_u32 m0, s30, 3072
  s_nop 0
  buffer_load_dwordx4 v11, s[12:15], s35 offen lds
  s_mul_i32 s29, s25, 61440
  s_add_u32 s29, s29, s34
  s_mul_i32 s32, s32, 245760
  s_add_u32 s29, s29, s32
  s_add_u32 m0, s31, 65536
  s_nop 0
  buffer_load_dwordx4 v12, s[16:19], s29 offen lds
  s_add_u32 s29, s29, 30720
  s_add_u32 m0, s31, 66560
  s_nop 0
  buffer_load_dwordx4 v12, s[16:19], s29 offen lds
  s_lshl_b32 s32, s24, 1
  s_add_u32 s32, s32, 1
  s_cmp_ge_u32 s32, 10
  s_cselect_b32 s33, 10, 0
  s_sub_u32 s32, s32, s33
  s_lshl_b32 s35, s32, 7
  s_add_u32 s35, s35, s28
  s_add_u32 m0, s30, 16384
  s_nop 0
  buffer_load_dwordx4 v8, s[12:15], s35 offen lds
  s_add_u32 m0, s30, 17408
  s_nop 0
  buffer_load_dwordx4 v9, s[12:15], s35 offen lds
  s_add_u32 m0, s30, 18432
  s_nop 0
  buffer_load_dwordx4 v10, s[12:15], s35 offen lds
  s_add_u32 m0, s30, 19456
  s_nop 0
  buffer_load_dwordx4 v11, s[12:15], s35 offen lds
  s_mul_i32 s29, s25, 61440
  s_add_u32 s29, s29, s34
  s_mul_i32 s32, s32, 245760
  s_add_u32 s29, s29, s32
  s_add_u32 m0, s31, 73728
  s_nop 0
  buffer_load_dwordx4 v12, s[16:19], s29 offen lds
  s_add_u32 s29, s29, 30720
  s_add_u32 m0, s31, 74752
  s_nop 0
  buffer_load_dwordx4 v12, s[16:19], s29 offen lds
  s_add_u32 s44, s86, 26214400
  s_addc_u32 s45, s87, 0
  s_mov_b32 s46, 7296
  s_mov_b32 s47, 0x20000
  s_mov_b32 s48, s84
  s_mov_b32 s49, s85
  s_mov_b32 s50, 256
  s_mov_b32 s51, 0x20000
  s_and_b32 s20, s2, 7
  s_lshr_b32 s21, s2, 3
  s_and_b32 s22, s21, 1
  s_lshl_b32 s20, s20, 1
  s_add_u32 s58, s20, s22
  s_lshr_b32 s59, s21, 1
  s_and_b32 s20, s2, 7
  s_lshr_b32 s21, s2, 3
  s_and_b32 s22, s20, 1
  s_lshl_b32 s22, s22, 2
  s_and_b32 s23, s21, 3
  s_add_u32 s61, s22, s23
  s_lshr_b32 s20, s20, 1
  s_lshl_b32 s20, s20, 3
  s_lshr_b32 s21, s21, 2
  s_add_u32 s60, s20, s21
  s_mov_b32 s20, s72
  s_mov_b32 s21, s73
  s_mov_b32 s22, 2211840
  s_mov_b32 s23, 0x20000
  s_waitcnt vmcnt(6)
  s_barrier
  s_lshl_b32 s32, s24, 1
  s_add_u32 s32, s32, 2
  s_cmp_ge_u32 s32, 10
  s_cselect_b32 s33, 10, 0
  s_sub_u32 s32, s32, s33
  s_lshl_b32 s35, s32, 7
  s_add_u32 s35, s35, s28
  s_add_u32 m0, s30, 32768
  s_nop 0
  buffer_load_dwordx4 v8, s[12:15], s35 offen lds
  s_add_u32 m0, s30, 33792
  s_nop 0
  buffer_load_dwordx4 v9, s[12:15], s35 offen lds
  s_add_u32 m0, s30, 34816
  s_nop 0
  buffer_load_dwordx4 v10, s[12:15], s35 offen lds
  s_add_u32 m0, s30, 35840
  s_nop 0
  buffer_load_dwordx4 v11, s[12:15], s35 offen lds
  s_mul_i32 s29, s25, 61440
  s_add_u32 s29, s29, s34
  s_mul_i32 s32, s32, 245760
  s_add_u32 s29, s29, s32
  s_add_u32 m0, s31, 81920
  s_nop 0
  buffer_load_dwordx4 v12, s[16:19], s29 offen lds
  s_add_u32 s29, s29, 30720
  s_add_u32 m0, s31, 82944
  s_nop 0
  buffer_load_dwordx4 v12, s[16:19], s29 offen lds
  s_waitcnt vmcnt(6)
  s_barrier
  s_lshl_b32 s32, s24, 1
  s_add_u32 s32, s32, 3
  s_cmp_ge_u32 s32, 10
  s_cselect_b32 s33, 10, 0
  s_sub_u32 s32, s32, s33
  s_lshl_b32 s35, s32, 7
  s_add_u32 s35, s35, s28
  s_add_u32 m0, s30, 49152
  s_nop 0
  buffer_load_dwordx4 v8, s[12:15], s35 offen lds
  s_add_u32 m0, s30, 50176
  s_nop 0
  buffer_load_dwordx4 v9, s[12:15], s35 offen lds
  s_add_u32 m0, s30, 51200
  s_nop 0
  buffer_load_dwordx4 v10, s[12:15], s35 offen lds
  s_add_u32 m0, s30, 52224
  s_nop 0
  buffer_load_dwordx4 v11, s[12:15], s35 offen lds
  s_mul_i32 s29, s25, 61440
  s_add_u32 s29, s29, s34
  s_mul_i32 s32, s32, 245760
  s_add_u32 s29, s29, s32
  s_add_u32 m0, s31, 90112
  s_nop 0
  buffer_load_dwordx4 v12, s[16:19], s29 offen lds
  s_add_u32 s29, s29, 30720
  s_add_u32 m0, s31, 91136
  s_nop 0
  buffer_load_dwordx4 v12, s[16:19], s29 offen lds
  s_waitcnt vmcnt(6)
  s_barrier
  s_lshl_b32 s32, s24, 1
  s_add_u32 s32, s32, 4
  s_cmp_ge_u32 s32, 10
  s_cselect_b32 s33, 10, 0
  s_sub_u32 s32, s32, s33
  s_lshl_b32 s35, s32, 7
  s_add_u32 s35, s35, s28
  s_add_u32 m0, s30, 0
  s_nop 0
  buffer_load_dwordx4 v8, s[12:15], s35 offen lds
  s_add_u32 m0, s30, 1024
  s_nop 0
  buffer_load_dwordx4 v9, s[12:15], s35 offen lds
  s_add_u32 m0, s30, 2048
  s_nop 0
  buffer_load_dwordx4 v10, s[12:15], s35 offen lds
  s_add_u32 m0, s30, 3072
  s_nop 0
  buffer_load_dwordx4 v11, s[12:15], s35 offen lds
  s_mul_i32 s29, s25, 61440
  s_add_u32 s29, s29, s34
  s_mul_i32 s32, s32, 245760
  s_add_u32 s29, s29, s32
  s_add_u32 m0, s31, 65536
  s_nop 0
  buffer_load_dwordx4 v12, s[16:19], s29 offen lds
  s_add_u32 s29, s29, 30720
  s_add_u32 m0, s31, 66560
  s_nop 0
  buffer_load_dwordx4 v12, s[16:19], s29 offen lds
  s_waitcnt vmcnt(6)
  s_barrier
  s_lshl_b32 s32, s24, 1
  s_add_u32 s32, s32, 5
  s_cmp_ge_u32 s32, 10
  s_cselect_b32 s33, 10, 0
  s_sub_u32 s32, s32, s33
  s_lshl_b32 s35, s32, 7
  s_add_u32 s35, s35, s28
  s_add_u32 m0, s30, 16384
  s_nop 0
  buffer_load_dwordx4 v8, s[12:15], s35 offen lds
  s_add_u32 m0, s30, 17408
  s_nop 0
  buffer_load_dwordx4 v9, s[12:15], s35 offen lds
  s_add_u32 m0, s30, 18432
  s_nop 0
  buffer_load_dwordx4 v10, s[12:15], s35 offen lds
  s_add_u32 m0, s30, 19456
  s_nop 0
  buffer_load_dwordx4 v11, s[12:15], s35 offen lds
  s_mul_i32 s29, s25, 61440
  s_add_u32 s29, s29, s34
  s_mul_i32 s32, s32, 245760
  s_add_u32 s29, s29, s32
  s_add_u32 m0, s31, 73728
  s_nop 0
  buffer_load_dwordx4 v12, s[16:19], s29 offen lds
  s_add_u32 s29, s29, 30720
  s_add_u32 m0, s31, 74752
  s_nop 0
  buffer_load_dwordx4 v12, s[16:19], s29 offen lds
  s_waitcnt vmcnt(6)
  s_barrier
  s_lshl_b32 s32, s24, 1
  s_add_u32 s32, s32, 6
  s_cmp_ge_u32 s32, 10
  s_cselect_b32 s33, 10, 0
  s_sub_u32 s32, s32, s33
  s_lshl_b32 s35, s32, 7
  s_add_u32 s35, s35, s28
  s_add_u32 m0, s30, 32768
  s_nop 0
  buffer_load_dwordx4 v8, s[12:15], s35 offen lds
  s_add_u32 m0, s30, 33792
  s_nop 0
  buffer_load_dwordx4 v9, s[12:15], s35 offen lds
  s_add_u32 m0, s30, 34816
  s_nop 0
  buffer_load_dwordx4 v10, s[12:15], s35 offen lds
  s_add_u32 m0, s30, 35840
  s_nop 0
  buffer_load_dwordx4 v11, s[12:15], s35 offen lds
  s_mul_i32 s29, s25, 61440
  s_add_u32 s29, s29, s34
  s_mul_i32 s32, s32, 245760
  s_add_u32 s29, s29, s32
  s_add_u32 m0, s31, 81920
  s_nop 0
  buffer_load_dwordx4 v12, s[16:19], s29 offen lds
  s_add_u32 s29, s29, 30720
  s_add_u32 m0, s31, 82944
  s_nop 0
  buffer_load_dwordx4 v12, s[16:19], s29 offen lds
  s_waitcnt vmcnt(6)
  s_barrier
  s_lshl_b32 s32, s24, 1
  s_add_u32 s32, s32, 7
  s_cmp_ge_u32 s32, 10
  s_cselect_b32 s33, 10, 0
  s_sub_u32 s32, s32, s33
  s_lshl_b32 s35, s32, 7
  s_add_u32 s35, s35, s28
  s_add_u32 m0, s30, 49152
  s_nop 0
  buffer_load_dwordx4 v8, s[12:15], s35 offen lds
  s_add_u32 m0, s30, 50176
  s_nop 0
  buffer_load_dwordx4 v9, s[12:15], s35 offen lds
  s_add_u32 m0, s30, 51200
  s_nop 0
  buffer_load_dwordx4 v10, s[12:15], s35 offen lds
  s_add_u32 m0, s30, 52224
  s_nop 0
  buffer_load_dwordx4 v11, s[12:15], s35 offen lds
  s_mul_i32 s29, s25, 61440
  s_add_u32 s29, s29, s34
  s_mul_i32 s32, s32, 245760
  s_add_u32 s29, s29, s32
  s_add_u32 m0, s31, 90112
  s_nop 0
  buffer_load_dwordx4 v12, s[16:19], s29 offen lds
  s_add_u32 s29, s29, 30720
  s_add_u32 m0, s31, 91136
  s_nop 0
  buffer_load_dwordx4 v12, s[16:19], s29 offen lds
  s_waitcnt vmcnt(6)
  s_barrier
  s_lshl_b32 s32, s24, 1
  s_add_u32 s32, s32, 8
  s_cmp_ge_u32 s32, 10
  s_cselect_b32 s33, 10, 0
  s_sub_u32 s32, s32, s33
  s_lshl_b32 s35, s32, 7
  s_add_u32 s35, s35, s28
  s_add_u32 m0, s30, 0
  s_nop 0
  buffer_load_dwordx4 v8, s[12:15], s35 offen lds
  s_add_u32 m0, s30, 1024
  s_nop 0
  buffer_load_dwordx4 v9, s[12:15], s35 offen lds
  s_add_u32 m0, s30, 2048
  s_nop 0
  buffer_load_dwordx4 v10, s[12:15], s35 offen lds
  s_add_u32 m0, s30, 3072
  s_nop 0
  buffer_load_dwordx4 v11, s[12:15], s35 offen lds
  s_mul_i32 s29, s25, 61440
  s_add_u32 s29, s29, s34
  s_mul_i32 s32, s32, 245760
  s_add_u32 s29, s29, s32
  s_add_u32 m0, s31, 65536
  s_nop 0
  buffer_load_dwordx4 v12, s[16:19], s29 offen lds
  s_add_u32 s29, s29, 30720
  s_add_u32 m0, s31, 66560
  s_nop 0
  buffer_load_dwordx4 v12, s[16:19], s29 offen lds
  s_waitcnt vmcnt(6)
  s_barrier
  s_lshl_b32 s32, s24, 1
  s_add_u32 s32, s32, 9
  s_cmp_ge_u32 s32, 10
  s_cselect_b32 s33, 10, 0
  s_sub_u32 s32, s32, s33
  s_lshl_b32 s35, s32, 7
  s_add_u32 s35, s35, s28
  s_add_u32 m0, s30, 16384
  s_nop 0
  buffer_load_dwordx4 v8, s[12:15], s35 offen lds
  s_add_u32 m0, s30, 17408
  s_nop 0
  buffer_load_dwordx4 v9, s[12:15], s35 offen lds
  s_add_u32 m0, s30, 18432
  s_nop 0
  buffer_load_dwordx4 v10, s[12:15], s35 offen lds
  s_add_u32 m0, s30, 19456
  s_nop 0
  buffer_load_dwordx4 v11, s[12:15], s35 offen lds
  s_mul_i32 s29, s25, 61440
  s_add_u32 s29, s29, s34
  s_mul_i32 s32, s32, 245760
  s_add_u32 s29, s29, s32
  s_add_u32 m0, s31, 73728
  s_nop 0
  buffer_load_dwordx4 v12, s[16:19], s29 offen lds
  s_add_u32 s29, s29, 30720
  s_add_u32 m0, s31, 74752
  s_nop 0
  buffer_load_dwordx4 v12, s[16:19], s29 offen lds
  s_waitcnt vmcnt(6)
  s_barrier
  s_add_u32 s32, s24, 0
  s_cmp_ge_u32 s32, 5
  s_cselect_b32 s33, 5, 0
  s_sub_u32 s32, s32, s33
  s_mul_i32 s32, s32, 491520
  s_mul_i32 s29, s25, 122880
  s_add_u32 s29, s29, s34
  s_add_u32 s29, s29, s32
  s_add_u32 s29, s29, 128
  s_add_u32 m0, s30, 98304
  s_nop 0
  buffer_load_dwordx4 v12, s[16:19], s29 offen lds
  s_add_u32 s29, s29, 30720
  s_add_u32 m0, s30, 99328
  s_nop 0
  buffer_load_dwordx4 v12, s[16:19], s29 offen lds
  s_add_u32 s29, s29, 30720
  s_add_u32 m0, s30, 100352
  s_nop 0
  buffer_load_dwordx4 v12, s[16:19], s29 offen lds
  s_add_u32 s29, s29, 30720
  s_add_u32 m0, s30, 101376
  s_nop 0
  buffer_load_dwordx4 v12, s[16:19], s29 offen lds
  s_add_u32 s32, s24, 1
  s_cmp_ge_u32 s32, 5
  s_cselect_b32 s33, 5, 0
  s_sub_u32 s32, s32, s33
  s_mul_i32 s32, s32, 491520
  s_mul_i32 s29, s25, 122880
  s_add_u32 s29, s29, s34
  s_add_u32 s29, s29, s32
  s_add_u32 s29, s29, 128
  s_add_u32 m0, s30, 114688
  s_nop 0
  buffer_load_dwordx4 v12, s[16:19], s29 offen lds
  s_add_u32 s29, s29, 30720
  s_add_u32 m0, s30, 115712
  s_nop 0
  buffer_load_dwordx4 v12, s[16:19], s29 offen lds
  s_add_u32 s29, s29, 30720
  s_add_u32 m0, s30, 116736
  s_nop 0
  buffer_load_dwordx4 v12, s[16:19], s29 offen lds
  s_add_u32 s29, s29, 30720
  s_add_u32 m0, s30, 117760
  s_nop 0
  buffer_load_dwordx4 v12, s[16:19], s29 offen lds
  s_waitcnt vmcnt(8)
  s_barrier
  s_add_u32 s32, s24, 2
  s_cmp_ge_u32 s32, 5
  s_cselect_b32 s33, 5, 0
  s_sub_u32 s32, s32, s33
  s_mul_i32 s32, s32, 491520
  s_mul_i32 s29, s25, 122880
  s_add_u32 s29, s29, s34
  s_add_u32 s29, s29, s32
  s_add_u32 s29, s29, 128
  s_add_u32 m0, s30, 131072
  s_nop 0
  buffer_load_dwordx4 v12, s[16:19], s29 offen lds
  s_add_u32 s29, s29, 30720
  s_add_u32 m0, s30, 132096
  s_nop 0
  buffer_load_dwordx4 v12, s[16:19], s29 offen lds
  s_add_u32 s29, s29, 30720
  s_add_u32 m0, s30, 133120
  s_nop 0
  buffer_load_dwordx4 v12, s[16:19], s29 offen lds
  s_add_u32 s29, s29, 30720
  s_add_u32 m0, s30, 134144
  s_nop 0
  buffer_load_dwordx4 v12, s[16:19], s29 offen lds
  s_waitcnt vmcnt(8)
  s_barrier
  s_add_u32 s32, s24, 3
  s_cmp_ge_u32 s32, 5
  s_cselect_b32 s33, 5, 0
  s_sub_u32 s32, s32, s33
  s_mul_i32 s32, s32, 491520
  s_mul_i32 s29, s25, 122880
  s_add_u32 s29, s29, s34
  s_add_u32 s29, s29, s32
  s_add_u32 s29, s29, 128
  s_add_u32 m0, s30, 147456
  s_nop 0
  buffer_load_dwordx4 v12, s[16:19], s29 offen lds
  s_add_u32 s29, s29, 30720
  s_add_u32 m0, s30, 148480
  s_nop 0
  buffer_load_dwordx4 v12, s[16:19], s29 offen lds
  s_add_u32 s29, s29, 30720
  s_add_u32 m0, s30, 149504
  s_nop 0
  buffer_load_dwordx4 v12, s[16:19], s29 offen lds
  s_add_u32 s29, s29, 30720
  s_add_u32 m0, s30, 150528
  s_nop 0
  buffer_load_dwordx4 v12, s[16:19], s29 offen lds
  s_waitcnt vmcnt(8)
  s_barrier
  s_add_u32 s32, s24, 4
  s_cmp_ge_u32 s32, 5
  s_cselect_b32 s33, 5, 0
  s_sub_u32 s32, s32, s33
  s_mul_i32 s32, s32, 491520
  s_mul_i32 s29, s25, 122880
  s_add_u32 s29, s29, s34
  s_add_u32 s29, s29, s32
  s_add_u32 s29, s29, 128
  s_add_u32 m0, s30, 81920
  s_nop 0
  buffer_load_dwordx4 v12, s[16:19], s29 offen lds
  s_add_u32 s29, s29, 30720
  s_add_u32 m0, s30, 82944
  s_nop 0
  buffer_load_dwordx4 v12, s[16:19], s29 offen lds
  s_add_u32 s29, s29, 30720
  s_add_u32 m0, s30, 83968
  s_nop 0
  buffer_load_dwordx4 v12, s[16:19], s29 offen lds
  s_add_u32 s29, s29, 30720
  s_add_u32 m0, s30, 84992
  s_nop 0
  buffer_load_dwordx4 v12, s[16:19], s29 offen lds
  s_waitcnt vmcnt(8)
  s_barrier
  s_cmp_eq_u32 s54, 0
  s_cbranch_scc0 L_ld_mlp
  s_waitcnt vmcnt(4)
  s_barrier
  s_waitcnt vmcnt(0)
  s_barrier
  s_branch L_A_only_done
L_ld_mlp:
  s_add_u32 s32, s24, 0
  s_cmp_ge_u32 s32, 5
  s_cselect_b32 s33, 5, 0
  s_sub_u32 s32, s32, s33
  s_mul_i32 s32, s32, 442368
  s_mul_i32 s29, s25, 110592
  s_add_u32 s29, s29, s34
  s_add_u32 s29, s29, s32
  s_add_u32 m0, s30, 98304
  s_nop 0
  buffer_load_dwordx4 v13, s[20:23], s29 offen lds
  s_add_u32 s29, s29, 27648
  s_add_u32 m0, s30, 99328
  s_nop 0
  buffer_load_dwordx4 v13, s[20:23], s29 offen lds
  s_add_u32 s29, s29, 27648
  s_add_u32 m0, s30, 100352
  s_nop 0
  buffer_load_dwordx4 v13, s[20:23], s29 offen lds
  s_add_u32 s29, s29, 27648
  s_add_u32 m0, s30, 101376
  s_nop 0
  buffer_load_dwordx4 v13, s[20:23], s29 offen lds
  s_waitcnt vmcnt(8)
  s_barrier
  s_add_u32 s32, s24, 1
  s_cmp_ge_u32 s32, 5
  s_cselect_b32 s33, 5, 0
  s_sub_u32 s32, s32, s33
  s_mul_i32 s32, s32, 442368
  s_mul_i32 s29, s25, 110592
  s_add_u32 s29, s29, s34
  s_add_u32 s29, s29, s32
  s_add_u32 m0, s30, 114688
  s_nop 0
  buffer_load_dwordx4 v13, s[20:23], s29 offen lds
  s_add_u32 s29, s29, 27648
  s_add_u32 m0, s30, 115712
  s_nop 0
  buffer_load_dwordx4 v13, s[20:23], s29 offen lds
  s_add_u32 s29, s29, 27648
  s_add_u32 m0, s30, 116736
  s_nop 0
  buffer_load_dwordx4 v13, s[20:23], s29 offen lds
  s_add_u32 s29, s29, 27648
  s_add_u32 m0, s30, 117760
  s_nop 0
  buffer_load_dwordx4 v13, s[20:23], s29 offen lds
  s_waitcnt vmcnt(8)
  s_barrier
  s_add_u32 s32, s24, 2
  s_cmp_ge_u32 s32, 5
  s_cselect_b32 s33, 5, 0
  s_sub_u32 s32, s32, s33
  s_mul_i32 s32, s32, 442368
  s_mul_i32 s29, s25, 110592
  s_add_u32 s29, s29, s34
  s_add_u32 s29, s29, s32
  s_add_u32 m0, s30, 131072
  s_nop 0
  buffer_load_dwordx4 v13, s[20:23], s29 offen lds
  s_add_u32 s29, s29, 27648
  s_add_u32 m0, s30, 132096
  s_nop 0
  buffer_load_dwordx4 v13, s[20:23], s29 offen lds
  s_add_u32 s29, s29, 27648
  s_add_u32 m0, s30, 133120
  s_nop 0
  buffer_load_dwordx4 v13, s[20:23], s29 offen lds
  s_add_u32 s29, s29, 27648
  s_add_u32 m0, s30, 134144
  s_nop 0
  buffer_load_dwordx4 v13, s[20:23], s29 offen lds
  s_waitcnt vmcnt(8)
  s_barrier
  s_add_u32 s32, s24, 3
  s_cmp_ge_u32 s32, 5
  s_cselect_b32 s33, 5, 0
  s_sub_u32 s32, s32, s33
  s_mul_i32 s32, s32, 442368
  s_mul_i32 s29, s25, 110592
  s_add_u32 s29, s29, s34
  s_add_u32 s29, s29, s32
  s_add_u32 m0, s30, 147456
  s_nop 0
  buffer_load_dwordx4 v13, s[20:23], s29 offen lds
  s_add_u32 s29, s29, 27648
  s_add_u32 m0, s30, 148480
  s_nop 0
  buffer_load_dwordx4 v13, s[20:23], s29 offen lds
  s_add_u32 s29, s29, 27648
  s_add_u32 m0, s30, 149504
  s_nop 0
  buffer_load_dwordx4 v13, s[20:23], s29 offen lds
  s_add_u32 s29, s29, 27648
  s_add_u32 m0, s30, 150528
  s_nop 0
  buffer_load_dwordx4 v13, s[20:23], s29 offen lds
  s_waitcnt vmcnt(8)
  s_barrier
  s_add_u32 s32, s24, 4
  s_cmp_ge_u32 s32, 5
  s_cselect_b32 s33, 5, 0
  s_sub_u32 s32, s32, s33
  s_mul_i32 s32, s32, 442368
  s_mul_i32 s29, s25, 110592
  s_add_u32 s29, s29, s34
  s_add_u32 s29, s29, s32
  s_add_u32 m0, s30, 81920
  s_nop 0
  buffer_load_dwordx4 v13, s[20:23], s29 offen lds
  s_add_u32 s29, s29, 27648
  s_add_u32 m0, s30, 82944
  s_nop 0
  buffer_load_dwordx4 v13, s[20:23], s29 offen lds
  s_add_u32 s29, s29, 27648
  s_add_u32 m0, s30, 83968
  s_nop 0
  buffer_load_dwordx4 v13, s[20:23], s29 offen lds
  s_add_u32 s29, s29, 27648
  s_add_u32 m0, s30, 84992
  s_nop 0
  buffer_load_dwordx4 v13, s[20:23], s29 offen lds
  s_waitcnt vmcnt(8)
  s_barrier
  s_add_u32 s32, s24, 0
  s_cmp_ge_u32 s32, 5
  s_cselect_b32 s33, 5, 0
  s_sub_u32 s32, s32, s33
  s_mul_i32 s32, s32, 442368
  s_mul_i32 s29, s25, 110592
  s_add_u32 s29, s29, s34
  s_add_u32 s29, s29, s32
  s_add_u32 s29, s29, 128
  s_add_u32 m0, s30, 98304
  s_nop 0
  buffer_load_dwordx4 v13, s[20:23], s29 offen lds
  s_add_u32 s29, s29, 27648
  s_add_u32 m0, s30, 99328
  s_nop 0
  buffer_load_dwordx4 v13, s[20:23], s29 offen lds
  s_add_u32 s29, s29, 27648
  s_add_u32 m0, s30, 100352
  s_nop 0
  buffer_load_dwordx4 v13, s[20:23], s29 offen lds
  s_add_u32 s29, s29, 27648
  s_add_u32 m0, s30, 101376
  s_nop 0
  buffer_load_dwordx4 v13, s[20:23], s29 offen lds
  s_waitcnt vmcnt(8)
  s_barrier
  s_add_u32 s32, s24, 1
  s_cmp_ge_u32 s32, 5
  s_cselect_b32 s33, 5, 0
  s_sub_u32 s32, s32, s33
  s_mul_i32 s32, s32, 442368
  s_mul_i32 s29, s25, 110592
  s_add_u32 s29, s29, s34
  s_add_u32 s29, s29, s32
  s_add_u32 s29, s29, 128
  s_add_u32 m0, s30, 114688
  s_nop 0
  buffer_load_dwordx4 v13, s[20:23], s29 offen lds
  s_add_u32 s29, s29, 27648
  s_add_u32 m0, s30, 115712
  s_nop 0
  buffer_load_dwordx4 v13, s[20:23], s29 offen lds
  s_add_u32 s29, s29, 27648
  s_add_u32 m0, s30, 116736
  s_nop 0
  buffer_load_dwordx4 v13, s[20:23], s29 offen lds
  s_add_u32 s29, s29, 27648
  s_add_u32 m0, s30, 117760
  s_nop 0
  buffer_load_dwordx4 v13, s[20:23], s29 offen lds
  s_waitcnt vmcnt(8)
  s_barrier
  s_add_u32 s32, s24, 2
  s_cmp_ge_u32 s32, 5
  s_cselect_b32 s33, 5, 0
  s_sub_u32 s32, s32, s33
  s_mul_i32 s32, s32, 442368
  s_mul_i32 s29, s25, 110592
  s_add_u32 s29, s29, s34
  s_add_u32 s29, s29, s32
  s_add_u32 s29, s29, 128
  s_add_u32 m0, s30, 131072
  s_nop 0
  buffer_load_dwordx4 v13, s[20:23], s29 offen lds
  s_add_u32 s29, s29, 27648
  s_add_u32 m0, s30, 132096
  s_nop 0
  buffer_load_dwordx4 v13, s[20:23], s29 offen lds
  s_add_u32 s29, s29, 27648
  s_add_u32 m0, s30, 133120
  s_nop 0
  buffer_load_dwordx4 v13, s[20:23], s29 offen lds
  s_add_u32 s29, s29, 27648
  s_add_u32 m0, s30, 134144
  s_nop 0
  buffer_load_dwordx4 v13, s[20:23], s29 offen lds
  s_waitcnt vmcnt(8)
  s_barrier
  s_add_u32 s32, s24, 3
  s_cmp_ge_u32 s32, 5
  s_cselect_b32 s33, 5, 0
  s_sub_u32 s32, s32, s33
  s_mul_i32 s32, s32, 442368
  s_mul_i32 s29, s25, 110592
  s_add_u32 s29, s29, s34
  s_add_u32 s29, s29, s32
  s_add_u32 s29, s29, 128
  s_add_u32 m0, s30, 147456
  s_nop 0
  buffer_load_dwordx4 v13, s[20:23], s29 offen lds
  s_add_u32 s29, s29, 27648
  s_add_u32 m0, s30, 148480
  s_nop 0
  buffer_load_dwordx4 v13, s[20:23], s29 offen lds
  s_add_u32 s29, s29, 27648
  s_add_u32 m0, s30, 149504
  s_nop 0
  buffer_load_dwordx4 v13, s[20:23], s29 offen lds
  s_add_u32 s29, s29, 27648
  s_add_u32 m0, s30, 150528
  s_nop 0
  buffer_load_dwordx4 v13, s[20:23], s29 offen lds
  s_waitcnt vmcnt(8)
  s_barrier
  s_add_u32 s32, s24, 4
  s_cmp_ge_u32 s32, 5
  s_cselect_b32 s33, 5, 0
  s_sub_u32 s32, s32, s33
  s_mul_i32 s32, s32, 442368
  s_mul_i32 s29, s25, 110592
  s_add_u32 s29, s29, s34
  s_add_u32 s29, s29, s32
  s_add_u32 s29, s29, 128
  s_add_u32 m0, s30, 81920
  s_nop 0
  buffer_load_dwordx4 v13, s[20:23], s29 offen lds
  s_add_u32 s29, s29, 27648
  s_add_u32 m0, s30, 82944
  s_nop 0
  buffer_load_dwordx4 v13, s[20:23], s29 offen lds
  s_add_u32 s29, s29, 27648
  s_add_u32 m0, s30, 83968
  s_nop 0
  buffer_load_dwordx4 v13, s[20:23], s29 offen lds
  s_add_u32 s29, s29, 27648
  s_add_u32 m0, s30, 84992
  s_nop 0
  buffer_load_dwordx4 v13, s[20:23], s29 offen lds
  v_mov_b32 v176, 0
  v_mov_b32 v4, 68864
  v_mov_b32 v5, 0
  ds_write_b32 v4, v5 offset:0
  ds_write_b32 v4, v5 offset:4
  ds_write_b32 v4, v5 offset:8
  ds_write_b32 v4, v5 offset:12
  s_lshr_b32 s26, s3, 2
  s_xor_b32 s26, s26, 1
  s_and_b32 s27, s3, 3
  s_lshl_b32 s28, s59, 2
  s_add_u32 s28, s28, s27
  s_mul_i32 s23, s58, 5
  s_mul_i32 s29, s26, 3
  v_and_b32 v3, 31, v2
  v_lshrrev_b32 v4, 5, v2
  s_lshl_b32 s30, s28, 9
  v_lshl_add_u32 v6, v3, 4, s30
  s_add_u32 s31, s23, s29
  v_add_u32 v7, s31, v4
  v_lshl_add_u32 v18, v7, 15, v6
  s_add_u32 s31, s23, 2
  s_lshl_b32 s31, s31, 15
  s_lshl_b32 s32, s26, 3
  s_add_u32 s31, s31, s32
  v_add_u32 v19, s31, v6
  s_lshl_b32 s30, s27, 9
  v_add_u32 v6, s29, v4
  v_mul_u32_u24 v6, 6208, v6
  v_lshl_add_u32 v6, v3, 4, v6
  v_add_u32 v14, s30, v6
  s_add_u32 s31, s30, 12416
  s_add_u32 s31, s31, s32
  v_lshl_add_u32 v15, v3, 4, s31
  v_and_b32 v5, 3, v2
  v_bfe_u32 v6, v2, 4, 1
  v_bfe_u32 v7, v2, 2, 2
  v_and_b32 v20, 1, v5
  v_add_u32 v20, s29, v20
  v_mul_u32_u24 v20, 6208, v20
  v_lshrrev_b32 v21, 1, v5
  v_lshl_add_u32 v20, v21, 3, v20
  s_add_u32 s31, s32, 12416
  s_lshl_b32 s33, s26, 7
  s_sub_u32 s33, 31168, s33
  v_mov_b32 v21, s33
  v_mov_b32 v22, s31
  v_cmp_eq_u32 vcc, 0, v5
  v_lshl_add_u32 v7, v4, 2, v7
  s_nop 0
  v_cndmask_b32 v21, v21, v22, vcc
  v_cmp_eq_u32 vcc, 0, v6
  s_add_u32 s31, s30, 31232
  s_nop 0
  v_cndmask_b32 v20, v21, v20, vcc
  v_lshl_add_u32 v20, v7, 4, v20
  v_add_u32 v16, s31, v20
  v_and_b32 v7, 31, v2
  v_lshrrev_b32 v5, 5, v2
  v_lshlrev_b32 v5, 2, v5
  v_sub_u32 v5, v7, v5
  v_mov_b32 v6, 0xf149f2ca
  v_subrev_u32 v112, 0, v5
  v_ashrrev_i32 v112, 31, v112
  v_and_b32 v112, v6, v112
  v_xor_b32 v96, v6, v112
  v_subrev_u32 v113, 1, v5
  v_ashrrev_i32 v113, 31, v113
  v_and_b32 v113, v6, v113
  v_xor_b32 v97, v6, v113
  v_subrev_u32 v114, 2, v5
  v_ashrrev_i32 v114, 31, v114
  v_and_b32 v114, v6, v114
  v_xor_b32 v98, v6, v114
  v_subrev_u32 v115, 3, v5
  v_ashrrev_i32 v115, 31, v115
  v_and_b32 v115, v6, v115
  v_xor_b32 v99, v6, v115
  v_subrev_u32 v116, 8, v5
  v_ashrrev_i32 v116, 31, v116
  v_and_b32 v116, v6, v116
  v_xor_b32 v100, v6, v116
  v_subrev_u32 v117, 9, v5
  v_ashrrev_i32 v117, 31, v117
  v_and_b32 v117, v6, v117
  v_xor_b32 v101, v6, v117
  v_subrev_u32 v118, 10, v5
  v_ashrrev_i32 v118, 31, v118
  v_and_b32 v118, v6, v118
  v_xor_b32 v102, v6, v118
  v_subrev_u32 v119, 11, v5
  v_ashrrev_i32 v119, 31, v119
  v_and_b32 v119, v6, v119
  v_xor_b32 v103, v6, v119
  v_subrev_u32 v120, 16, v5
  v_ashrrev_i32 v120, 31, v120
  v_and_b32 v120, v6, v120
  v_xor_b32 v104, v6, v120
  v_subrev_u32 v121, 17, v5
  v_ashrrev_i32 v121, 31, v121
  v_and_b32 v121, v6, v121
  v_xor_b32 v105, v6, v121
  v_subrev_u32 v122, 18, v5
  v_ashrrev_i32 v122, 31, v122
  v_and_b32 v122, v6, v122
  v_xor_b32 v106, v6, v122
  v_subrev_u32 v123, 19, v5
  v_ashrrev_i32 v123, 31, v123
  v_and_b32 v123, v6, v123
  v_xor_b32 v107, v6, v123
  v_subrev_u32 v124, 24, v5
  v_ashrrev_i32 v124, 31, v124
  v_and_b32 v124, v6, v124
  v_xor_b32 v108, v6, v124
  v_subrev_u32 v125, 25, v5
  v_ashrrev_i32 v125, 31, v125
  v_and_b32 v125, v6, v125
  v_xor_b32 v109, v6, v125
  v_subrev_u32 v126, 26, v5
  v_ashrrev_i32 v126, 31, v126
  v_and_b32 v126, v6, v126
  v_xor_b32 v110, v6, v126
  v_subrev_u32 v127, 27, v5
  v_ashrrev_i32 v127, 31, v127
  v_and_b32 v127, v6, v127
  v_xor_b32 v111, v6, v127
  v_mov_b32 v23, v2
  v_lshrrev_b32 v22, 4, v23
  v_min_u32 v22, 2, v22
  s_sub_u32 s36, s59, 2
  v_add_u32 v22, s36, v22
  v_max_i32 v22, 0, v22
  v_lshlrev_b32 v22, 7, v22
  v_and_b32 v23, 15, v23
  v_min_u32 v23, 14, v23
  v_lshl_add_u32 v22, v23, 2, v22
  v_add_u32 v22, 0, v22
  v_mov_b32 v24, v22
  s_sub_u32 s8, s3, 4
  v_lshl_add_u32 v4, v2, 2, s8
  v_mul_u32_u24 v5, 43, v4
  v_lshrrev_b32 v5, 8, v5
  v_mul_u32_u24 v6, 6, v5
  v_sub_u32 v6, v4, v6
  v_lshlrev_b32 v6, 10, v6
  v_add_u32 v7, 3, v5
  v_lshrrev_b32 v7, 3, v7
  v_mul_u32_u24 v20, 75, v7
  v_add_u32 v20, v20, v5
  s_mul_i32 s9, s58, 5
  s_add_u32 s9, s9, 80
  v_add_u32 v20, s9, v20
  v_lshlrev_b32 v20, 15, v20
  s_lshl_b32 s9, s59, 11
  s_sub_u32 s9, s9, 4096
  v_add3_u32 v20, v20, v6, s9
  v_mul_u32_u24 v21, 6208, v5
  v_mul_u32_u24 v7, 192, v7
  v_add3_u32 v21, v21, v7, v6
  v_lshlrev_b32 v3, 4, v2
  v_readlane_b32 s12, v20, 0
  v_readlane_b32 s13, v20, 1
  v_readlane_b32 s14, v20, 2
  v_readlane_b32 s15, v20, 3
  v_readlane_b32 s16, v20, 4
  v_readlane_b32 s17, v20, 5
  v_readlane_b32 s18, v20, 6
  v_readlane_b32 s19, v20, 7
  v_readlane_b32 s20, v20, 8
  v_readlane_b32 s21, v20, 9
  v_readlane_b32 s22, v20, 10
  v_readlane_b32 s23, v20, 11
  v_readlane_b32 s24, v20, 12
  v_readlane_b32 s25, v20, 13
  v_readlane_b32 s26, v20, 14
  v_readlane_b32 s27, v21, 0
  v_readlane_b32 s28, v21, 1
  v_readlane_b32 s29, v21, 2
  v_readlane_b32 s30, v21, 3
  v_readlane_b32 s31, v21, 4
  v_readlane_b32 s32, v21, 5
  v_readlane_b32 s33, v21, 6
  v_readlane_b32 s34, v21, 7
  v_readlane_b32 s35, v21, 8
  v_readlane_b32 s36, v21, 9
  v_readlane_b32 s37, v21, 10
  v_readlane_b32 s38, v21, 11
  v_readlane_b32 s39, v21, 12
  v_readlane_b32 s40, v21, 13
  v_readlane_b32 s41, v21, 14
  s_add_u32 s4, s86, 0
  s_addc_u32 s5, s87, 0
  s_mov_b32 s6, 7864320
  s_mov_b32 s7, 0x20000
  s_nop 0
  s_waitcnt lgkmcnt(0)
  s_waitcnt vmcnt(8)
  s_barrier
  v_and_b32 v40, 15, v2
  v_lshlrev_b32 v40, 2, v40
  v_add_u32 v40, 6144, v40
  buffer_load_dword v41, v40, s[44:47], 0 offen sc1
  buffer_load_dword v26, v24, s[44:47], 0 offen sc1
  s_waitcnt vmcnt(6)
  s_barrier
  s_waitcnt vmcnt(1)
  s_mov_b32 s43, 0
L_wst_1:
  v_cmp_eq_u32 vcc, 0, v41
  s_nop 0
  s_cmp_eq_u64 vcc, 0
  s_cbranch_scc1 L_wsd_2
  s_add_u32 s43, s43, 1
  s_cmp_ge_u32 s43, 200000
  s_cbranch_scc1 L_wsd_2
  s_sleep 2
  buffer_load_dword v41, v40, s[44:47], 0 offen sc1
  s_waitcnt vmcnt(0)
  s_branch L_wst_1
L_wsd_2:
  s_add_u32 s88, s86, 25165824
  s_addc_u32 s89, s87, 0
  s_mov_b32 s90, 40960
  s_mov_b32 s91, 0x20000
  v_and_b32 v42, 31, v2
  v_lshlrev_b32 v42, 4, v42
  v_lshrrev_b32 v43, 5, v2
  v_mul_u32_u24 v44, 8192, v43
  v_add_u32 v44, v44, v42
  v_mul_u32_u24 v45, 8192, v43
  v_add_u32 v45, v45, v42
  s_lshl_b32 s11, s56, 9
  s_add_u32 s11, s11, 0
  s_lshl_b32 s10, s57, 9
  s_add_u32 s10, s10, 24576
  s_mov_b32 m0, 69120
  s_nop 0
  buffer_load_dwordx4 v44, s[88:91], s10 offen sc1 lds
  s_mov_b32 m0, 70144
  s_nop 0
  buffer_load_dwordx4 v45, s[88:91], s11 offen sc1 lds
  s_waitcnt vmcnt(2)
  v_cmp_eq_u32 vcc, 0, v26
  s_nop 0
  s_cmp_eq_u64 vcc, 0
  s_cbranch_scc0 L_ld_late
  s_mov_b32 m0, s27
  s_nop 0
  buffer_load_dwordx4 v3, s[4:7], s12 offen sc1 lds
  s_mov_b32 m0, s28
  s_nop 0
  buffer_load_dwordx4 v3, s[4:7], s13 offen sc1 lds
  s_mov_b32 m0, s29
  s_nop 0
  buffer_load_dwordx4 v3, s[4:7], s14 offen sc1 lds
  s_mov_b32 m0, s30
  s_nop 0
  buffer_load_dwordx4 v3, s[4:7], s15 offen sc1 lds
  s_mov_b32 m0, s31
  s_nop 0
  buffer_load_dwordx4 v3, s[4:7], s16 offen sc1 lds
  s_mov_b32 m0, s32
  s_nop 0
  buffer_load_dwordx4 v3, s[4:7], s17 offen sc1 lds
  s_mov_b32 m0, s33
  s_nop 0
  buffer_load_dwordx4 v3, s[4:7], s18 offen sc1 lds
  s_mov_b32 m0, s34
  s_nop 0
  buffer_load_dwordx4 v3, s[4:7], s19 offen sc1 lds
  s_mov_b32 m0, s35
  s_nop 0
  buffer_load_dwordx4 v3, s[4:7], s20 offen sc1 lds
  s_mov_b32 m0, s36
  s_nop 0
  buffer_load_dwordx4 v3, s[4:7], s21 offen sc1 lds
  s_mov_b32 m0, s37
  s_nop 0
  buffer_load_dwordx4 v3, s[4:7], s22 offen sc1 lds
  s_mov_b32 m0, s38
  s_nop 0
  buffer_load_dwordx4 v3, s[4:7], s23 offen sc1 lds
  s_mov_b32 m0, s39
  s_nop 0
  buffer_load_dwordx4 v3, s[4:7], s24 offen sc1 lds
  s_mov_b32 m0, s40
  s_nop 0
  buffer_load_dwordx4 v3, s[4:7], s25 offen sc1 lds
  s_mov_b32 m0, s41
  s_nop 0
  buffer_load_dwordx4 v3, s[4:7], s26 offen sc1 lds
  s_mul_i32 s8, s58, 5
  s_lshl_b32 s9, s59, 11
  s_add_u32 s10, s3, -4
  s_lshr_b32 s11, s10, 1
  s_add_u32 s12, s11, s8
  s_lshl_b32 s12, s12, 15
  s_add_u32 s12, s12, s9
  s_and_b32 s13, s10, 1
  s_lshl_b32 s13, s13, 10
  s_add_u32 s12, s12, s13
  s_lshl_b32 s10, s10, 10
  s_add_u32 m0, s10, 71680
  s_nop 0
  buffer_load_dwordx4 v3, s[4:7], s12 offen sc1 lds
L_qd_3:
  s_add_u32 s10, s3, 0
  s_lshr_b32 s11, s10, 1
  s_add_u32 s12, s11, s8
  s_lshl_b32 s12, s12, 15
  s_add_u32 s12, s12, s9
  s_and_b32 s13, s10, 1
  s_lshl_b32 s13, s13, 10
  s_add_u32 s12, s12, s13
  s_lshl_b32 s10, s10, 10
  s_add_u32 m0, s10, 71680
  s_nop 0
  buffer_load_dwordx4 v3, s[4:7], s12 offen sc1 lds
L_qd_4:
  s_add_u32 s10, s3, 4
  s_cmp_ge_u32 s3, 6
  s_cselect_b32 s10, s3, s10
  s_lshr_b32 s11, s10, 1
  s_add_u32 s12, s11, s8
  s_lshl_b32 s12, s12, 15
  s_add_u32 s12, s12, s9
  s_and_b32 s13, s10, 1
  s_lshl_b32 s13, s13, 10
  s_add_u32 s12, s12, s13
  s_lshl_b32 s10, s10, 10
  s_add_u32 m0, s10, 71680
  s_nop 0
  buffer_load_dwordx4 v3, s[4:7], s12 offen sc1 lds
L_qd_5:
  s_waitcnt vmcnt(18)
  s_waitcnt vmcnt(22)
  s_barrier
  s_branch L_cpro_issued
L_ld_late:
  s_waitcnt vmcnt(0)
  s_waitcnt vmcnt(4)
  s_barrier
  s_branch L_cpro_ready
L_consumer:
  v_and_b32 v8, 31, v2
  v_lshrrev_b32 v9, 5, v2
  v_lshlrev_b32 v5, 15, v9
  v_lshl_add_u32 v5, v8, 4, v5
  v_bfe_u32 v10, v8, 1, 3
  v_xor_b32 v10, v9, v10
  v_lshlrev_b32 v10, 4, v10
  s_lshl_b32 s27, s3, 5
  v_add_u32 v11, s27, v8
  v_lshl_add_u32 v4, v11, 7, v10
  v_bfe_u32 v10, v2, 2, 2
  v_and_b32 v11, 1, v2
  v_bfe_u32 v12, v2, 1, 1
  v_lshl_or_b32 v11, v11, 1, v12
  v_bfe_u32 v12, v2, 4, 1
  v_lshl_or_b32 v11, v12, 2, v11
  v_lshlrev_b32 v11, 3, v11
  v_lshl_add_u32 v12, v9, 3, v10
  v_lshl_add_u32 v11, v12, 7, v11
  v_add_u32 v11, 65536, v11
  v_lshrrev_b32 v10, 1, v10
  v_lshl_add_u32 v2, v10, 6, v11
  v_xor_b32 v10, 1, v10
  v_lshl_add_u32 v3, v10, 6, v11
  s_waitcnt lgkmcnt(0)
  s_add_u32 s44, s86, 26214400
  s_addc_u32 s45, s87, 0
  s_mov_b32 s46, 7296
  s_mov_b32 s47, 0x20000
  s_mov_b32 s48, s84
  s_mov_b32 s49, s85
  s_mov_b32 s50, 256
  s_mov_b32 s51, 0x20000
  s_and_b32 s20, s2, 7
  s_lshr_b32 s21, s2, 3
  s_and_b32 s22, s21, 1
  s_lshl_b32 s20, s20, 1
  s_add_u32 s58, s20, s22
  s_lshr_b32 s59, s21, 1
  s_and_b32 s20, s2, 7
  s_lshr_b32 s21, s2, 3
  s_and_b32 s22, s20, 1
  s_lshl_b32 s22, s22, 2
  s_and_b32 s23, s21, 3
  s_add_u32 s61, s22, s23
  s_lshr_b32 s20, s20, 1
  s_lshl_b32 s20, s20, 3
  s_lshr_b32 s21, s21, 2
  s_add_u32 s60, s20, s21
  s_lshl_b32 s27, s57, 19
  s_lshl_b32 s28, s56, 11
  s_lshl_b32 s29, s3, 9
  s_add_u32 s27, s27, s28
  s_add_u32 s92, s27, s29
  s_add_u32 s12, s86, 0
  s_addc_u32 s13, s87, 0
  s_mov_b32 s14, 7864320
  s_mov_b32 s15, 0x20000
  s_add_u32 s20, s86, 8388608
  s_addc_u32 s21, s87, 0
  s_mov_b32 s22, 7077888
  s_mov_b32 s23, 0x20000
  s_mov_b32 s30, 0x3ea52b5c
  s_cmp_lt_u32 s57, 5
  s_cselect_b32 s30, s30, 1.0
  s_mov_b32 s94, 0xbdd2d3e8
  s_mov_b32 s95, 0xbdd2d3e8
  s_cmp_eq_u32 s54, 0
  s_cbranch_scc1 L_consumer_a
  s_barrier
  ds_read_b128 v[32:35], v4 offset:0
  v_xor_b32 v4, 32, v4
  ds_read_b64_tr_b16 v[8:9], v2 offset:0
  ds_read_b64_tr_b16 v[10:11], v2 offset:512
  ds_read_b64_tr_b16 v[12:13], v3 offset:0
  ds_read_b64_tr_b16 v[14:15], v3 offset:512
  ds_read_b128 v[36:39], v4 offset:0
  v_xor_b32 v4, 96, v4
  ds_read_b64_tr_b16 v[16:17], v2 offset:2048
  ds_read_b64_tr_b16 v[18:19], v2 offset:2560
  ds_read_b64_tr_b16 v[20:21], v3 offset:2048
  ds_read_b64_tr_b16 v[22:23], v3 offset:2560
  s_waitcnt lgkmcnt(7)
  v_mfma_f32_32x32x16_bf16 v[192:207], v[8:11], v[32:35], 0
  ds_read_b128 v[40:43], v4 offset:0
  v_xor_b32 v4, 32, v4
  ds_read_b64_tr_b16 v[24:25], v2 offset:4096
  ds_read_b64_tr_b16 v[26:27], v2 offset:4608
  s_waitcnt lgkmcnt(8)
  v_mfma_f32_32x32x16_bf16 v[208:223], v[12:15], v[32:35], 0
  ds_read_b64_tr_b16 v[8:9], v3 offset:4096
  ds_read_b64_tr_b16 v[10:11], v3 offset:4608
  s_waitcnt lgkmcnt(7)
  v_mfma_f32_32x32x16_bf16 v[192:207], v[16:19], v[36:39], v[192:207]
  ds_read_b128 v[44:47], v4 offset:0
  v_xor_b32 v4, 96, v4
  ds_read_b64_tr_b16 v[12:13], v2 offset:6144
  ds_read_b64_tr_b16 v[14:15], v2 offset:6656
  s_waitcnt lgkmcnt(8)
  v_mfma_f32_32x32x16_bf16 v[208:223], v[20:23], v[36:39], v[208:223]
  ds_read_b64_tr_b16 v[16:17], v3 offset:6144
  ds_read_b64_tr_b16 v[18:19], v3 offset:6656
  s_waitcnt lgkmcnt(7)
  v_mfma_f32_32x32x16_bf16 v[192:207], v[24:27], v[40:43], v[192:207]
  s_barrier
  ds_read_b128 v[48:51], v4 offset:16384
  v_xor_b32 v4, 32, v4
  ds_read_b64_tr_b16 v[20:21], v2 offset:8192
  ds_read_b64_tr_b16 v[22:23], v2 offset:8704
  s_waitcnt lgkmcnt(8)
  v_mfma_f32_32x32x16_bf16 v[208:223], v[8:11], v[40:43], v[208:223]
  ds_read_b64_tr_b16 v[24:25], v3 offset:8192
  ds_read_b64_tr_b16 v[26:27], v3 offset:8704
  s_waitcnt lgkmcnt(7)
  v_mfma_f32_32x32x16_bf16 v[192:207], v[12:15], v[44:47], v[192:207]
  ds_read_b128 v[52:55], v4 offset:16384
  v_xor_b32 v4, 96, v4
  ds_read_b64_tr_b16 v[8:9], v2 offset:10240
  ds_read_b64_tr_b16 v[10:11], v2 offset:10752
  s_waitcnt lgkmcnt(8)
  v_mfma_f32_32x32x16_bf16 v[208:223], v[16:19], v[44:47], v[208:223]
  ds_read_b64_tr_b16 v[12:13], v3 offset:10240
  ds_read_b64_tr_b16 v[14:15], v3 offset:10752
  s_waitcnt lgkmcnt(7)
  v_mfma_f32_32x32x16_bf16 v[192:207], v[20:23], v[48:51], v[192:207]
  ds_read_b128 v[56:59], v4 offset:16384
  v_xor_b32 v4, 32, v4
  ds_read_b64_tr_b16 v[16:17], v2 offset:12288
  ds_read_b64_tr_b16 v[18:19], v2 offset:12800
  s_waitcnt lgkmcnt(8)
  v_mfma_f32_32x32x16_bf16 v[208:223], v[24:27], v[48:51], v[208:223]
  ds_read_b64_tr_b16 v[20:21], v3 offset:12288
  ds_read_b64_tr_b16 v[22:23], v3 offset:12800
  s_waitcnt lgkmcnt(7)
  v_mfma_f32_32x32x16_bf16 v[192:207], v[8:11], v[52:55], v[192:207]
  ds_read_b128 v[60:63], v4 offset:16384
  v_xor_b32 v4, 96, v4
  ds_read_b64_tr_b16 v[24:25], v2 offset:14336
  ds_read_b64_tr_b16 v[26:27], v2 offset:14848
  s_waitcnt lgkmcnt(8)
  v_mfma_f32_32x32x16_bf16 v[208:223], v[12:15], v[52:55], v[208:223]
  ds_read_b64_tr_b16 v[8:9], v3 offset:14336
  ds_read_b64_tr_b16 v[10:11], v3 offset:14848
  s_waitcnt lgkmcnt(7)
  v_mfma_f32_32x32x16_bf16 v[192:207], v[16:19], v[56:59], v[192:207]
  s_barrier
  ds_read_b128 v[64:67], v4 offset:32768
  v_xor_b32 v4, 32, v4
  ds_read_b64_tr_b16 v[12:13], v2 offset:16384
  ds_read_b64_tr_b16 v[14:15], v2 offset:16896
  s_waitcnt lgkmcnt(8)
  v_mfma_f32_32x32x16_bf16 v[208:223], v[20:23], v[56:59], v[208:223]
  ds_read_b64_tr_b16 v[16:17], v3 offset:16384
  ds_read_b64_tr_b16 v[18:19], v3 offset:16896
  s_waitcnt lgkmcnt(7)
  v_mfma_f32_32x32x16_bf16 v[192:207], v[24:27], v[60:63], v[192:207]
  ds_read_b128 v[68:71], v4 offset:32768
  v_xor_b32 v4, 96, v4
  ds_read_b64_tr_b16 v[20:21], v2 offset:18432
  ds_read_b64_tr_b16 v[22:23], v2 offset:18944
  s_waitcnt lgkmcnt(8)
  v_mfma_f32_32x32x16_bf16 v[208:223], v[8:11], v[60:63], v[208:223]
  ds_read_b64_tr_b16 v[24:25], v3 offset:18432
  ds_read_b64_tr_b16 v[26:27], v3 offset:18944
  s_waitcnt lgkmcnt(7)
  v_mfma_f32_32x32x16_bf16 v[192:207], v[12:15], v[64:67], v[192:207]
  ds_read_b128 v[72:75], v4 offset:32768
  v_xor_b32 v4, 32, v4
  ds_read_b64_tr_b16 v[8:9], v2 offset:20480
  ds_read_b64_tr_b16 v[10:11], v2 offset:20992
  s_waitcnt lgkmcnt(8)
  v_mfma_f32_32x32x16_bf16 v[208:223], v[16:19], v[64:67], v[208:223]
  ds_read_b64_tr_b16 v[12:13], v3 offset:20480
  ds_read_b64_tr_b16 v[14:15], v3 offset:20992
  s_waitcnt lgkmcnt(7)
  v_mfma_f32_32x32x16_bf16 v[192:207], v[20:23], v[68:71], v[192:207]
  ds_read_b128 v[76:79], v4 offset:32768
  v_xor_b32 v4, 96, v4
  ds_read_b64_tr_b16 v[16:17], v2 offset:22528
  ds_read_b64_tr_b16 v[18:19], v2 offset:23040
  s_waitcnt lgkmcnt(8)
  v_mfma_f32_32x32x16_bf16 v[208:223], v[24:27], v[68:71], v[208:223]
  ds_read_b64_tr_b16 v[20:21], v3 offset:22528
  ds_read_b64_tr_b16 v[22:23], v3 offset:23040
  s_waitcnt lgkmcnt(7)
  v_mfma_f32_32x32x16_bf16 v[192:207], v[8:11], v[72:75], v[192:207]
  s_barrier
  ds_read_b128 v[80:83], v4 offset:49152
  v_xor_b32 v4, 32, v4
  ds_read_b64_tr_b16 v[24:25], v2 offset:24576
  ds_read_b64_tr_b16 v[26:27], v2 offset:25088
  s_waitcnt lgkmcnt(8)
  v_mfma_f32_32x32x16_bf16 v[208:223], v[12:15], v[72:75], v[208:223]
  ds_read_b64_tr_b16 v[8:9], v3 offset:24576
  ds_read_b64_tr_b16 v[10:11], v3 offset:25088
  s_waitcnt lgkmcnt(7)
  v_mfma_f32_32x32x16_bf16 v[192:207], v[16:19], v[76:79], v[192:207]
  ds_read_b128 v[84:87], v4 offset:49152
  v_xor_b32 v4, 96, v4
  ds_read_b64_tr_b16 v[12:13], v2 offset:26624
  ds_read_b64_tr_b16 v[14:15], v2 offset:27136
  s_waitcnt lgkmcnt(8)
  v_mfma_f32_32x32x16_bf16 v[208:223], v[20:23], v[76:79], v[208:223]
  ds_read_b64_tr_b16 v[16:17], v3 offset:26624
  ds_read_b64_tr_b16 v[18:19], v3 offset:27136
  s_waitcnt lgkmcnt(7)
  v_mfma_f32_32x32x16_bf16 v[192:207], v[24:27], v[80:83], v[192:207]
  ds_read_b128 v[88:91], v4 offset:49152
  v_xor_b32 v4, 32, v4
  ds_read_b64_tr_b16 v[20:21], v2 offset:28672
  ds_read_b64_tr_b16 v[22:23], v2 offset:29184
  s_waitcnt lgkmcnt(8)
  v_mfma_f32_32x32x16_bf16 v[208:223], v[8:11], v[80:83], v[208:223]
  ds_read_b64_tr_b16 v[24:25], v3 offset:28672
  ds_read_b64_tr_b16 v[26:27], v3 offset:29184
  s_waitcnt lgkmcnt(7)
  v_mfma_f32_32x32x16_bf16 v[192:207], v[12:15], v[84:87], v[192:207]
  ds_read_b128 v[92:95], v4 offset:49152
  v_xor_b32 v4, 96, v4
  ds_read_b64_tr_b16 v[8:9], v2 offset:30720
  ds_read_b64_tr_b16 v[10:11], v2 offset:31232
  s_waitcnt lgkmcnt(8)
  v_mfma_f32_32x32x16_bf16 v[208:223], v[16:19], v[84:87], v[208:223]
  ds_read_b64_tr_b16 v[12:13], v3 offset:30720
  ds_read_b64_tr_b16 v[14:15], v3 offset:31232
  s_waitcnt lgkmcnt(7)
  v_mfma_f32_32x32x16_bf16 v[192:207], v[20:23], v[88:91], v[192:207]
  s_barrier
  ds_read_b128 v[96:99], v4 offset:0
  v_xor_b32 v4, 32, v4
  ds_read_b64_tr_b16 v[16:17], v2 offset:0
  ds_read_b64_tr_b16 v[18:19], v2 offset:512
  s_waitcnt lgkmcnt(8)
  v_mfma_f32_32x32x16_bf16 v[208:223], v[24:27], v[88:91], v[208:223]
  ds_read_b64_tr_b16 v[20:21], v3 offset:0
  ds_read_b64_tr_b16 v[22:23], v3 offset:512
  s_waitcnt lgkmcnt(7)
  v_mfma_f32_32x32x16_bf16 v[192:207], v[8:11], v[92:95], v[192:207]
  ds_read_b128 v[100:103], v4 offset:0
  v_xor_b32 v4, 96, v4
  ds_read_b64_tr_b16 v[24:25], v2 offset:2048
  ds_read_b64_tr_b16 v[26:27], v2 offset:2560
  s_waitcnt lgkmcnt(8)
  v_mfma_f32_32x32x16_bf16 v[208:223], v[12:15], v[92:95], v[208:223]
  ds_read_b64_tr_b16 v[8:9], v3 offset:2048
  ds_read_b64_tr_b16 v[10:11], v3 offset:2560
  s_waitcnt lgkmcnt(7)
  v_mfma_f32_32x32x16_bf16 v[192:207], v[16:19], v[96:99], v[192:207]
  ds_read_b128 v[104:107], v4 offset:0
  v_xor_b32 v4, 32, v4
  ds_read_b64_tr_b16 v[12:13], v2 offset:4096
  ds_read_b64_tr_b16 v[14:15], v2 offset:4608
  s_waitcnt lgkmcnt(8)
  v_mfma_f32_32x32x16_bf16 v[208:223], v[20:23], v[96:99], v[208:223]
  ds_read_b64_tr_b16 v[16:17], v3 offset:4096
  ds_read_b64_tr_b16 v[18:19], v3 offset:4608
  s_waitcnt lgkmcnt(7)
  v_mfma_f32_32x32x16_bf16 v[192:207], v[24:27], v[100:103], v[192:207]
  ds_read_b128 v[108:111], v4 offset:0
  v_xor_b32 v4, 96, v4
  ds_read_b64_tr_b16 v[20:21], v2 offset:6144
  ds_read_b64_tr_b16 v[22:23], v2 offset:6656
  s_waitcnt lgkmcnt(8)
  v_mfma_f32_32x32x16_bf16 v[208:223], v[8:11], v[100:103], v[208:223]
  ds_read_b64_tr_b16 v[24:25], v3 offset:6144
  ds_read_b64_tr_b16 v[26:27], v3 offset:6656
  s_waitcnt lgkmcnt(7)
  v_mfma_f32_32x32x16_bf16 v[192:207], v[12:15], v[104:107], v[192:207]
  s_barrier
  ds_read_b128 v[112:115], v4 offset:16384
  v_xor_b32 v4, 32, v4
  ds_read_b64_tr_b16 v[8:9], v2 offset:8192
  ds_read_b64_tr_b16 v[10:11], v2 offset:8704
  s_waitcnt lgkmcnt(8)
  v_mfma_f32_32x32x16_bf16 v[208:223], v[16:19], v[104:107], v[208:223]
  ds_read_b64_tr_b16 v[12:13], v3 offset:8192
  ds_read_b64_tr_b16 v[14:15], v3 offset:8704
  s_waitcnt lgkmcnt(7)
  v_mfma_f32_32x32x16_bf16 v[192:207], v[20:23], v[108:111], v[192:207]
  ds_read_b128 v[116:119], v4 offset:16384
  v_xor_b32 v4, 96, v4
  ds_read_b64_tr_b16 v[16:17], v2 offset:10240
  ds_read_b64_tr_b16 v[18:19], v2 offset:10752
  s_waitcnt lgkmcnt(8)
  v_mfma_f32_32x32x16_bf16 v[208:223], v[24:27], v[108:111], v[208:223]
  ds_read_b64_tr_b16 v[20:21], v3 offset:10240
  ds_read_b64_tr_b16 v[22:23], v3 offset:10752
  s_waitcnt lgkmcnt(7)
  v_mfma_f32_32x32x16_bf16 v[192:207], v[8:11], v[112:115], v[192:207]
  ds_read_b128 v[120:123], v4 offset:16384
  v_xor_b32 v4, 32, v4
  ds_read_b64_tr_b16 v[24:25], v2 offset:12288
  ds_read_b64_tr_b16 v[26:27], v2 offset:12800
  s_waitcnt lgkmcnt(8)
  v_mfma_f32_32x32x16_bf16 v[208:223], v[12:15], v[112:115], v[208:223]
  ds_read_b64_tr_b16 v[8:9], v3 offset:12288
  ds_read_b64_tr_b16 v[10:11], v3 offset:12800
  s_waitcnt lgkmcnt(7)
  v_mfma_f32_32x32x16_bf16 v[192:207], v[16:19], v[116:119], v[192:207]
  ds_read_b128 v[124:127], v4 offset:16384
  v_xor_b32 v4, 96, v4
  ds_read_b64_tr_b16 v[12:13], v2 offset:14336
  ds_read_b64_tr_b16 v[14:15], v2 offset:14848
  s_waitcnt lgkmcnt(8)
  v_mfma_f32_32x32x16_bf16 v[208:223], v[20:23], v[116:119], v[208:223]
  ds_read_b64_tr_b16 v[16:17], v3 offset:14336
  ds_read_b64_tr_b16 v[18:19], v3 offset:14848
  s_waitcnt lgkmcnt(7)
  v_mfma_f32_32x32x16_bf16 v[192:207], v[24:27], v[120:123], v[192:207]
  s_barrier
  ds_read_b128 v[128:131], v4 offset:32768
  v_xor_b32 v4, 32, v4
  ds_read_b64_tr_b16 v[20:21], v2 offset:16384
  ds_read_b64_tr_b16 v[22:23], v2 offset:16896
  s_waitcnt lgkmcnt(8)
  v_mfma_f32_32x32x16_bf16 v[208:223], v[8:11], v[120:123], v[208:223]
  ds_read_b64_tr_b16 v[24:25], v3 offset:16384
  ds_read_b64_tr_b16 v[26:27], v3 offset:16896
  s_waitcnt lgkmcnt(7)
  v_mfma_f32_32x32x16_bf16 v[192:207], v[12:15], v[124:127], v[192:207]
  ds_read_b128 v[132:135], v4 offset:32768
  v_xor_b32 v4, 96, v4
  ds_read_b64_tr_b16 v[8:9], v2 offset:18432
  ds_read_b64_tr_b16 v[10:11], v2 offset:18944
  s_waitcnt lgkmcnt(8)
  v_mfma_f32_32x32x16_bf16 v[208:223], v[16:19], v[124:127], v[208:223]
  ds_read_b64_tr_b16 v[12:13], v3 offset:18432
  ds_read_b64_tr_b16 v[14:15], v3 offset:18944
  s_waitcnt lgkmcnt(7)
  v_mfma_f32_32x32x16_bf16 v[192:207], v[20:23], v[128:131], v[192:207]
  ds_read_b128 v[136:139], v4 offset:32768
  v_xor_b32 v4, 32, v4
  ds_read_b64_tr_b16 v[16:17], v2 offset:20480
  ds_read_b64_tr_b16 v[18:19], v2 offset:20992
  s_waitcnt lgkmcnt(8)
  v_mfma_f32_32x32x16_bf16 v[208:223], v[24:27], v[128:131], v[208:223]
  ds_read_b64_tr_b16 v[20:21], v3 offset:20480
  ds_read_b64_tr_b16 v[22:23], v3 offset:20992
  s_waitcnt lgkmcnt(7)
  v_mfma_f32_32x32x16_bf16 v[192:207], v[8:11], v[132:135], v[192:207]
  ds_read_b128 v[140:143], v4 offset:32768
  v_xor_b32 v4, 96, v4
  ds_read_b64_tr_b16 v[24:25], v2 offset:22528
  ds_read_b64_tr_b16 v[26:27], v2 offset:23040
  s_waitcnt lgkmcnt(8)
  v_mfma_f32_32x32x16_bf16 v[208:223], v[12:15], v[132:135], v[208:223]
  ds_read_b64_tr_b16 v[8:9], v3 offset:22528
  ds_read_b64_tr_b16 v[10:11], v3 offset:23040
  s_waitcnt lgkmcnt(7)
  v_mfma_f32_32x32x16_bf16 v[192:207], v[16:19], v[136:139], v[192:207]
  s_barrier
  ds_read_b128 v[144:147], v4 offset:49152
  v_xor_b32 v4, 32, v4
  ds_read_b64_tr_b16 v[12:13], v2 offset:24576
  ds_read_b64_tr_b16 v[14:15], v2 offset:25088
  s_waitcnt lgkmcnt(8)
  v_mfma_f32_32x32x16_bf16 v[208:223], v[20:23], v[136:139], v[208:223]
  ds_read_b64_tr_b16 v[16:17], v3 offset:24576
  ds_read_b64_tr_b16 v[18:19], v3 offset:25088
  s_waitcnt lgkmcnt(7)
  v_mfma_f32_32x32x16_bf16 v[192:207], v[24:27], v[140:143], v[192:207]
  ds_read_b128 v[148:151], v4 offset:49152
  v_xor_b32 v4, 96, v4
  ds_read_b64_tr_b16 v[20:21], v2 offset:26624
  ds_read_b64_tr_b16 v[22:23], v2 offset:27136
  s_waitcnt lgkmcnt(8)
  v_mfma_f32_32x32x16_bf16 v[208:223], v[8:11], v[140:143], v[208:223]
  ds_read_b64_tr_b16 v[24:25], v3 offset:26624
  ds_read_b64_tr_b16 v[26:27], v3 offset:27136
  s_waitcnt lgkmcnt(7)
  v_mfma_f32_32x32x16_bf16 v[192:207], v[12:15], v[144:147], v[192:207]
  ds_read_b128 v[152:155], v4 offset:49152
  v_xor_b32 v4, 32, v4
  ds_read_b64_tr_b16 v[8:9], v2 offset:28672
  ds_read_b64_tr_b16 v[10:11], v2 offset:29184
  s_waitcnt lgkmcnt(8)
  v_mfma_f32_32x32x16_bf16 v[208:223], v[16:19], v[144:147], v[208:223]
  ds_read_b64_tr_b16 v[12:13], v3 offset:28672
  ds_read_b64_tr_b16 v[14:15], v3 offset:29184
  s_waitcnt lgkmcnt(7)
  v_mfma_f32_32x32x16_bf16 v[192:207], v[20:23], v[148:151], v[192:207]
  ds_read_b128 v[156:159], v4 offset:49152
  v_xor_b32 v4, 96, v4
  ds_read_b64_tr_b16 v[16:17], v2 offset:30720
  ds_read_b64_tr_b16 v[18:19], v2 offset:31232
  s_waitcnt lgkmcnt(8)
  v_mfma_f32_32x32x16_bf16 v[208:223], v[24:27], v[148:151], v[208:223]
  ds_read_b64_tr_b16 v[20:21], v3 offset:30720
  ds_read_b64_tr_b16 v[22:23], v3 offset:31232
  s_waitcnt lgkmcnt(7)
  v_mfma_f32_32x32x16_bf16 v[192:207], v[8:11], v[152:155], v[192:207]
  s_barrier
  ds_read_b128 v[160:163], v4 offset:0
  v_xor_b32 v4, 32, v4
  ds_read_b64_tr_b16 v[24:25], v2 offset:0
  ds_read_b64_tr_b16 v[26:27], v2 offset:512
  s_waitcnt lgkmcnt(8)
  v_mfma_f32_32x32x16_bf16 v[208:223], v[12:15], v[152:155], v[208:223]
  ds_read_b64_tr_b16 v[8:9], v3 offset:0
  ds_read_b64_tr_b16 v[10:11], v3 offset:512
  s_waitcnt lgkmcnt(7)
  v_mfma_f32_32x32x16_bf16 v[192:207], v[16:19], v[156:159], v[192:207]
  ds_read_b128 v[164:167], v4 offset:0
  v_xor_b32 v4, 96, v4
  ds_read_b64_tr_b16 v[12:13], v2 offset:2048
  ds_read_b64_tr_b16 v[14:15], v2 offset:2560
  s_waitcnt lgkmcnt(8)
  v_mfma_f32_32x32x16_bf16 v[208:223], v[20:23], v[156:159], v[208:223]
  ds_read_b64_tr_b16 v[16:17], v3 offset:2048
  ds_read_b64_tr_b16 v[18:19], v3 offset:2560
  s_waitcnt lgkmcnt(7)
  v_mfma_f32_32x32x16_bf16 v[192:207], v[24:27], v[160:163], v[192:207]
  ds_read_b128 v[168:171], v4 offset:0
  v_xor_b32 v4, 32, v4
  ds_read_b64_tr_b16 v[20:21], v2 offset:4096
  ds_read_b64_tr_b16 v[22:23], v2 offset:4608
  s_waitcnt lgkmcnt(8)
  v_mfma_f32_32x32x16_bf16 v[208:223], v[8:11], v[160:163], v[208:223]
  ds_read_b64_tr_b16 v[24:25], v3 offset:4096
  ds_read_b64_tr_b16 v[26:27], v3 offset:4608
  s_waitcnt lgkmcnt(7)
  v_mfma_f32_32x32x16_bf16 v[192:207], v[12:15], v[164:167], v[192:207]
  ds_read_b128 v[172:175], v4 offset:0
  v_xor_b32 v4, 96, v4
  ds_read_b64_tr_b16 v[8:9], v2 offset:6144
  ds_read_b64_tr_b16 v[10:11], v2 offset:6656
  s_waitcnt lgkmcnt(8)
  v_mfma_f32_32x32x16_bf16 v[208:223], v[16:19], v[164:167], v[208:223]
  ds_read_b64_tr_b16 v[12:13], v3 offset:6144
  ds_read_b64_tr_b16 v[14:15], v3 offset:6656
  s_waitcnt lgkmcnt(7)
  v_mfma_f32_32x32x16_bf16 v[192:207], v[20:23], v[168:171], v[192:207]
  s_barrier
  ds_read_b128 v[176:179], v4 offset:16384
  v_xor_b32 v4, 32, v4
  ds_read_b64_tr_b16 v[16:17], v2 offset:8192
  ds_read_b64_tr_b16 v[18:19], v2 offset:8704
  s_waitcnt lgkmcnt(8)
  v_mfma_f32_32x32x16_bf16 v[208:223], v[24:27], v[168:171], v[208:223]
  ds_read_b64_tr_b16 v[20:21], v3 offset:8192
  ds_read_b64_tr_b16 v[22:23], v3 offset:8704
  s_waitcnt lgkmcnt(7)
  v_mfma_f32_32x32x16_bf16 v[192:207], v[8:11], v[172:175], v[192:207]
  ds_read_b128 v[180:183], v4 offset:16384
  v_xor_b32 v4, 96, v4
  ds_read_b64_tr_b16 v[24:25], v2 offset:10240
  ds_read_b64_tr_b16 v[26:27], v2 offset:10752
  s_waitcnt lgkmcnt(8)
  v_mfma_f32_32x32x16_bf16 v[208:223], v[12:15], v[172:175], v[208:223]
  ds_read_b64_tr_b16 v[8:9], v3 offset:10240
  ds_read_b64_tr_b16 v[10:11], v3 offset:10752
  s_waitcnt lgkmcnt(7)
  v_mfma_f32_32x32x16_bf16 v[192:207], v[16:19], v[176:179], v[192:207]
  ds_read_b128 v[184:187], v4 offset:16384
  v_xor_b32 v4, 32, v4
  ds_read_b64_tr_b16 v[12:13], v2 offset:12288
  ds_read_b64_tr_b16 v[14:15], v2 offset:12800
  s_waitcnt lgkmcnt(8)
  v_mfma_f32_32x32x16_bf16 v[208:223], v[20:23], v[176:179], v[208:223]
  ds_read_b64_tr_b16 v[16:17], v3 offset:12288
  ds_read_b64_tr_b16 v[18:19], v3 offset:12800
  s_waitcnt lgkmcnt(7)
  v_mfma_f32_32x32x16_bf16 v[192:207], v[24:27], v[180:183], v[192:207]
  ds_read_b128 v[188:191], v4 offset:16384
  v_xor_b32 v4, 96, v4
  ds_read_b64_tr_b16 v[20:21], v2 offset:14336
  ds_read_b64_tr_b16 v[22:23], v2 offset:14848
  s_waitcnt lgkmcnt(8)
  v_mfma_f32_32x32x16_bf16 v[208:223], v[8:11], v[180:183], v[208:223]
  ds_read_b64_tr_b16 v[24:25], v3 offset:14336
  ds_read_b64_tr_b16 v[26:27], v3 offset:14848
  s_waitcnt lgkmcnt(7)
  v_mfma_f32_32x32x16_bf16 v[192:207], v[12:15], v[184:187], v[192:207]
  s_barrier
  v_add_u32 v2, 0x8000, v2
  v_add_u32 v3, 0x8000, v3
  ds_read_b64_tr_b16 v[8:9], v2 offset:0
  ds_read_b64_tr_b16 v[10:11], v2 offset:512
  s_waitcnt lgkmcnt(7)
  v_mfma_f32_32x32x16_bf16 v[208:223], v[16:19], v[184:187], v[208:223]
  ds_read_b64_tr_b16 v[12:13], v3 offset:0
  ds_read_b64_tr_b16 v[14:15], v3 offset:512
  s_waitcnt lgkmcnt(6)
  v_mfma_f32_32x32x16_bf16 v[192:207], v[20:23], v[188:191], v[192:207]
  ds_read_b64_tr_b16 v[16:17], v2 offset:2048
  ds_read_b64_tr_b16 v[18:19], v2 offset:2560
  s_waitcnt lgkmcnt(6)
  v_mfma_f32_32x32x16_bf16 v[208:223], v[24:27], v[188:191], v[208:223]
  ds_read_b64_tr_b16 v[20:21], v3 offset:2048
  ds_read_b64_tr_b16 v[22:23], v3 offset:2560
  s_waitcnt lgkmcnt(6)
  v_mfma_f32_32x32x16_bf16 v[224:239], v[8:11], v[32:35], 0
  ds_read_b64_tr_b16 v[24:25], v2 offset:4096
  ds_read_b64_tr_b16 v[26:27], v2 offset:4608
  s_waitcnt lgkmcnt(6)
  v_mfma_f32_32x32x16_bf16 v[240:255], v[12:15], v[32:35], 0
  s_waitcnt vmcnt(0)
  ds_read_b64_tr_b16 v[8:9], v3 offset:4096
  ds_read_b64_tr_b16 v[10:11], v3 offset:4608
  s_waitcnt lgkmcnt(6)
  v_mfma_f32_32x32x16_bf16 v[224:239], v[16:19], v[36:39], v[224:239]
  ds_read_b64_tr_b16 v[12:13], v2 offset:6144
  ds_read_b64_tr_b16 v[14:15], v2 offset:6656
  s_waitcnt lgkmcnt(6)
  v_mfma_f32_32x32x16_bf16 v[240:255], v[20:23], v[36:39], v[240:255]
  ds_read_b64_tr_b16 v[16:17], v3 offset:6144
  ds_read_b64_tr_b16 v[18:19], v3 offset:6656
  s_waitcnt lgkmcnt(6)
  v_mfma_f32_32x32x16_bf16 v[224:239], v[24:27], v[40:43], v[224:239]
  ds_read_b64_tr_b16 v[20:21], v2 offset:8192
  ds_read_b64_tr_b16 v[22:23], v2 offset:8704
  s_waitcnt lgkmcnt(6)
  v_mfma_f32_32x32x16_bf16 v[240:255], v[8:11], v[40:43], v[240:255]
  ds_read_b64_tr_b16 v[24:25], v3 offset:8192
  ds_read_b64_tr_b16 v[26:27], v3 offset:8704
  s_waitcnt lgkmcnt(6)
  v_mfma_f32_32x32x16_bf16 v[224:239], v[12:15], v[44:47], v[224:239]
  ds_read_b64_tr_b16 v[8:9], v2 offset:10240
  ds_read_b64_tr_b16 v[10:11], v2 offset:10752
  s_waitcnt lgkmcnt(6)
  v_mfma_f32_32x32x16_bf16 v[240:255], v[16:19], v[44:47], v[240:255]
  ds_read_b64_tr_b16 v[12:13], v3 offset:10240
  ds_read_b64_tr_b16 v[14:15], v3 offset:10752
  s_waitcnt lgkmcnt(6)
  v_mfma_f32_32x32x16_bf16 v[224:239], v[20:23], v[48:51], v[224:239]
  v_mul_f32 v192, s30, v192
  ds_read_b64_tr_b16 v[16:17], v2 offset:12288
  ds_read_b64_tr_b16 v[18:19], v2 offset:12800
  s_waitcnt lgkmcnt(6)
  v_mfma_f32_32x32x16_bf16 v[240:255], v[24:27], v[48:51], v[240:255]
  v_mul_f32 v193, s30, v193
  ds_read_b64_tr_b16 v[20:21], v3 offset:12288
  ds_read_b64_tr_b16 v[22:23], v3 offset:12800
  s_waitcnt lgkmcnt(6)
  v_mfma_f32_32x32x16_bf16 v[224:239], v[8:11], v[52:55], v[224:239]
  v_mul_f32 v194, s30, v194
  ds_read_b64_tr_b16 v[24:25], v2 offset:14336
  ds_read_b64_tr_b16 v[26:27], v2 offset:14848
  s_waitcnt lgkmcnt(6)
  v_mfma_f32_32x32x16_bf16 v[240:255], v[12:15], v[52:55], v[240:255]
  v_mul_f32 v195, s30, v195
  ds_read_b64_tr_b16 v[8:9], v3 offset:14336
  ds_read_b64_tr_b16 v[10:11], v3 offset:14848
  s_waitcnt lgkmcnt(6)
  v_mfma_f32_32x32x16_bf16 v[224:239], v[16:19], v[56:59], v[224:239]
  v_mul_f32 v196, s30, v196
  s_barrier
  ds_read_b64_tr_b16 v[12:13], v2 offset:16384
  ds_read_b64_tr_b16 v[14:15], v2 offset:16896
  s_waitcnt lgkmcnt(6)
  v_mfma_f32_32x32x16_bf16 v[240:255], v[20:23], v[56:59], v[240:255]
  v_mul_f32 v197, s30, v197
  ds_read_b64_tr_b16 v[16:17], v3 offset:16384
  ds_read_b64_tr_b16 v[18:19], v3 offset:16896
  s_waitcnt lgkmcnt(6)
  v_mfma_f32_32x32x16_bf16 v[224:239], v[24:27], v[60:63], v[224:239]
  v_mul_f32 v198, s30, v198
  ds_read_b64_tr_b16 v[20:21], v2 offset:18432
  ds_read_b64_tr_b16 v[22:23], v2 offset:18944
  s_waitcnt lgkmcnt(6)
  v_mfma_f32_32x32x16_bf16 v[240:255], v[8:11], v[60:63], v[240:255]
  ds_read_b64_tr_b16 v[24:25], v3 offset:18432
  ds_read_b64_tr_b16 v[26:27], v3 offset:18944
  s_waitcnt lgkmcnt(6)
  v_mfma_f32_32x32x16_bf16 v[224:239], v[12:15], v[64:67], v[224:239]
  v_mul_f32 v199, s30, v199
  ds_read_b64_tr_b16 v[8:9], v2 offset:20480
  ds_read_b64_tr_b16 v[10:11], v2 offset:20992
  s_waitcnt lgkmcnt(6)
  v_mfma_f32_32x32x16_bf16 v[240:255], v[16:19], v[64:67], v[240:255]
  v_cvt_pk_bf16_f32 v28, v192, v193
  ds_read_b64_tr_b16 v[12:13], v3 offset:20480
  ds_read_b64_tr_b16 v[14:15], v3 offset:20992
  s_waitcnt lgkmcnt(6)
  v_mfma_f32_32x32x16_bf16 v[224:239], v[20:23], v[68:71], v[224:239]
  v_cvt_pk_bf16_f32 v29, v194, v195
  ds_read_b64_tr_b16 v[16:17], v2 offset:22528
  ds_read_b64_tr_b16 v[18:19], v2 offset:23040
  s_waitcnt lgkmcnt(6)
  v_mfma_f32_32x32x16_bf16 v[240:255], v[24:27], v[68:71], v[240:255]
  v_cvt_pk_bf16_f32 v30, v196, v197
  ds_read_b64_tr_b16 v[20:21], v3 offset:22528
  ds_read_b64_tr_b16 v[22:23], v3 offset:23040
  s_waitcnt lgkmcnt(6)
  v_mfma_f32_32x32x16_bf16 v[224:239], v[8:11], v[72:75], v[224:239]
  v_cvt_pk_bf16_f32 v31, v198, v199
  ds_read_b64_tr_b16 v[24:25], v2 offset:24576
  ds_read_b64_tr_b16 v[26:27], v2 offset:25088
  s_waitcnt lgkmcnt(6)
  v_mfma_f32_32x32x16_bf16 v[240:255], v[12:15], v[72:75], v[240:255]
  s_add_u32 s93, s92, 0
  ds_read_b64_tr_b16 v[8:9], v3 offset:24576
  ds_read_b64_tr_b16 v[10:11], v3 offset:25088
  s_waitcnt lgkmcnt(6)
  v_mfma_f32_32x32x16_bf16 v[224:239], v[16:19], v[76:79], v[224:239]
  buffer_store_dwordx4 v[28:31], v5, s[12:15], s93 offen sc1
  ds_read_b64_tr_b16 v[12:13], v2 offset:26624
  ds_read_b64_tr_b16 v[14:15], v2 offset:27136
  s_waitcnt lgkmcnt(6)
  v_mfma_f32_32x32x16_bf16 v[240:255], v[20:23], v[76:79], v[240:255]
  ds_read_b64_tr_b16 v[16:17], v3 offset:26624
  ds_read_b64_tr_b16 v[18:19], v3 offset:27136
  s_waitcnt lgkmcnt(6)
  v_mfma_f32_32x32x16_bf16 v[224:239], v[24:27], v[80:83], v[224:239]
  ds_read_b64_tr_b16 v[20:21], v2 offset:28672
  ds_read_b64_tr_b16 v[22:23], v2 offset:29184
  s_waitcnt lgkmcnt(6)
  v_mfma_f32_32x32x16_bf16 v[240:255], v[8:11], v[80:83], v[240:255]
  ds_read_b64_tr_b16 v[24:25], v3 offset:28672
  ds_read_b64_tr_b16 v[26:27], v3 offset:29184
  s_waitcnt lgkmcnt(6)
  v_mfma_f32_32x32x16_bf16 v[224:239], v[12:15], v[84:87], v[224:239]
  v_mul_f32 v200, s30, v200
  ds_read_b64_tr_b16 v[8:9], v2 offset:30720
  ds_read_b64_tr_b16 v[10:11], v2 offset:31232
  s_waitcnt lgkmcnt(6)
  v_mfma_f32_32x32x16_bf16 v[240:255], v[16:19], v[84:87], v[240:255]
  v_mul_f32 v201, s30, v201
  ds_read_b64_tr_b16 v[12:13], v3 offset:30720
  ds_read_b64_tr_b16 v[14:15], v3 offset:31232
  s_waitcnt lgkmcnt(6)
  v_mfma_f32_32x32x16_bf16 v[224:239], v[20:23], v[88:91], v[224:239]
  v_mul_f32 v202, s30, v202
  s_barrier
  ds_read_b64_tr_b16 v[16:17], v2 offset:32768
  ds_read_b64_tr_b16 v[18:19], v2 offset:33280
  s_waitcnt lgkmcnt(6)
  v_mfma_f32_32x32x16_bf16 v[240:255], v[24:27], v[88:91], v[240:255]
  v_mul_f32 v203, s30, v203
  ds_read_b64_tr_b16 v[20:21], v3 offset:32768
  ds_read_b64_tr_b16 v[22:23], v3 offset:33280
  s_waitcnt lgkmcnt(6)
  v_mfma_f32_32x32x16_bf16 v[224:239], v[8:11], v[92:95], v[224:239]
  v_mul_f32 v204, s30, v204
  ds_read_b64_tr_b16 v[24:25], v2 offset:34816
  ds_read_b64_tr_b16 v[26:27], v2 offset:35328
  s_waitcnt lgkmcnt(6)
  v_mfma_f32_32x32x16_bf16 v[240:255], v[12:15], v[92:95], v[240:255]
  v_mul_f32 v205, s30, v205
  ds_read_b64_tr_b16 v[8:9], v3 offset:34816
  ds_read_b64_tr_b16 v[10:11], v3 offset:35328
  s_waitcnt lgkmcnt(6)
  v_mfma_f32_32x32x16_bf16 v[224:239], v[16:19], v[96:99], v[224:239]
  v_mul_f32 v206, s30, v206
  ds_read_b64_tr_b16 v[12:13], v2 offset:36864
  ds_read_b64_tr_b16 v[14:15], v2 offset:37376
  s_waitcnt lgkmcnt(6)
  v_mfma_f32_32x32x16_bf16 v[240:255], v[20:23], v[96:99], v[240:255]
  ds_read_b64_tr_b16 v[16:17], v3 offset:36864
  ds_read_b64_tr_b16 v[18:19], v3 offset:37376
  s_waitcnt lgkmcnt(6)
  v_mfma_f32_32x32x16_bf16 v[224:239], v[24:27], v[100:103], v[224:239]
  v_mul_f32 v207, s30, v207
  ds_read_b64_tr_b16 v[20:21], v2 offset:38912
  ds_read_b64_tr_b16 v[22:23], v2 offset:39424
  s_waitcnt lgkmcnt(6)
  v_mfma_f32_32x32x16_bf16 v[240:255], v[8:11], v[100:103], v[240:255]
  v_cvt_pk_bf16_f32 v28, v200, v201
  ds_read_b64_tr_b16 v[24:25], v3 offset:38912
  ds_read_b64_tr_b16 v[26:27], v3 offset:39424
  s_waitcnt lgkmcnt(6)
  v_mfma_f32_32x32x16_bf16 v[224:239], v[12:15], v[104:107], v[224:239]
  v_cvt_pk_bf16_f32 v29, v202, v203
  ds_read_b64_tr_b16 v[8:9], v2 offset:40960
  ds_read_b64_tr_b16 v[10:11], v2 offset:41472
  s_waitcnt lgkmcnt(6)
  v_mfma_f32_32x32x16_bf16 v[240:255], v[16:19], v[104:107], v[240:255]
  v_cvt_pk_bf16_f32 v30, v204, v205
  ds_read_b64_tr_b16 v[12:13], v3 offset:40960
  ds_read_b64_tr_b16 v[14:15], v3 offset:41472
  s_waitcnt lgkmcnt(6)
  v_mfma_f32_32x32x16_bf16 v[224:239], v[20:23], v[108:111], v[224:239]
  v_cvt_pk_bf16_f32 v31, v206, v207
  ds_read_b64_tr_b16 v[16:17], v2 offset:43008
  ds_read_b64_tr_b16 v[18:19], v2 offset:43520
  s_waitcnt lgkmcnt(6)
  v_mfma_f32_32x32x16_bf16 v[240:255], v[24:27], v[108:111], v[240:255]
  s_add_u32 s93, s92, 65536
  ds_read_b64_tr_b16 v[20:21], v3 offset:43008
  ds_read_b64_tr_b16 v[22:23], v3 offset:43520
  s_waitcnt lgkmcnt(6)
  v_mfma_f32_32x32x16_bf16 v[224:239], v[8:11], v[112:115], v[224:239]
  buffer_store_dwordx4 v[28:31], v5, s[12:15], s93 offen sc1
  ds_read_b64_tr_b16 v[24:25], v2 offset:45056
  ds_read_b64_tr_b16 v[26:27], v2 offset:45568
  s_waitcnt lgkmcnt(6)
  v_mfma_f32_32x32x16_bf16 v[240:255], v[12:15], v[112:115], v[240:255]
  ds_read_b64_tr_b16 v[8:9], v3 offset:45056
  ds_read_b64_tr_b16 v[10:11], v3 offset:45568
  s_waitcnt lgkmcnt(6)
  v_mfma_f32_32x32x16_bf16 v[224:239], v[16:19], v[116:119], v[224:239]
  ds_read_b64_tr_b16 v[12:13], v2 offset:47104
  ds_read_b64_tr_b16 v[14:15], v2 offset:47616
  s_waitcnt lgkmcnt(6)
  v_mfma_f32_32x32x16_bf16 v[240:255], v[20:23], v[116:119], v[240:255]
  ds_read_b64_tr_b16 v[16:17], v3 offset:47104
  ds_read_b64_tr_b16 v[18:19], v3 offset:47616
  s_waitcnt lgkmcnt(6)
  v_mfma_f32_32x32x16_bf16 v[224:239], v[24:27], v[120:123], v[224:239]
  v_mul_f32 v208, s30, v208
  s_barrier
  ds_read_b64_tr_b16 v[20:21], v2 offset:49152
  ds_read_b64_tr_b16 v[22:23], v2 offset:49664
  s_waitcnt lgkmcnt(6)
  v_mfma_f32_32x32x16_bf16 v[240:255], v[8:11], v[120:123], v[240:255]
  v_mul_f32 v209, s30, v209
  ds_read_b64_tr_b16 v[24:25], v3 offset:49152
  ds_read_b64_tr_b16 v[26:27], v3 offset:49664
  s_waitcnt lgkmcnt(6)
  v_mfma_f32_32x32x16_bf16 v[224:239], v[12:15], v[124:127], v[224:239]
  v_mul_f32 v210, s30, v210
  ds_read_b64_tr_b16 v[8:9], v2 offset:51200
  ds_read_b64_tr_b16 v[10:11], v2 offset:51712
  s_waitcnt lgkmcnt(6)
  v_mfma_f32_32x32x16_bf16 v[240:255], v[16:19], v[124:127], v[240:255]
  v_mul_f32 v211, s30, v211
  ds_read_b64_tr_b16 v[12:13], v3 offset:51200
  ds_read_b64_tr_b16 v[14:15], v3 offset:51712
  s_waitcnt lgkmcnt(6)
  v_mfma_f32_32x32x16_bf16 v[224:239], v[20:23], v[128:131], v[224:239]
  v_mul_f32 v212, s30, v212
  ds_read_b64_tr_b16 v[16:17], v2 offset:53248
  ds_read_b64_tr_b16 v[18:19], v2 offset:53760
  s_waitcnt lgkmcnt(6)
  v_mfma_f32_32x32x16_bf16 v[240:255], v[24:27], v[128:131], v[240:255]
  v_mul_f32 v213, s30, v213
  ds_read_b64_tr_b16 v[20:21], v3 offset:53248
  ds_read_b64_tr_b16 v[22:23], v3 offset:53760
  s_waitcnt lgkmcnt(6)
  v_mfma_f32_32x32x16_bf16 v[224:239], v[8:11], v[132:135], v[224:239]
  v_mul_f32 v214, s30, v214
  ds_read_b64_tr_b16 v[24:25], v2 offset:55296
  ds_read_b64_tr_b16 v[26:27], v2 offset:55808
  s_waitcnt lgkmcnt(6)
  v_mfma_f32_32x32x16_bf16 v[240:255], v[12:15], v[132:135], v[240:255]
  ds_read_b64_tr_b16 v[8:9], v3 offset:55296
  ds_read_b64_tr_b16 v[10:11], v3 offset:55808
  s_waitcnt lgkmcnt(6)
  v_mfma_f32_32x32x16_bf16 v[224:239], v[16:19], v[136:139], v[224:239]
  v_mul_f32 v215, s30, v215
  ds_read_b64_tr_b16 v[12:13], v2 offset:57344
  ds_read_b64_tr_b16 v[14:15], v2 offset:57856
  s_waitcnt lgkmcnt(6)
  v_mfma_f32_32x32x16_bf16 v[240:255], v[20:23], v[136:139], v[240:255]
  v_cvt_pk_bf16_f32 v28, v208, v209
  ds_read_b64_tr_b16 v[16:17], v3 offset:57344
  ds_read_b64_tr_b16 v[18:19], v3 offset:57856
  s_waitcnt lgkmcnt(6)
  v_mfma_f32_32x32x16_bf16 v[224:239], v[24:27], v[140:143], v[224:239]
  v_cvt_pk_bf16_f32 v29, v210, v211
  ds_read_b64_tr_b16 v[20:21], v2 offset:59392
  ds_read_b64_tr_b16 v[22:23], v2 offset:59904
  s_waitcnt lgkmcnt(6)
  v_mfma_f32_32x32x16_bf16 v[240:255], v[8:11], v[140:143], v[240:255]
  v_cvt_pk_bf16_f32 v30, v212, v213
  ds_read_b64_tr_b16 v[24:25], v3 offset:59392
  ds_read_b64_tr_b16 v[26:27], v3 offset:59904
  s_waitcnt lgkmcnt(6)
  v_mfma_f32_32x32x16_bf16 v[224:239], v[12:15], v[144:147], v[224:239]
  v_cvt_pk_bf16_f32 v31, v214, v215
  ds_read_b64_tr_b16 v[8:9], v2 offset:61440
  ds_read_b64_tr_b16 v[10:11], v2 offset:61952
  s_waitcnt lgkmcnt(6)
  v_mfma_f32_32x32x16_bf16 v[240:255], v[16:19], v[144:147], v[240:255]
  s_add_u32 s93, s92, 131072
  ds_read_b64_tr_b16 v[12:13], v3 offset:61440
  ds_read_b64_tr_b16 v[14:15], v3 offset:61952
  s_waitcnt lgkmcnt(6)
  v_mfma_f32_32x32x16_bf16 v[224:239], v[20:23], v[148:151], v[224:239]
  buffer_store_dwordx4 v[28:31], v5, s[12:15], s93 offen sc1
  ds_read_b64_tr_b16 v[16:17], v2 offset:63488
  ds_read_b64_tr_b16 v[18:19], v2 offset:64000
  s_waitcnt lgkmcnt(6)
  v_mfma_f32_32x32x16_bf16 v[240:255], v[24:27], v[148:151], v[240:255]
  ds_read_b64_tr_b16 v[20:21], v3 offset:63488
  ds_read_b64_tr_b16 v[22:23], v3 offset:64000
  s_waitcnt lgkmcnt(6)
  v_mfma_f32_32x32x16_bf16 v[224:239], v[8:11], v[152:155], v[224:239]
  s_barrier
  v_add_u32 v2, 0xffffc000, v2
  v_add_u32 v3, 0xffffc000, v3
  ds_read_b64_tr_b16 v[24:25], v2 offset:0
  ds_read_b64_tr_b16 v[26:27], v2 offset:512
  s_waitcnt lgkmcnt(6)
  v_mfma_f32_32x32x16_bf16 v[240:255], v[12:15], v[152:155], v[240:255]
  ds_read_b64_tr_b16 v[8:9], v3 offset:0
  ds_read_b64_tr_b16 v[10:11], v3 offset:512
  s_waitcnt lgkmcnt(6)
  v_mfma_f32_32x32x16_bf16 v[224:239], v[16:19], v[156:159], v[224:239]
  v_mul_f32 v216, s30, v216
  ds_read_b64_tr_b16 v[12:13], v2 offset:2048
  ds_read_b64_tr_b16 v[14:15], v2 offset:2560
  s_waitcnt lgkmcnt(6)
  v_mfma_f32_32x32x16_bf16 v[240:255], v[20:23], v[156:159], v[240:255]
  v_mul_f32 v217, s30, v217
  ds_read_b64_tr_b16 v[16:17], v3 offset:2048
  ds_read_b64_tr_b16 v[18:19], v3 offset:2560
  s_waitcnt lgkmcnt(6)
  v_mfma_f32_32x32x16_bf16 v[224:239], v[24:27], v[160:163], v[224:239]
  v_mul_f32 v218, s30, v218
  ds_read_b64_tr_b16 v[20:21], v2 offset:4096
  ds_read_b64_tr_b16 v[22:23], v2 offset:4608
  s_waitcnt lgkmcnt(6)
  v_mfma_f32_32x32x16_bf16 v[240:255], v[8:11], v[160:163], v[240:255]
  v_mul_f32 v219, s30, v219
  ds_read_b64_tr_b16 v[24:25], v3 offset:4096
  ds_read_b64_tr_b16 v[26:27], v3 offset:4608
  s_waitcnt lgkmcnt(6)
  v_mfma_f32_32x32x16_bf16 v[224:239], v[12:15], v[164:167], v[224:239]
  v_mul_f32 v220, s30, v220
  ds_read_b64_tr_b16 v[8:9], v2 offset:6144
  ds_read_b64_tr_b16 v[10:11], v2 offset:6656
  s_waitcnt lgkmcnt(6)
  v_mfma_f32_32x32x16_bf16 v[240:255], v[16:19], v[164:167], v[240:255]
  v_mul_f32 v221, s30, v221
  ds_read_b64_tr_b16 v[12:13], v3 offset:6144
  ds_read_b64_tr_b16 v[14:15], v3 offset:6656
  s_waitcnt lgkmcnt(6)
  v_mfma_f32_32x32x16_bf16 v[224:239], v[20:23], v[168:171], v[224:239]
  v_mul_f32 v222, s30, v222
  ds_read_b64_tr_b16 v[16:17], v2 offset:8192
  ds_read_b64_tr_b16 v[18:19], v2 offset:8704
  s_waitcnt lgkmcnt(6)
  v_mfma_f32_32x32x16_bf16 v[240:255], v[24:27], v[168:171], v[240:255]
  ds_read_b64_tr_b16 v[20:21], v3 offset:8192
  ds_read_b64_tr_b16 v[22:23], v3 offset:8704
  s_waitcnt lgkmcnt(6)
  v_mfma_f32_32x32x16_bf16 v[224:239], v[8:11], v[172:175], v[224:239]
  v_mul_f32 v223, s30, v223
  ds_read_b64_tr_b16 v[24:25], v2 offset:10240
  ds_read_b64_tr_b16 v[26:27], v2 offset:10752
  s_waitcnt lgkmcnt(6)
  v_mfma_f32_32x32x16_bf16 v[240:255], v[12:15], v[172:175], v[240:255]
  v_cvt_pk_bf16_f32 v28, v216, v217
  ds_read_b64_tr_b16 v[8:9], v3 offset:10240
  ds_read_b64_tr_b16 v[10:11], v3 offset:10752
  s_waitcnt lgkmcnt(6)
  v_mfma_f32_32x32x16_bf16 v[224:239], v[16:19], v[176:179], v[224:239]
  v_cvt_pk_bf16_f32 v29, v218, v219
  ds_read_b64_tr_b16 v[12:13], v2 offset:12288
  ds_read_b64_tr_b16 v[14:15], v2 offset:12800
  s_waitcnt lgkmcnt(6)
  v_mfma_f32_32x32x16_bf16 v[240:255], v[20:23], v[176:179], v[240:255]
  v_cvt_pk_bf16_f32 v30, v220, v221
  ds_read_b64_tr_b16 v[16:17], v3 offset:12288
  ds_read_b64_tr_b16 v[18:19], v3 offset:12800
  s_waitcnt lgkmcnt(6)
  v_mfma_f32_32x32x16_bf16 v[224:239], v[24:27], v[180:183], v[224:239]
  v_cvt_pk_bf16_f32 v31, v222, v223
  ds_read_b64_tr_b16 v[20:21], v2 offset:14336
  ds_read_b64_tr_b16 v[22:23], v2 offset:14848
  s_waitcnt lgkmcnt(6)
  v_mfma_f32_32x32x16_bf16 v[240:255], v[8:11], v[180:183], v[240:255]
  s_add_u32 s93, s92, 196608
  ds_read_b64_tr_b16 v[24:25], v3 offset:14336
  ds_read_b64_tr_b16 v[26:27], v3 offset:14848
  s_waitcnt lgkmcnt(6)
  v_mfma_f32_32x32x16_bf16 v[224:239], v[12:15], v[184:187], v[224:239]
  buffer_store_dwordx4 v[28:31], v5, s[12:15], s93 offen sc1
  s_barrier
  v_add_u32 v2, 0x4000, v2
  v_add_u32 v3, 0x4000, v3
  ds_read_b64_tr_b16 v[8:9], v2 offset:0
  ds_read_b64_tr_b16 v[10:11], v2 offset:512
  s_waitcnt lgkmcnt(6)
  v_mfma_f32_32x32x16_bf16 v[240:255], v[16:19], v[184:187], v[240:255]
  ds_read_b64_tr_b16 v[12:13], v3 offset:0
  ds_read_b64_tr_b16 v[14:15], v3 offset:512
  s_waitcnt lgkmcnt(6)
  v_mfma_f32_32x32x16_bf16 v[224:239], v[20:23], v[188:191], v[224:239]
  ds_read_b64_tr_b16 v[16:17], v2 offset:2048
  ds_read_b64_tr_b16 v[18:19], v2 offset:2560
  s_waitcnt lgkmcnt(6)
  v_mfma_f32_32x32x16_bf16 v[240:255], v[24:27], v[188:191], v[240:255]
  ds_read_b64_tr_b16 v[20:21], v3 offset:2048
  ds_read_b64_tr_b16 v[22:23], v3 offset:2560
  s_waitcnt lgkmcnt(6)
  v_mfma_f32_32x32x16_bf16 v[192:207], v[8:11], v[32:35], 0
  ds_read_b64_tr_b16 v[24:25], v2 offset:4096
  ds_read_b64_tr_b16 v[26:27], v2 offset:4608
  s_waitcnt lgkmcnt(6)
  v_mfma_f32_32x32x16_bf16 v[208:223], v[12:15], v[32:35], 0
  ds_read_b64_tr_b16 v[8:9], v3 offset:4096
  ds_read_b64_tr_b16 v[10:11], v3 offset:4608
  s_waitcnt lgkmcnt(6)
  v_mfma_f32_32x32x16_bf16 v[192:207], v[16:19], v[36:39], v[192:207]
  ds_read_b64_tr_b16 v[12:13], v2 offset:6144
  ds_read_b64_tr_b16 v[14:15], v2 offset:6656
  s_waitcnt lgkmcnt(6)
  v_mfma_f32_32x32x16_bf16 v[208:223], v[20:23], v[36:39], v[208:223]
  ds_read_b64_tr_b16 v[16:17], v3 offset:6144
  ds_read_b64_tr_b16 v[18:19], v3 offset:6656
  s_waitcnt lgkmcnt(6)
  v_mfma_f32_32x32x16_bf16 v[192:207], v[24:27], v[40:43], v[192:207]
  ds_read_b64_tr_b16 v[20:21], v2 offset:8192
  ds_read_b64_tr_b16 v[22:23], v2 offset:8704
  s_waitcnt lgkmcnt(6)
  v_mfma_f32_32x32x16_bf16 v[208:223], v[8:11], v[40:43], v[208:223]
  ds_read_b64_tr_b16 v[24:25], v3 offset:8192
  ds_read_b64_tr_b16 v[26:27], v3 offset:8704
  s_waitcnt lgkmcnt(6)
  v_mfma_f32_32x32x16_bf16 v[192:207], v[12:15], v[44:47], v[192:207]
  v_mov_b32 v7, 0
  buffer_load_dword v6, v7, s[48:51], 0 offen sc1
  ds_read_b64_tr_b16 v[8:9], v2 offset:10240
  ds_read_b64_tr_b16 v[10:11], v2 offset:10752
  s_waitcnt lgkmcnt(6)
  v_mfma_f32_32x32x16_bf16 v[208:223], v[16:19], v[44:47], v[208:223]
  ds_read_b64_tr_b16 v[12:13], v3 offset:10240
  ds_read_b64_tr_b16 v[14:15], v3 offset:10752
  s_waitcnt lgkmcnt(6)
  v_mfma_f32_32x32x16_bf16 v[192:207], v[20:23], v[48:51], v[192:207]
  v_mul_f32 v224, s30, v224
  ds_read_b64_tr_b16 v[16:17], v2 offset:12288
  ds_read_b64_tr_b16 v[18:19], v2 offset:12800
  s_waitcnt lgkmcnt(6)
  v_mfma_f32_32x32x16_bf16 v[208:223], v[24:27], v[48:51], v[208:223]
  v_mul_f32 v225, s30, v225
  ds_read_b64_tr_b16 v[20:21], v3 offset:12288
  ds_read_b64_tr_b16 v[22:23], v3 offset:12800
  s_waitcnt lgkmcnt(6)
  v_mfma_f32_32x32x16_bf16 v[192:207], v[8:11], v[52:55], v[192:207]
  v_mul_f32 v226, s30, v226
  ds_read_b64_tr_b16 v[24:25], v2 offset:14336
  ds_read_b64_tr_b16 v[26:27], v2 offset:14848
  s_waitcnt lgkmcnt(6)
  v_mfma_f32_32x32x16_bf16 v[208:223], v[12:15], v[52:55], v[208:223]
  v_mul_f32 v227, s30, v227
  ds_read_b64_tr_b16 v[8:9], v3 offset:14336
  ds_read_b64_tr_b16 v[10:11], v3 offset:14848
  s_waitcnt lgkmcnt(6)
  v_mfma_f32_32x32x16_bf16 v[192:207], v[16:19], v[56:59], v[192:207]
  v_mul_f32 v228, s30, v228
  s_barrier
  ds_read_b64_tr_b16 v[12:13], v2 offset:16384
  ds_read_b64_tr_b16 v[14:15], v2 offset:16896
  s_waitcnt lgkmcnt(6)
  v_mfma_f32_32x32x16_bf16 v[208:223], v[20:23], v[56:59], v[208:223]
  v_mul_f32 v229, s30, v229
  ds_read_b64_tr_b16 v[16:17], v3 offset:16384
  ds_read_b64_tr_b16 v[18:19], v3 offset:16896
  s_waitcnt lgkmcnt(6)
  v_mfma_f32_32x32x16_bf16 v[192:207], v[24:27], v[60:63], v[192:207]
  v_mul_f32 v230, s30, v230
  ds_read_b64_tr_b16 v[20:21], v2 offset:18432
  ds_read_b64_tr_b16 v[22:23], v2 offset:18944
  s_waitcnt lgkmcnt(6)
  v_mfma_f32_32x32x16_bf16 v[208:223], v[8:11], v[60:63], v[208:223]
  v_mul_f32 v231, s30, v231
  ds_read_b64_tr_b16 v[24:25], v3 offset:18432
  ds_read_b64_tr_b16 v[26:27], v3 offset:18944
  s_waitcnt lgkmcnt(6)
  v_mfma_f32_32x32x16_bf16 v[192:207], v[12:15], v[64:67], v[192:207]
  v_cvt_pk_bf16_f32 v28, v224, v225
  ds_read_b64_tr_b16 v[8:9], v2 offset:20480
  ds_read_b64_tr_b16 v[10:11], v2 offset:20992
  s_waitcnt lgkmcnt(6)
  v_mfma_f32_32x32x16_bf16 v[208:223], v[16:19], v[64:67], v[208:223]
  v_cvt_pk_bf16_f32 v29, v226, v227
  ds_read_b64_tr_b16 v[12:13], v3 offset:20480
  ds_read_b64_tr_b16 v[14:15], v3 offset:20992
  s_waitcnt lgkmcnt(6)
  v_mfma_f32_32x32x16_bf16 v[192:207], v[20:23], v[68:71], v[192:207]
  v_cvt_pk_bf16_f32 v30, v228, v229
  ds_read_b64_tr_b16 v[16:17], v2 offset:22528
  ds_read_b64_tr_b16 v[18:19], v2 offset:23040
  s_waitcnt lgkmcnt(6)
  v_mfma_f32_32x32x16_bf16 v[208:223], v[24:27], v[68:71], v[208:223]
  v_cvt_pk_bf16_f32 v31, v230, v231
  ds_read_b64_tr_b16 v[20:21], v3 offset:22528
  ds_read_b64_tr_b16 v[22:23], v3 offset:23040
  s_waitcnt lgkmcnt(6)
  v_mfma_f32_32x32x16_bf16 v[192:207], v[8:11], v[72:75], v[192:207]
  s_add_u32 s93, s92, 262144
  ds_read_b64_tr_b16 v[24:25], v2 offset:24576
  ds_read_b64_tr_b16 v[26:27], v2 offset:25088
  s_waitcnt lgkmcnt(6)
  v_mfma_f32_32x32x16_bf16 v[208:223], v[12:15], v[72:75], v[208:223]
  buffer_store_dwordx4 v[28:31], v5, s[12:15], s93 offen sc1
  ds_read_b64_tr_b16 v[8:9], v3 offset:24576
  ds_read_b64_tr_b16 v[10:11], v3 offset:25088
  s_waitcnt lgkmcnt(6)
  v_mfma_f32_32x32x16_bf16 v[192:207], v[16:19], v[76:79], v[192:207]
  v_mul_f32 v232, s30, v232
  ds_read_b64_tr_b16 v[12:13], v2 offset:26624
  ds_read_b64_tr_b16 v[14:15], v2 offset:27136
  s_waitcnt lgkmcnt(6)
  v_mfma_f32_32x32x16_bf16 v[208:223], v[20:23], v[76:79], v[208:223]
  v_mul_f32 v233, s30, v233
  ds_read_b64_tr_b16 v[16:17], v3 offset:26624
  ds_read_b64_tr_b16 v[18:19], v3 offset:27136
  s_waitcnt lgkmcnt(6)
  v_mfma_f32_32x32x16_bf16 v[192:207], v[24:27], v[80:83], v[192:207]
  v_mul_f32 v234, s30, v234
  ds_read_b64_tr_b16 v[20:21], v2 offset:28672
  ds_read_b64_tr_b16 v[22:23], v2 offset:29184
  s_waitcnt lgkmcnt(6)
  v_mfma_f32_32x32x16_bf16 v[208:223], v[8:11], v[80:83], v[208:223]
  v_mul_f32 v235, s30, v235
  ds_read_b64_tr_b16 v[24:25], v3 offset:28672
  ds_read_b64_tr_b16 v[26:27], v3 offset:29184
  s_waitcnt lgkmcnt(6)
  v_mfma_f32_32x32x16_bf16 v[192:207], v[12:15], v[84:87], v[192:207]
  v_mul_f32 v236, s30, v236
  ds_read_b64_tr_b16 v[8:9], v2 offset:30720
  ds_read_b64_tr_b16 v[10:11], v2 offset:31232
  s_waitcnt lgkmcnt(6)
  v_mfma_f32_32x32x16_bf16 v[208:223], v[16:19], v[84:87], v[208:223]
  v_mul_f32 v237, s30, v237
  ds_read_b64_tr_b16 v[12:13], v3 offset:30720
  ds_read_b64_tr_b16 v[14:15], v3 offset:31232
  s_waitcnt lgkmcnt(6)
  v_mfma_f32_32x32x16_bf16 v[192:207], v[20:23], v[88:91], v[192:207]
  v_mul_f32 v238, s30, v238
  s_barrier
  ds_read_b64_tr_b16 v[16:17], v2 offset:32768
  ds_read_b64_tr_b16 v[18:19], v2 offset:33280
  s_waitcnt lgkmcnt(6)
  v_mfma_f32_32x32x16_bf16 v[208:223], v[24:27], v[88:91], v[208:223]
  v_mul_f32 v239, s30, v239
  ds_read_b64_tr_b16 v[20:21], v3 offset:32768
  ds_read_b64_tr_b16 v[22:23], v3 offset:33280
  s_waitcnt lgkmcnt(6)
  v_mfma_f32_32x32x16_bf16 v[192:207], v[8:11], v[92:95], v[192:207]
  v_cvt_pk_bf16_f32 v28, v232, v233
  ds_read_b64_tr_b16 v[24:25], v2 offset:34816
  ds_read_b64_tr_b16 v[26:27], v2 offset:35328
  s_waitcnt lgkmcnt(6)
  v_mfma_f32_32x32x16_bf16 v[208:223], v[12:15], v[92:95], v[208:223]
  v_cvt_pk_bf16_f32 v29, v234, v235
  ds_read_b64_tr_b16 v[8:9], v3 offset:34816
  ds_read_b64_tr_b16 v[10:11], v3 offset:35328
  s_waitcnt lgkmcnt(6)
  v_mfma_f32_32x32x16_bf16 v[192:207], v[16:19], v[96:99], v[192:207]
  v_cvt_pk_bf16_f32 v30, v236, v237
  ds_read_b64_tr_b16 v[12:13], v2 offset:36864
  ds_read_b64_tr_b16 v[14:15], v2 offset:37376
  s_waitcnt lgkmcnt(6)
  v_mfma_f32_32x32x16_bf16 v[208:223], v[20:23], v[96:99], v[208:223]
  v_cvt_pk_bf16_f32 v31, v238, v239
  ds_read_b64_tr_b16 v[16:17], v3 offset:36864
  ds_read_b64_tr_b16 v[18:19], v3 offset:37376
  s_waitcnt lgkmcnt(6)
  v_mfma_f32_32x32x16_bf16 v[192:207], v[24:27], v[100:103], v[192:207]
  s_add_u32 s93, s92, 327680
  ds_read_b64_tr_b16 v[20:21], v2 offset:38912
  ds_read_b64_tr_b16 v[22:23], v2 offset:39424
  s_waitcnt lgkmcnt(6)
  v_mfma_f32_32x32x16_bf16 v[208:223], v[8:11], v[100:103], v[208:223]
  buffer_store_dwordx4 v[28:31], v5, s[12:15], s93 offen sc1
  ds_read_b64_tr_b16 v[24:25], v3 offset:38912
  ds_read_b64_tr_b16 v[26:27], v3 offset:39424
  s_waitcnt lgkmcnt(6)
  v_mfma_f32_32x32x16_bf16 v[192:207], v[12:15], v[104:107], v[192:207]
  v_mul_f32 v240, s30, v240
  ds_read_b64_tr_b16 v[8:9], v2 offset:40960
  ds_read_b64_tr_b16 v[10:11], v2 offset:41472
  s_waitcnt lgkmcnt(6)
  v_mfma_f32_32x32x16_bf16 v[208:223], v[16:19], v[104:107], v[208:223]
  v_mul_f32 v241, s30, v241
  ds_read_b64_tr_b16 v[12:13], v3 offset:40960
  ds_read_b64_tr_b16 v[14:15], v3 offset:41472
  s_waitcnt lgkmcnt(6)
  v_mfma_f32_32x32x16_bf16 v[192:207], v[20:23], v[108:111], v[192:207]
  v_mul_f32 v242, s30, v242
  ds_read_b64_tr_b16 v[16:17], v2 offset:43008
  ds_read_b64_tr_b16 v[18:19], v2 offset:43520
  s_waitcnt lgkmcnt(6)
  v_mfma_f32_32x32x16_bf16 v[208:223], v[24:27], v[108:111], v[208:223]
  v_mul_f32 v243, s30, v243
  ds_read_b64_tr_b16 v[20:21], v3 offset:43008
  ds_read_b64_tr_b16 v[22:23], v3 offset:43520
  s_waitcnt lgkmcnt(6)
  v_mfma_f32_32x32x16_bf16 v[192:207], v[8:11], v[112:115], v[192:207]
  v_mul_f32 v244, s30, v244
  ds_read_b64_tr_b16 v[24:25], v2 offset:45056
  ds_read_b64_tr_b16 v[26:27], v2 offset:45568
  s_waitcnt lgkmcnt(6)
  v_mfma_f32_32x32x16_bf16 v[208:223], v[12:15], v[112:115], v[208:223]
  v_mul_f32 v245, s30, v245
  ds_read_b64_tr_b16 v[8:9], v3 offset:45056
  ds_read_b64_tr_b16 v[10:11], v3 offset:45568
  s_waitcnt lgkmcnt(6)
  v_mfma_f32_32x32x16_bf16 v[192:207], v[16:19], v[116:119], v[192:207]
  v_mul_f32 v246, s30, v246
  ds_read_b64_tr_b16 v[12:13], v2 offset:47104
  ds_read_b64_tr_b16 v[14:15], v2 offset:47616
  s_waitcnt lgkmcnt(6)
  v_mfma_f32_32x32x16_bf16 v[208:223], v[20:23], v[116:119], v[208:223]
  v_mul_f32 v247, s30, v247
  ds_read_b64_tr_b16 v[16:17], v3 offset:47104
  ds_read_b64_tr_b16 v[18:19], v3 offset:47616
  s_waitcnt lgkmcnt(6)
  v_mfma_f32_32x32x16_bf16 v[192:207], v[24:27], v[120:123], v[192:207]
  v_cvt_pk_bf16_f32 v28, v240, v241
  s_barrier
  ds_read_b64_tr_b16 v[20:21], v2 offset:49152
  ds_read_b64_tr_b16 v[22:23], v2 offset:49664
  s_waitcnt lgkmcnt(6)
  v_mfma_f32_32x32x16_bf16 v[208:223], v[8:11], v[120:123], v[208:223]
  v_cvt_pk_bf16_f32 v29, v242, v243
  ds_read_b64_tr_b16 v[24:25], v3 offset:49152
  ds_read_b64_tr_b16 v[26:27], v3 offset:49664
  s_waitcnt lgkmcnt(6)
  v_mfma_f32_32x32x16_bf16 v[192:207], v[12:15], v[124:127], v[192:207]
  v_cvt_pk_bf16_f32 v30, v244, v245
  ds_read_b64_tr_b16 v[8:9], v2 offset:51200
  ds_read_b64_tr_b16 v[10:11], v2 offset:51712
  s_waitcnt lgkmcnt(6)
  v_mfma_f32_32x32x16_bf16 v[208:223], v[16:19], v[124:127], v[208:223]
  v_cvt_pk_bf16_f32 v31, v246, v247
  ds_read_b64_tr_b16 v[12:13], v3 offset:51200
  ds_read_b64_tr_b16 v[14:15], v3 offset:51712
  s_waitcnt lgkmcnt(6)
  v_mfma_f32_32x32x16_bf16 v[192:207], v[20:23], v[128:131], v[192:207]
  s_add_u32 s93, s92, 393216
  ds_read_b64_tr_b16 v[16:17], v2 offset:53248
  ds_read_b64_tr_b16 v[18:19], v2 offset:53760
  s_waitcnt lgkmcnt(6)
  v_mfma_f32_32x32x16_bf16 v[208:223], v[24:27], v[128:131], v[208:223]
  buffer_store_dwordx4 v[28:31], v5, s[12:15], s93 offen sc1
  ds_read_b64_tr_b16 v[20:21], v3 offset:53248
  ds_read_b64_tr_b16 v[22:23], v3 offset:53760
  s_waitcnt lgkmcnt(6)
  v_mfma_f32_32x32x16_bf16 v[192:207], v[8:11], v[132:135], v[192:207]
  v_mul_f32 v248, s30, v248
  ds_read_b64_tr_b16 v[24:25], v2 offset:55296
  ds_read_b64_tr_b16 v[26:27], v2 offset:55808
  s_waitcnt lgkmcnt(6)
  v_mfma_f32_32x32x16_bf16 v[208:223], v[12:15], v[132:135], v[208:223]
  v_mul_f32 v249, s30, v249
  ds_read_b64_tr_b16 v[8:9], v3 offset:55296
  ds_read_b64_tr_b16 v[10:11], v3 offset:55808
  s_waitcnt lgkmcnt(6)
  v_mfma_f32_32x32x16_bf16 v[192:207], v[16:19], v[136:139], v[192:207]
  v_mul_f32 v250, s30, v250
  ds_read_b64_tr_b16 v[12:13], v2 offset:57344
  ds_read_b64_tr_b16 v[14:15], v2 offset:57856
  s_waitcnt lgkmcnt(6)
  v_mfma_f32_32x32x16_bf16 v[208:223], v[20:23], v[136:139], v[208:223]
  v_mul_f32 v251, s30, v251
  ds_read_b64_tr_b16 v[16:17], v3 offset:57344
  ds_read_b64_tr_b16 v[18:19], v3 offset:57856
  s_waitcnt lgkmcnt(6)
  v_mfma_f32_32x32x16_bf16 v[192:207], v[24:27], v[140:143], v[192:207]
  v_mul_f32 v252, s30, v252
  ds_read_b64_tr_b16 v[20:21], v2 offset:59392
  ds_read_b64_tr_b16 v[22:23], v2 offset:59904
  s_waitcnt lgkmcnt(6)
  v_mfma_f32_32x32x16_bf16 v[208:223], v[8:11], v[140:143], v[208:223]
  v_mul_f32 v253, s30, v253
  ds_read_b64_tr_b16 v[24:25], v3 offset:59392
  ds_read_b64_tr_b16 v[26:27], v3 offset:59904
  s_waitcnt lgkmcnt(6)
  v_mfma_f32_32x32x16_bf16 v[192:207], v[12:15], v[144:147], v[192:207]
  v_mul_f32 v254, s30, v254
  ds_read_b64_tr_b16 v[8:9], v2 offset:61440
  ds_read_b64_tr_b16 v[10:11], v2 offset:61952
  s_waitcnt lgkmcnt(6)
  v_mfma_f32_32x32x16_bf16 v[208:223], v[16:19], v[144:147], v[208:223]
  v_mul_f32 v255, s30, v255
  ds_read_b64_tr_b16 v[12:13], v3 offset:61440
  ds_read_b64_tr_b16 v[14:15], v3 offset:61952
  s_waitcnt lgkmcnt(6)
  v_mfma_f32_32x32x16_bf16 v[192:207], v[20:23], v[148:151], v[192:207]
  v_cvt_pk_bf16_f32 v28, v248, v249
  ds_read_b64_tr_b16 v[16:17], v2 offset:63488
  ds_read_b64_tr_b16 v[18:19], v2 offset:64000
  s_waitcnt lgkmcnt(6)
  v_mfma_f32_32x32x16_bf16 v[208:223], v[24:27], v[148:151], v[208:223]
  v_cvt_pk_bf16_f32 v29, v250, v251
  ds_read_b64_tr_b16 v[20:21], v3 offset:63488
  ds_read_b64_tr_b16 v[22:23], v3 offset:64000
  s_waitcnt lgkmcnt(6)
  v_mfma_f32_32x32x16_bf16 v[192:207], v[8:11], v[152:155], v[192:207]
  v_cvt_pk_bf16_f32 v30, v252, v253
  s_barrier
  v_add_u32 v2, 0xffffc000, v2
  v_add_u32 v3, 0xffffc000, v3
  ds_read_b64_tr_b16 v[24:25], v2 offset:0
  ds_read_b64_tr_b16 v[26:27], v2 offset:512
  s_waitcnt lgkmcnt(6)
  v_mfma_f32_32x32x16_bf16 v[208:223], v[12:15], v[152:155], v[208:223]
  v_cvt_pk_bf16_f32 v31, v254, v255
  ds_read_b64_tr_b16 v[8:9], v3 offset:0
  ds_read_b64_tr_b16 v[10:11], v3 offset:512
  s_waitcnt lgkmcnt(6)
  v_mfma_f32_32x32x16_bf16 v[192:207], v[16:19], v[156:159], v[192:207]
  s_add_u32 s93, s92, 458752
  ds_read_b64_tr_b16 v[12:13], v2 offset:2048
  ds_read_b64_tr_b16 v[14:15], v2 offset:2560
  s_waitcnt lgkmcnt(6)
  v_mfma_f32_32x32x16_bf16 v[208:223], v[20:23], v[156:159], v[208:223]
  buffer_store_dwordx4 v[28:31], v5, s[12:15], s93 offen sc1
  ds_read_b64_tr_b16 v[16:17], v3 offset:2048
  ds_read_b64_tr_b16 v[18:19], v3 offset:2560
  s_waitcnt lgkmcnt(6)
  v_mfma_f32_32x32x16_bf16 v[192:207], v[24:27], v[160:163], v[192:207]
  ds_read_b64_tr_b16 v[20:21], v2 offset:4096
  ds_read_b64_tr_b16 v[22:23], v2 offset:4608
  s_waitcnt lgkmcnt(6)
  v_mfma_f32_32x32x16_bf16 v[208:223], v[8:11], v[160:163], v[208:223]
  ds_read_b64_tr_b16 v[24:25], v3 offset:4096
  ds_read_b64_tr_b16 v[26:27], v3 offset:4608
  s_waitcnt lgkmcnt(6)
  v_mfma_f32_32x32x16_bf16 v[192:207], v[12:15], v[164:167], v[192:207]
  ds_read_b64_tr_b16 v[8:9], v2 offset:6144
  ds_read_b64_tr_b16 v[10:11], v2 offset:6656
  s_waitcnt lgkmcnt(6)
  v_mfma_f32_32x32x16_bf16 v[208:223], v[16:19], v[164:167], v[208:223]
  ds_read_b64_tr_b16 v[12:13], v3 offset:6144
  ds_read_b64_tr_b16 v[14:15], v3 offset:6656
  s_waitcnt lgkmcnt(6)
  v_mfma_f32_32x32x16_bf16 v[192:207], v[20:23], v[168:171], v[192:207]
  ds_read_b64_tr_b16 v[16:17], v2 offset:8192
  ds_read_b64_tr_b16 v[18:19], v2 offset:8704
  s_waitcnt lgkmcnt(6)
  v_mfma_f32_32x32x16_bf16 v[208:223], v[24:27], v[168:171], v[208:223]
  ds_read_b64_tr_b16 v[20:21], v3 offset:8192
  ds_read_b64_tr_b16 v[22:23], v3 offset:8704
  s_waitcnt lgkmcnt(6)
  v_mfma_f32_32x32x16_bf16 v[192:207], v[8:11], v[172:175], v[192:207]
  ds_read_b64_tr_b16 v[24:25], v2 offset:10240
  ds_read_b64_tr_b16 v[26:27], v2 offset:10752
  s_waitcnt lgkmcnt(6)
  v_mfma_f32_32x32x16_bf16 v[208:223], v[12:15], v[172:175], v[208:223]
  ds_read_b64_tr_b16 v[8:9], v3 offset:10240
  ds_read_b64_tr_b16 v[10:11], v3 offset:10752
  s_waitcnt lgkmcnt(6)
  v_mfma_f32_32x32x16_bf16 v[192:207], v[16:19], v[176:179], v[192:207]
  ds_read_b64_tr_b16 v[12:13], v2 offset:12288
  ds_read_b64_tr_b16 v[14:15], v2 offset:12800
  s_waitcnt lgkmcnt(6)
  v_mfma_f32_32x32x16_bf16 v[208:223], v[20:23], v[176:179], v[208:223]
  ds_read_b64_tr_b16 v[16:17], v3 offset:12288
  ds_read_b64_tr_b16 v[18:19], v3 offset:12800
  s_waitcnt lgkmcnt(6)
  v_mfma_f32_32x32x16_bf16 v[192:207], v[24:27], v[180:183], v[192:207]
  ds_read_b64_tr_b16 v[20:21], v2 offset:14336
  ds_read_b64_tr_b16 v[22:23], v2 offset:14848
  s_waitcnt lgkmcnt(6)
  v_mfma_f32_32x32x16_bf16 v[208:223], v[8:11], v[180:183], v[208:223]
  ds_read_b64_tr_b16 v[24:25], v3 offset:14336
  ds_read_b64_tr_b16 v[26:27], v3 offset:14848
  s_waitcnt lgkmcnt(6)
  v_mfma_f32_32x32x16_bf16 v[192:207], v[12:15], v[184:187], v[192:207]
  s_barrier
  v_add_u32 v2, 0x4000, v2
  v_add_u32 v3, 0x4000, v3
  ds_read_b64_tr_b16 v[8:9], v2 offset:0
  ds_read_b64_tr_b16 v[10:11], v2 offset:512
  s_waitcnt lgkmcnt(6)
  v_mfma_f32_32x32x16_bf16 v[208:223], v[16:19], v[184:187], v[208:223]
  ds_read_b64_tr_b16 v[12:13], v3 offset:0
  ds_read_b64_tr_b16 v[14:15], v3 offset:512
  s_waitcnt lgkmcnt(6)
  v_mfma_f32_32x32x16_bf16 v[192:207], v[20:23], v[188:191], v[192:207]
  ds_read_b64_tr_b16 v[16:17], v2 offset:2048
  ds_read_b64_tr_b16 v[18:19], v2 offset:2560
  s_waitcnt lgkmcnt(6)
  v_mfma_f32_32x32x16_bf16 v[208:223], v[24:27], v[188:191], v[208:223]
  ds_read_b64_tr_b16 v[20:21], v3 offset:2048
  ds_read_b64_tr_b16 v[22:23], v3 offset:2560
  s_waitcnt lgkmcnt(6)
  v_mfma_f32_32x32x16_bf16 v[224:239], v[8:11], v[32:35], 0
  ds_read_b64_tr_b16 v[24:25], v2 offset:4096
  ds_read_b64_tr_b16 v[26:27], v2 offset:4608
  s_waitcnt lgkmcnt(6)
  v_mfma_f32_32x32x16_bf16 v[240:255], v[12:15], v[32:35], 0
  ds_read_b64_tr_b16 v[8:9], v3 offset:4096
  ds_read_b64_tr_b16 v[10:11], v3 offset:4608
  s_waitcnt lgkmcnt(6)
  v_mfma_f32_32x32x16_bf16 v[224:239], v[16:19], v[36:39], v[224:239]
  ds_read_b64_tr_b16 v[12:13], v2 offset:6144
  ds_read_b64_tr_b16 v[14:15], v2 offset:6656
  s_waitcnt lgkmcnt(6)
  v_mfma_f32_32x32x16_bf16 v[240:255], v[20:23], v[36:39], v[240:255]
  ds_read_b64_tr_b16 v[16:17], v3 offset:6144
  ds_read_b64_tr_b16 v[18:19], v3 offset:6656
  s_waitcnt lgkmcnt(6)
  v_mfma_f32_32x32x16_bf16 v[224:239], v[24:27], v[40:43], v[224:239]
  ds_read_b64_tr_b16 v[20:21], v2 offset:8192
  ds_read_b64_tr_b16 v[22:23], v2 offset:8704
  s_waitcnt lgkmcnt(6)
  v_mfma_f32_32x32x16_bf16 v[240:255], v[8:11], v[40:43], v[240:255]
  ds_read_b64_tr_b16 v[24:25], v3 offset:8192
  ds_read_b64_tr_b16 v[26:27], v3 offset:8704
  s_waitcnt lgkmcnt(6)
  v_mfma_f32_32x32x16_bf16 v[224:239], v[12:15], v[44:47], v[224:239]
  ds_read_b64_tr_b16 v[8:9], v2 offset:10240
  ds_read_b64_tr_b16 v[10:11], v2 offset:10752
  s_waitcnt lgkmcnt(6)
  v_mfma_f32_32x32x16_bf16 v[240:255], v[16:19], v[44:47], v[240:255]
  ds_read_b64_tr_b16 v[12:13], v3 offset:10240
  ds_read_b64_tr_b16 v[14:15], v3 offset:10752
  s_waitcnt lgkmcnt(6)
  v_mfma_f32_32x32x16_bf16 v[224:239], v[20:23], v[48:51], v[224:239]
  ds_read_b64_tr_b16 v[16:17], v2 offset:12288
  ds_read_b64_tr_b16 v[18:19], v2 offset:12800
  s_waitcnt lgkmcnt(6)
  v_mfma_f32_32x32x16_bf16 v[240:255], v[24:27], v[48:51], v[240:255]
  ds_read_b64_tr_b16 v[20:21], v3 offset:12288
  ds_read_b64_tr_b16 v[22:23], v3 offset:12800
  s_waitcnt lgkmcnt(6)
  v_mfma_f32_32x32x16_bf16 v[224:239], v[8:11], v[52:55], v[224:239]
  ds_read_b64_tr_b16 v[24:25], v2 offset:14336
  ds_read_b64_tr_b16 v[26:27], v2 offset:14848
  s_waitcnt lgkmcnt(6)
  v_mfma_f32_32x32x16_bf16 v[240:255], v[12:15], v[52:55], v[240:255]
  ds_read_b64_tr_b16 v[8:9], v3 offset:14336
  ds_read_b64_tr_b16 v[10:11], v3 offset:14848
  s_waitcnt lgkmcnt(6)
  v_mfma_f32_32x32x16_bf16 v[224:239], v[16:19], v[56:59], v[224:239]
  s_waitcnt vmcnt(0)
  s_barrier
  s_cmp_eq_u32 s3, 0
  s_cbranch_scc0 L_sa_6
  s_mov_b32 s43, 0
L_rdyt_7:
  v_cmp_eq_u32 vcc, 0, v6
  s_nop 0
  s_cmp_eq_u64 vcc, 0
  s_cbranch_scc1 L_rdyd_8
  s_add_u32 s43, s43, 1
  s_cmp_ge_u32 s43, 200000
  s_cbranch_scc1 L_rdyd_8
  s_sleep 2
  buffer_load_dword v6, v7, s[48:51], 0 offen sc1
  s_waitcnt vmcnt(0)
  s_branch L_rdyt_7
L_rdyd_8:
  s_lshl_b32 s42, s56, 7
  s_lshl_b32 s28, s57, 2
  s_add_u32 s42, s42, s28
  s_add_u32 s42, s42, 0
  v_mov_b32 v6, 1
  s_mov_b64 exec, 1
  buffer_store_dword v6, v7, s[44:47], s42 offen sc1
  s_mov_b64 exec, -1
L_sa_6:
  ds_read_b64_tr_b16 v[12:13], v2 offset:16384
  ds_read_b64_tr_b16 v[14:15], v2 offset:16896
  s_waitcnt lgkmcnt(6)
  v_mfma_f32_32x32x16_bf16 v[240:255], v[20:23], v[56:59], v[240:255]
  ds_read_b64_tr_b16 v[16:17], v3 offset:16384
  ds_read_b64_tr_b16 v[18:19], v3 offset:16896
  s_waitcnt lgkmcnt(6)
  v_mfma_f32_32x32x16_bf16 v[224:239], v[24:27], v[60:63], v[224:239]
  ds_read_b64_tr_b16 v[20:21], v2 offset:18432
  ds_read_b64_tr_b16 v[22:23], v2 offset:18944
  s_waitcnt lgkmcnt(6)
  v_mfma_f32_32x32x16_bf16 v[240:255], v[8:11], v[60:63], v[240:255]
  ds_read_b64_tr_b16 v[24:25], v3 offset:18432
  ds_read_b64_tr_b16 v[26:27], v3 offset:18944
  s_waitcnt lgkmcnt(6)
  v_mfma_f32_32x32x16_bf16 v[224:239], v[12:15], v[64:67], v[224:239]
  ds_read_b64_tr_b16 v[8:9], v2 offset:20480
  ds_read_b64_tr_b16 v[10:11], v2 offset:20992
  s_waitcnt lgkmcnt(6)
  v_mfma_f32_32x32x16_bf16 v[240:255], v[16:19], v[64:67], v[240:255]
  ds_read_b64_tr_b16 v[12:13], v3 offset:20480
  ds_read_b64_tr_b16 v[14:15], v3 offset:20992
  s_waitcnt lgkmcnt(6)
  v_mfma_f32_32x32x16_bf16 v[224:239], v[20:23], v[68:71], v[224:239]
  ds_read_b64_tr_b16 v[16:17], v2 offset:22528
  ds_read_b64_tr_b16 v[18:19], v2 offset:23040
  s_waitcnt lgkmcnt(6)
  v_mfma_f32_32x32x16_bf16 v[240:255], v[24:27], v[68:71], v[240:255]
  ds_read_b64_tr_b16 v[20:21], v3 offset:22528
  ds_read_b64_tr_b16 v[22:23], v3 offset:23040
  s_waitcnt lgkmcnt(6)
  v_mfma_f32_32x32x16_bf16 v[224:239], v[8:11], v[72:75], v[224:239]
  ds_read_b64_tr_b16 v[24:25], v2 offset:24576
  ds_read_b64_tr_b16 v[26:27], v2 offset:25088
  s_waitcnt lgkmcnt(6)
  v_mfma_f32_32x32x16_bf16 v[240:255], v[12:15], v[72:75], v[240:255]
  ds_read_b64_tr_b16 v[8:9], v3 offset:24576
  ds_read_b64_tr_b16 v[10:11], v3 offset:25088
  s_waitcnt lgkmcnt(6)
  v_mfma_f32_32x32x16_bf16 v[224:239], v[16:19], v[76:79], v[224:239]
  ds_read_b64_tr_b16 v[12:13], v2 offset:26624
  ds_read_b64_tr_b16 v[14:15], v2 offset:27136
  s_waitcnt lgkmcnt(6)
  v_mfma_f32_32x32x16_bf16 v[240:255], v[20:23], v[76:79], v[240:255]
  ds_read_b64_tr_b16 v[16:17], v3 offset:26624
  ds_read_b64_tr_b16 v[18:19], v3 offset:27136
  s_waitcnt lgkmcnt(6)
  v_mfma_f32_32x32x16_bf16 v[224:239], v[24:27], v[80:83], v[224:239]
  ds_read_b64_tr_b16 v[20:21], v2 offset:28672
  ds_read_b64_tr_b16 v[22:23], v2 offset:29184
  s_waitcnt lgkmcnt(6)
  v_mfma_f32_32x32x16_bf16 v[240:255], v[8:11], v[80:83], v[240:255]
  ds_read_b64_tr_b16 v[24:25], v3 offset:28672
  ds_read_b64_tr_b16 v[26:27], v3 offset:29184
  s_waitcnt lgkmcnt(6)
  v_mfma_f32_32x32x16_bf16 v[224:239], v[12:15], v[84:87], v[224:239]
  ds_read_b64_tr_b16 v[8:9], v2 offset:30720
  ds_read_b64_tr_b16 v[10:11], v2 offset:31232
  s_waitcnt lgkmcnt(6)
  v_mfma_f32_32x32x16_bf16 v[240:255], v[16:19], v[84:87], v[240:255]
  ds_read_b64_tr_b16 v[12:13], v3 offset:30720
  ds_read_b64_tr_b16 v[14:15], v3 offset:31232
  s_waitcnt lgkmcnt(6)
  v_mfma_f32_32x32x16_bf16 v[224:239], v[20:23], v[88:91], v[224:239]
  s_barrier
  ds_read_b64_tr_b16 v[16:17], v2 offset:32768
  ds_read_b64_tr_b16 v[18:19], v2 offset:33280
  s_waitcnt lgkmcnt(6)
  v_mfma_f32_32x32x16_bf16 v[240:255], v[24:27], v[88:91], v[240:255]
  ds_read_b64_tr_b16 v[20:21], v3 offset:32768
  ds_read_b64_tr_b16 v[22:23], v3 offset:33280
  s_waitcnt lgkmcnt(6)
  v_mfma_f32_32x32x16_bf16 v[224:239], v[8:11], v[92:95], v[224:239]
  ds_read_b64_tr_b16 v[24:25], v2 offset:34816
  ds_read_b64_tr_b16 v[26:27], v2 offset:35328
  s_waitcnt lgkmcnt(6)
  v_mfma_f32_32x32x16_bf16 v[240:255], v[12:15], v[92:95], v[240:255]
  ds_read_b64_tr_b16 v[8:9], v3 offset:34816
  ds_read_b64_tr_b16 v[10:11], v3 offset:35328
  s_waitcnt lgkmcnt(6)
  v_mfma_f32_32x32x16_bf16 v[224:239], v[16:19], v[96:99], v[224:239]
  ds_read_b64_tr_b16 v[12:13], v2 offset:36864
  ds_read_b64_tr_b16 v[14:15], v2 offset:37376
  s_waitcnt lgkmcnt(6)
  v_mfma_f32_32x32x16_bf16 v[240:255], v[20:23], v[96:99], v[240:255]
  ds_read_b64_tr_b16 v[16:17], v3 offset:36864
  ds_read_b64_tr_b16 v[18:19], v3 offset:37376
  s_waitcnt lgkmcnt(6)
  v_mfma_f32_32x32x16_bf16 v[224:239], v[24:27], v[100:103], v[224:239]
  ds_read_b64_tr_b16 v[20:21], v2 offset:38912
  ds_read_b64_tr_b16 v[22:23], v2 offset:39424
  s_waitcnt lgkmcnt(6)
  v_mfma_f32_32x32x16_bf16 v[240:255], v[8:11], v[100:103], v[240:255]
  ds_read_b64_tr_b16 v[24:25], v3 offset:38912
  ds_read_b64_tr_b16 v[26:27], v3 offset:39424
  s_waitcnt lgkmcnt(6)
  v_mfma_f32_32x32x16_bf16 v[224:239], v[12:15], v[104:107], v[224:239]
  ds_read_b64_tr_b16 v[8:9], v2 offset:40960
  ds_read_b64_tr_b16 v[10:11], v2 offset:41472
  s_waitcnt lgkmcnt(6)
  v_mfma_f32_32x32x16_bf16 v[240:255], v[16:19], v[104:107], v[240:255]
  ds_read_b64_tr_b16 v[12:13], v3 offset:40960
  ds_read_b64_tr_b16 v[14:15], v3 offset:41472
  s_waitcnt lgkmcnt(6)
  v_mfma_f32_32x32x16_bf16 v[224:239], v[20:23], v[108:111], v[224:239]
  ds_read_b64_tr_b16 v[16:17], v2 offset:43008
  ds_read_b64_tr_b16 v[18:19], v2 offset:43520
  s_waitcnt lgkmcnt(6)
  v_mfma_f32_32x32x16_bf16 v[240:255], v[24:27], v[108:111], v[240:255]
  ds_read_b64_tr_b16 v[20:21], v3 offset:43008
  ds_read_b64_tr_b16 v[22:23], v3 offset:43520
  s_waitcnt lgkmcnt(6)
  v_mfma_f32_32x32x16_bf16 v[224:239], v[8:11], v[112:115], v[224:239]
  ds_read_b64_tr_b16 v[24:25], v2 offset:45056
  ds_read_b64_tr_b16 v[26:27], v2 offset:45568
  s_waitcnt lgkmcnt(6)
  v_mfma_f32_32x32x16_bf16 v[240:255], v[12:15], v[112:115], v[240:255]
  ds_read_b64_tr_b16 v[8:9], v3 offset:45056
  ds_read_b64_tr_b16 v[10:11], v3 offset:45568
  s_waitcnt lgkmcnt(6)
  v_mfma_f32_32x32x16_bf16 v[224:239], v[16:19], v[116:119], v[224:239]
  ds_read_b64_tr_b16 v[12:13], v2 offset:47104
  ds_read_b64_tr_b16 v[14:15], v2 offset:47616
  s_waitcnt lgkmcnt(6)
  v_mfma_f32_32x32x16_bf16 v[240:255], v[20:23], v[116:119], v[240:255]
  ds_read_b64_tr_b16 v[16:17], v3 offset:47104
  ds_read_b64_tr_b16 v[18:19], v3 offset:47616
  s_waitcnt lgkmcnt(6)
  v_mfma_f32_32x32x16_bf16 v[224:239], v[24:27], v[120:123], v[224:239]
  s_barrier
  ds_read_b64_tr_b16 v[20:21], v2 offset:49152
  ds_read_b64_tr_b16 v[22:23], v2 offset:49664
  s_waitcnt lgkmcnt(6)
  v_mfma_f32_32x32x16_bf16 v[240:255], v[8:11], v[120:123], v[240:255]
  ds_read_b64_tr_b16 v[24:25], v3 offset:49152
  ds_read_b64_tr_b16 v[26:27], v3 offset:49664
  s_waitcnt lgkmcnt(6)
  v_mfma_f32_32x32x16_bf16 v[224:239], v[12:15], v[124:127], v[224:239]
  ds_read_b64_tr_b16 v[8:9], v2 offset:51200
  ds_read_b64_tr_b16 v[10:11], v2 offset:51712
  s_waitcnt lgkmcnt(6)
  v_mfma_f32_32x32x16_bf16 v[240:255], v[16:19], v[124:127], v[240:255]
  ds_read_b64_tr_b16 v[12:13], v3 offset:51200
  ds_read_b64_tr_b16 v[14:15], v3 offset:51712
  s_waitcnt lgkmcnt(6)
  v_mfma_f32_32x32x16_bf16 v[224:239], v[20:23], v[128:131], v[224:239]
  ds_read_b64_tr_b16 v[16:17], v2 offset:53248
  ds_read_b64_tr_b16 v[18:19], v2 offset:53760
  s_waitcnt lgkmcnt(6)
  v_mfma_f32_32x32x16_bf16 v[240:255], v[24:27], v[128:131], v[240:255]
  ds_read_b64_tr_b16 v[20:21], v3 offset:53248
  ds_read_b64_tr_b16 v[22:23], v3 offset:53760
  s_waitcnt lgkmcnt(6)
  v_mfma_f32_32x32x16_bf16 v[224:239], v[8:11], v[132:135], v[224:239]
  ds_read_b64_tr_b16 v[24:25], v2 offset:55296
  ds_read_b64_tr_b16 v[26:27], v2 offset:55808
  s_waitcnt lgkmcnt(6)
  v_mfma_f32_32x32x16_bf16 v[240:255], v[12:15], v[132:135], v[240:255]
  ds_read_b64_tr_b16 v[8:9], v3 offset:55296
  ds_read_b64_tr_b16 v[10:11], v3 offset:55808
  s_waitcnt lgkmcnt(6)
  v_mfma_f32_32x32x16_bf16 v[224:239], v[16:19], v[136:139], v[224:239]
  ds_read_b64_tr_b16 v[12:13], v2 offset:57344
  ds_read_b64_tr_b16 v[14:15], v2 offset:57856
  s_waitcnt lgkmcnt(6)
  v_mfma_f32_32x32x16_bf16 v[240:255], v[20:23], v[136:139], v[240:255]
  ds_read_b64_tr_b16 v[16:17], v3 offset:57344
  ds_read_b64_tr_b16 v[18:19], v3 offset:57856
  s_waitcnt lgkmcnt(6)
  v_mfma_f32_32x32x16_bf16 v[224:239], v[24:27], v[140:143], v[224:239]
  ds_read_b64_tr_b16 v[20:21], v2 offset:59392
  ds_read_b64_tr_b16 v[22:23], v2 offset:59904
  s_waitcnt lgkmcnt(6)
  v_mfma_f32_32x32x16_bf16 v[240:255], v[8:11], v[140:143], v[240:255]
  ds_read_b64_tr_b16 v[24:25], v3 offset:59392
  ds_read_b64_tr_b16 v[26:27], v3 offset:59904
  s_waitcnt lgkmcnt(6)
  v_mfma_f32_32x32x16_bf16 v[224:239], v[12:15], v[144:147], v[224:239]
  ds_read_b64_tr_b16 v[8:9], v2 offset:61440
  ds_read_b64_tr_b16 v[10:11], v2 offset:61952
  s_waitcnt lgkmcnt(6)
  v_mfma_f32_32x32x16_bf16 v[240:255], v[16:19], v[144:147], v[240:255]
  ds_read_b64_tr_b16 v[12:13], v3 offset:61440
  ds_read_b64_tr_b16 v[14:15], v3 offset:61952
  s_waitcnt lgkmcnt(6)
  v_mfma_f32_32x32x16_bf16 v[224:239], v[20:23], v[148:151], v[224:239]
  ds_read_b64_tr_b16 v[16:17], v2 offset:63488
  ds_read_b64_tr_b16 v[18:19], v2 offset:64000
  s_waitcnt lgkmcnt(6)
  v_mfma_f32_32x32x16_bf16 v[240:255], v[24:27], v[148:151], v[240:255]
  ds_read_b64_tr_b16 v[20:21], v3 offset:63488
  ds_read_b64_tr_b16 v[22:23], v3 offset:64000
  s_waitcnt lgkmcnt(6)
  v_mfma_f32_32x32x16_bf16 v[224:239], v[8:11], v[152:155], v[224:239]
  s_barrier
  v_add_u32 v2, 0xffffc000, v2
  v_add_u32 v3, 0xffffc000, v3
  ds_read_b64_tr_b16 v[24:25], v2 offset:0
  ds_read_b64_tr_b16 v[26:27], v2 offset:512
  s_waitcnt lgkmcnt(6)
  v_mfma_f32_32x32x16_bf16 v[240:255], v[12:15], v[152:155], v[240:255]
  ds_read_b64_tr_b16 v[8:9], v3 offset:0
  ds_read_b64_tr_b16 v[10:11], v3 offset:512
  s_waitcnt lgkmcnt(6)
  v_mfma_f32_32x32x16_bf16 v[224:239], v[16:19], v[156:159], v[224:239]
  ds_read_b64_tr_b16 v[12:13], v2 offset:2048
  ds_read_b64_tr_b16 v[14:15], v2 offset:2560
  s_waitcnt lgkmcnt(6)
  v_mfma_f32_32x32x16_bf16 v[240:255], v[20:23], v[156:159], v[240:255]
  ds_read_b64_tr_b16 v[16:17], v3 offset:2048
  ds_read_b64_tr_b16 v[18:19], v3 offset:2560
  s_waitcnt lgkmcnt(6)
  v_mfma_f32_32x32x16_bf16 v[224:239], v[24:27], v[160:163], v[224:239]
  ds_read_b64_tr_b16 v[20:21], v2 offset:4096
  ds_read_b64_tr_b16 v[22:23], v2 offset:4608
  s_waitcnt lgkmcnt(6)
  v_mfma_f32_32x32x16_bf16 v[240:255], v[8:11], v[160:163], v[240:255]
  ds_read_b64_tr_b16 v[24:25], v3 offset:4096
  ds_read_b64_tr_b16 v[26:27], v3 offset:4608
  s_waitcnt lgkmcnt(6)
  v_mfma_f32_32x32x16_bf16 v[224:239], v[12:15], v[164:167], v[224:239]
  ds_read_b64_tr_b16 v[8:9], v2 offset:6144
  ds_read_b64_tr_b16 v[10:11], v2 offset:6656
  s_waitcnt lgkmcnt(6)
  v_mfma_f32_32x32x16_bf16 v[240:255], v[16:19], v[164:167], v[240:255]
  ds_read_b64_tr_b16 v[12:13], v3 offset:6144
  ds_read_b64_tr_b16 v[14:15], v3 offset:6656
  s_waitcnt lgkmcnt(6)
  v_mfma_f32_32x32x16_bf16 v[224:239], v[20:23], v[168:171], v[224:239]
  ds_read_b64_tr_b16 v[16:17], v2 offset:8192
  ds_read_b64_tr_b16 v[18:19], v2 offset:8704
  s_waitcnt lgkmcnt(6)
  v_mfma_f32_32x32x16_bf16 v[240:255], v[24:27], v[168:171], v[240:255]
  ds_read_b64_tr_b16 v[20:21], v3 offset:8192
  ds_read_b64_tr_b16 v[22:23], v3 offset:8704
  s_waitcnt lgkmcnt(6)
  v_mfma_f32_32x32x16_bf16 v[224:239], v[8:11], v[172:175], v[224:239]
  ds_read_b64_tr_b16 v[24:25], v2 offset:10240
  ds_read_b64_tr_b16 v[26:27], v2 offset:10752
  s_waitcnt lgkmcnt(6)
  v_mfma_f32_32x32x16_bf16 v[240:255], v[12:15], v[172:175], v[240:255]
  ds_read_b64_tr_b16 v[8:9], v3 offset:10240
  ds_read_b64_tr_b16 v[10:11], v3 offset:10752
  s_waitcnt lgkmcnt(6)
  v_mfma_f32_32x32x16_bf16 v[224:239], v[16:19], v[176:179], v[224:239]
  ds_read_b64_tr_b16 v[12:13], v2 offset:12288
  ds_read_b64_tr_b16 v[14:15], v2 offset:12800
  s_waitcnt lgkmcnt(6)
  v_mfma_f32_32x32x16_bf16 v[240:255], v[20:23], v[176:179], v[240:255]
  ds_read_b64_tr_b16 v[16:17], v3 offset:12288
  ds_read_b64_tr_b16 v[18:19], v3 offset:12800
  s_waitcnt lgkmcnt(6)
  v_mfma_f32_32x32x16_bf16 v[224:239], v[24:27], v[180:183], v[224:239]
  ds_read_b64_tr_b16 v[20:21], v2 offset:14336
  ds_read_b64_tr_b16 v[22:23], v2 offset:14848
  s_waitcnt lgkmcnt(6)
  v_mfma_f32_32x32x16_bf16 v[240:255], v[8:11], v[180:183], v[240:255]
  ds_read_b64_tr_b16 v[24:25], v3 offset:14336
  ds_read_b64_tr_b16 v[26:27], v3 offset:14848
  s_waitcnt lgkmcnt(6)
  v_mfma_f32_32x32x16_bf16 v[224:239], v[12:15], v[184:187], v[224:239]
  s_waitcnt lgkmcnt(4)
  v_mfma_f32_32x32x16_bf16 v[240:255], v[16:19], v[184:187], v[240:255]
  s_waitcnt lgkmcnt(2)
  v_mfma_f32_32x32x16_bf16 v[224:239], v[20:23], v[188:191], v[224:239]
  s_waitcnt lgkmcnt(0)
  v_mfma_f32_32x32x16_bf16 v[240:255], v[24:27], v[188:191], v[240:255]
  v_mbcnt_lo_u32_b32 v32, -1, 0
  v_mbcnt_hi_u32_b32 v32, -1, v32
  v_and_b32 v34, 31, v32
  s_lshl_b32 s28, s3, 5
  v_add_u32 v34, s28, v34
  v_lshlrev_b32 v34, 2, v34
  v_add_u32 v36, 70144, v34
  ds_read_b32 v34, v36
  ds_read_b32 v36, v36 offset:512
  v_lshrrev_b32 v32, 5, v32
  v_lshlrev_b32 v32, 5, v32
  v_add_u32 v32, 69120, v32
  v_mov_b32 v38, 0xc0135761
  v_mov_b32 v39, 0xc0135761
  ds_read_b128 v[40:43], v32 offset:0
  ds_read_b128 v[48:51], v32 offset:512
  ds_read_b128 v[44:47], v32 offset:16
  ds_read_b128 v[52:55], v32 offset:528
  s_nop 7
  ds_read_b128 v[72:75], v32 offset:64
  ds_read_b128 v[80:83], v32 offset:576
  ds_read_b128 v[76:79], v32 offset:80
  ds_read_b128 v[84:87], v32 offset:592
  s_waitcnt lgkmcnt(4)
  v_pk_fma_f32 v[56:57], v[40:41], v[34:35], v[48:49] op_sel_hi:[1,0,1] neg_lo:[1,0,0] neg_hi:[1,0,0]
  v_pk_fma_f32 v[58:59], v[42:43], v[34:35], v[50:51] op_sel_hi:[1,0,1] neg_lo:[1,0,0] neg_hi:[1,0,0]
  v_pk_fma_f32 v[60:61], v[44:45], v[34:35], v[52:53] op_sel_hi:[1,0,1] neg_lo:[1,0,0] neg_hi:[1,0,0]
  v_pk_fma_f32 v[62:63], v[46:47], v[34:35], v[54:55] op_sel_hi:[1,0,1] neg_lo:[1,0,0] neg_hi:[1,0,0]
  v_pk_fma_f32 v[192:193], v[192:193], v[36:37], v[56:57] op_sel_hi:[1,0,1]
  v_pk_fma_f32 v[194:195], v[194:195], v[36:37], v[58:59] op_sel_hi:[1,0,1]
  v_pk_fma_f32 v[196:197], v[196:197], v[36:37], v[60:61] op_sel_hi:[1,0,1]
  v_pk_fma_f32 v[198:199], v[198:199], v[36:37], v[62:63] op_sel_hi:[1,0,1]
  v_pk_mul_f32 v[56:57], v[192:193], v[192:193]
  v_pk_mul_f32 v[58:59], v[194:195], v[194:195]
  v_pk_mul_f32 v[60:61], v[196:197], v[196:197]
  v_pk_mul_f32 v[62:63], v[198:199], v[198:199]
  v_pk_fma_f32 v[56:57], v[56:57], s[94:95], v[38:39]
  v_pk_fma_f32 v[58:59], v[58:59], s[94:95], v[38:39]
  v_pk_fma_f32 v[60:61], v[60:61], s[94:95], v[38:39]
  v_pk_fma_f32 v[62:63], v[62:63], s[94:95], v[38:39]
  v_pk_mul_f32 v[56:57], v[56:57], v[192:193]
  v_pk_mul_f32 v[58:59], v[58:59], v[194:195]
  v_pk_mul_f32 v[60:61], v[60:61], v[196:197]
  v_pk_mul_f32 v[62:63], v[62:63], v[198:199]
  v_exp_f32 v56, v56
  v_exp_f32 v57, v57
  v_exp_f32 v58, v58
  v_exp_f32 v59, v59
  v_exp_f32 v60, v60
  v_exp_f32 v61, v61
  v_exp_f32 v62, v62
  v_exp_f32 v63, v63
  v_pk_add_f32 v[56:57], v[56:57], 1.0 op_sel_hi:[1,0]
  v_pk_add_f32 v[58:59], v[58:59], 1.0 op_sel_hi:[1,0]
  v_pk_add_f32 v[60:61], v[60:61], 1.0 op_sel_hi:[1,0]
  v_pk_add_f32 v[62:63], v[62:63], 1.0 op_sel_hi:[1,0]
  v_rcp_f32 v56, v56
  v_rcp_f32 v57, v57
  v_rcp_f32 v58, v58
  v_rcp_f32 v59, v59
  v_rcp_f32 v60, v60
  v_rcp_f32 v61, v61
  v_rcp_f32 v62, v62
  v_rcp_f32 v63, v63
  v_pk_mul_f32 v[56:57], v[56:57], v[192:193]
  v_pk_mul_f32 v[58:59], v[58:59], v[194:195]
  v_pk_mul_f32 v[60:61], v[60:61], v[196:197]
  v_pk_mul_f32 v[62:63], v[62:63], v[198:199]
  v_cvt_pk_bf16_f32 v88, v56, v57
  v_cvt_pk_bf16_f32 v89, v58, v59
  v_cvt_pk_bf16_f32 v90, v60, v61
  v_cvt_pk_bf16_f32 v91, v62, v63
  s_add_u32 s93, s92, 0
  buffer_store_dwordx4 v[88:91], v5, s[20:23], s93 offen sc1
  s_nop 0
  ds_read_b128 v[40:43], v32 offset:128
  ds_read_b128 v[48:51], v32 offset:640
  ds_read_b128 v[44:47], v32 offset:144
  ds_read_b128 v[52:55], v32 offset:656
  s_waitcnt lgkmcnt(4)
  v_pk_fma_f32 v[56:57], v[72:73], v[34:35], v[80:81] op_sel_hi:[1,0,1] neg_lo:[1,0,0] neg_hi:[1,0,0]
  v_pk_fma_f32 v[58:59], v[74:75], v[34:35], v[82:83] op_sel_hi:[1,0,1] neg_lo:[1,0,0] neg_hi:[1,0,0]
  v_pk_fma_f32 v[60:61], v[76:77], v[34:35], v[84:85] op_sel_hi:[1,0,1] neg_lo:[1,0,0] neg_hi:[1,0,0]
  v_pk_fma_f32 v[62:63], v[78:79], v[34:35], v[86:87] op_sel_hi:[1,0,1] neg_lo:[1,0,0] neg_hi:[1,0,0]
  v_pk_fma_f32 v[200:201], v[200:201], v[36:37], v[56:57] op_sel_hi:[1,0,1]
  v_pk_fma_f32 v[202:203], v[202:203], v[36:37], v[58:59] op_sel_hi:[1,0,1]
  v_pk_fma_f32 v[204:205], v[204:205], v[36:37], v[60:61] op_sel_hi:[1,0,1]
  v_pk_fma_f32 v[206:207], v[206:207], v[36:37], v[62:63] op_sel_hi:[1,0,1]
  v_pk_mul_f32 v[56:57], v[200:201], v[200:201]
  v_pk_mul_f32 v[58:59], v[202:203], v[202:203]
  v_pk_mul_f32 v[60:61], v[204:205], v[204:205]
  v_pk_mul_f32 v[62:63], v[206:207], v[206:207]
  v_pk_fma_f32 v[56:57], v[56:57], s[94:95], v[38:39]
  v_pk_fma_f32 v[58:59], v[58:59], s[94:95], v[38:39]
  v_pk_fma_f32 v[60:61], v[60:61], s[94:95], v[38:39]
  v_pk_fma_f32 v[62:63], v[62:63], s[94:95], v[38:39]
  v_pk_mul_f32 v[56:57], v[56:57], v[200:201]
  v_pk_mul_f32 v[58:59], v[58:59], v[202:203]
  v_pk_mul_f32 v[60:61], v[60:61], v[204:205]
  v_pk_mul_f32 v[62:63], v[62:63], v[206:207]
  v_exp_f32 v56, v56
  v_exp_f32 v57, v57
  v_exp_f32 v58, v58
  v_exp_f32 v59, v59
  v_exp_f32 v60, v60
  v_exp_f32 v61, v61
  v_exp_f32 v62, v62
  v_exp_f32 v63, v63
  v_pk_add_f32 v[56:57], v[56:57], 1.0 op_sel_hi:[1,0]
  v_pk_add_f32 v[58:59], v[58:59], 1.0 op_sel_hi:[1,0]
  v_pk_add_f32 v[60:61], v[60:61], 1.0 op_sel_hi:[1,0]
  v_pk_add_f32 v[62:63], v[62:63], 1.0 op_sel_hi:[1,0]
  v_rcp_f32 v56, v56
  v_rcp_f32 v57, v57
  v_rcp_f32 v58, v58
  v_rcp_f32 v59, v59
  v_rcp_f32 v60, v60
  v_rcp_f32 v61, v61
  v_rcp_f32 v62, v62
  v_rcp_f32 v63, v63
  v_pk_mul_f32 v[56:57], v[56:57], v[200:201]
  v_pk_mul_f32 v[58:59], v[58:59], v[202:203]
  v_pk_mul_f32 v[60:61], v[60:61], v[204:205]
  v_pk_mul_f32 v[62:63], v[62:63], v[206:207]
  v_cvt_pk_bf16_f32 v92, v56, v57
  v_cvt_pk_bf16_f32 v93, v58, v59
  v_cvt_pk_bf16_f32 v94, v60, v61
  v_cvt_pk_bf16_f32 v95, v62, v63
  s_add_u32 s93, s92, 65536
  buffer_store_dwordx4 v[92:95], v5, s[20:23], s93 offen sc1
  s_nop 0
  ds_read_b128 v[72:75], v32 offset:192
  ds_read_b128 v[80:83], v32 offset:704
  ds_read_b128 v[76:79], v32 offset:208
  ds_read_b128 v[84:87], v32 offset:720
  s_waitcnt lgkmcnt(4)
  v_pk_fma_f32 v[56:57], v[40:41], v[34:35], v[48:49] op_sel_hi:[1,0,1] neg_lo:[1,0,0] neg_hi:[1,0,0]
  v_pk_fma_f32 v[58:59], v[42:43], v[34:35], v[50:51] op_sel_hi:[1,0,1] neg_lo:[1,0,0] neg_hi:[1,0,0]
  v_pk_fma_f32 v[60:61], v[44:45], v[34:35], v[52:53] op_sel_hi:[1,0,1] neg_lo:[1,0,0] neg_hi:[1,0,0]
  v_pk_fma_f32 v[62:63], v[46:47], v[34:35], v[54:55] op_sel_hi:[1,0,1] neg_lo:[1,0,0] neg_hi:[1,0,0]
  v_pk_fma_f32 v[208:209], v[208:209], v[36:37], v[56:57] op_sel_hi:[1,0,1]
  v_pk_fma_f32 v[210:211], v[210:211], v[36:37], v[58:59] op_sel_hi:[1,0,1]
  v_pk_fma_f32 v[212:213], v[212:213], v[36:37], v[60:61] op_sel_hi:[1,0,1]
  v_pk_fma_f32 v[214:215], v[214:215], v[36:37], v[62:63] op_sel_hi:[1,0,1]
  v_pk_mul_f32 v[56:57], v[208:209], v[208:209]
  v_pk_mul_f32 v[58:59], v[210:211], v[210:211]
  v_pk_mul_f32 v[60:61], v[212:213], v[212:213]
  v_pk_mul_f32 v[62:63], v[214:215], v[214:215]
  v_pk_fma_f32 v[56:57], v[56:57], s[94:95], v[38:39]
  v_pk_fma_f32 v[58:59], v[58:59], s[94:95], v[38:39]
  v_pk_fma_f32 v[60:61], v[60:61], s[94:95], v[38:39]
  v_pk_fma_f32 v[62:63], v[62:63], s[94:95], v[38:39]
  v_pk_mul_f32 v[56:57], v[56:57], v[208:209]
  v_pk_mul_f32 v[58:59], v[58:59], v[210:211]
  v_pk_mul_f32 v[60:61], v[60:61], v[212:213]
  v_pk_mul_f32 v[62:63], v[62:63], v[214:215]
  v_exp_f32 v56, v56
  v_exp_f32 v57, v57
  v_exp_f32 v58, v58
  v_exp_f32 v59, v59
  v_exp_f32 v60, v60
  v_exp_f32 v61, v61
  v_exp_f32 v62, v62
  v_exp_f32 v63, v63
  v_pk_add_f32 v[56:57], v[56:57], 1.0 op_sel_hi:[1,0]
  v_pk_add_f32 v[58:59], v[58:59], 1.0 op_sel_hi:[1,0]
  v_pk_add_f32 v[60:61], v[60:61], 1.0 op_sel_hi:[1,0]
  v_pk_add_f32 v[62:63], v[62:63], 1.0 op_sel_hi:[1,0]
  v_rcp_f32 v56, v56
  v_rcp_f32 v57, v57
  v_rcp_f32 v58, v58
  v_rcp_f32 v59, v59
  v_rcp_f32 v60, v60
  v_rcp_f32 v61, v61
  v_rcp_f32 v62, v62
  v_rcp_f32 v63, v63
  v_pk_mul_f32 v[56:57], v[56:57], v[208:209]
  v_pk_mul_f32 v[58:59], v[58:59], v[210:211]
  v_pk_mul_f32 v[60:61], v[60:61], v[212:213]
  v_pk_mul_f32 v[62:63], v[62:63], v[214:215]
  v_cvt_pk_bf16_f32 v96, v56, v57
  v_cvt_pk_bf16_f32 v97, v58, v59
  v_cvt_pk_bf16_f32 v98, v60, v61
  v_cvt_pk_bf16_f32 v99, v62, v63
  s_add_u32 s93, s92, 131072
  buffer_store_dwordx4 v[96:99], v5, s[20:23], s93 offen sc1
  s_nop 0
  ds_read_b128 v[40:43], v32 offset:256
  ds_read_b128 v[48:51], v32 offset:768
  ds_read_b128 v[44:47], v32 offset:272
  ds_read_b128 v[52:55], v32 offset:784
  s_waitcnt lgkmcnt(4)
  v_pk_fma_f32 v[56:57], v[72:73], v[34:35], v[80:81] op_sel_hi:[1,0,1] neg_lo:[1,0,0] neg_hi:[1,0,0]
  v_pk_fma_f32 v[58:59], v[74:75], v[34:35], v[82:83] op_sel_hi:[1,0,1] neg_lo:[1,0,0] neg_hi:[1,0,0]
  v_pk_fma_f32 v[60:61], v[76:77], v[34:35], v[84:85] op_sel_hi:[1,0,1] neg_lo:[1,0,0] neg_hi:[1,0,0]
  v_pk_fma_f32 v[62:63], v[78:79], v[34:35], v[86:87] op_sel_hi:[1,0,1] neg_lo:[1,0,0] neg_hi:[1,0,0]
  v_pk_fma_f32 v[216:217], v[216:217], v[36:37], v[56:57] op_sel_hi:[1,0,1]
  v_pk_fma_f32 v[218:219], v[218:219], v[36:37], v[58:59] op_sel_hi:[1,0,1]
  v_pk_fma_f32 v[220:221], v[220:221], v[36:37], v[60:61] op_sel_hi:[1,0,1]
  v_pk_fma_f32 v[222:223], v[222:223], v[36:37], v[62:63] op_sel_hi:[1,0,1]
  v_pk_mul_f32 v[56:57], v[216:217], v[216:217]
  v_pk_mul_f32 v[58:59], v[218:219], v[218:219]
  v_pk_mul_f32 v[60:61], v[220:221], v[220:221]
  v_pk_mul_f32 v[62:63], v[222:223], v[222:223]
  v_pk_fma_f32 v[56:57], v[56:57], s[94:95], v[38:39]
  v_pk_fma_f32 v[58:59], v[58:59], s[94:95], v[38:39]
  v_pk_fma_f32 v[60:61], v[60:61], s[94:95], v[38:39]
  v_pk_fma_f32 v[62:63], v[62:63], s[94:95], v[38:39]
  v_pk_mul_f32 v[56:57], v[56:57], v[216:217]
  v_pk_mul_f32 v[58:59], v[58:59], v[218:219]
  v_pk_mul_f32 v[60:61], v[60:61], v[220:221]
  v_pk_mul_f32 v[62:63], v[62:63], v[222:223]
  v_exp_f32 v56, v56
  v_exp_f32 v57, v57
  v_exp_f32 v58, v58
  v_exp_f32 v59, v59
  v_exp_f32 v60, v60
  v_exp_f32 v61, v61
  v_exp_f32 v62, v62
  v_exp_f32 v63, v63
  v_pk_add_f32 v[56:57], v[56:57], 1.0 op_sel_hi:[1,0]
  v_pk_add_f32 v[58:59], v[58:59], 1.0 op_sel_hi:[1,0]
  v_pk_add_f32 v[60:61], v[60:61], 1.0 op_sel_hi:[1,0]
  v_pk_add_f32 v[62:63], v[62:63], 1.0 op_sel_hi:[1,0]
  v_rcp_f32 v56, v56
  v_rcp_f32 v57, v57
  v_rcp_f32 v58, v58
  v_rcp_f32 v59, v59
  v_rcp_f32 v60, v60
  v_rcp_f32 v61, v61
  v_rcp_f32 v62, v62
  v_rcp_f32 v63, v63
  v_pk_mul_f32 v[56:57], v[56:57], v[216:217]
  v_pk_mul_f32 v[58:59], v[58:59], v[218:219]
  v_pk_mul_f32 v[60:61], v[60:61], v[220:221]
  v_pk_mul_f32 v[62:63], v[62:63], v[222:223]
  v_cvt_pk_bf16_f32 v100, v56, v57
  v_cvt_pk_bf16_f32 v101, v58, v59
  v_cvt_pk_bf16_f32 v102, v60, v61
  v_cvt_pk_bf16_f32 v103, v62, v63
  s_add_u32 s93, s92, 196608
  buffer_store_dwordx4 v[100:103], v5, s[20:23], s93 offen sc1
  s_nop 0
  ds_read_b128 v[72:75], v32 offset:320
  ds_read_b128 v[80:83], v32 offset:832
  ds_read_b128 v[76:79], v32 offset:336
  ds_read_b128 v[84:87], v32 offset:848
  s_waitcnt lgkmcnt(4)
  v_pk_fma_f32 v[56:57], v[40:41], v[34:35], v[48:49] op_sel_hi:[1,0,1] neg_lo:[1,0,0] neg_hi:[1,0,0]
  v_pk_fma_f32 v[58:59], v[42:43], v[34:35], v[50:51] op_sel_hi:[1,0,1] neg_lo:[1,0,0] neg_hi:[1,0,0]
  v_pk_fma_f32 v[60:61], v[44:45], v[34:35], v[52:53] op_sel_hi:[1,0,1] neg_lo:[1,0,0] neg_hi:[1,0,0]
  v_pk_fma_f32 v[62:63], v[46:47], v[34:35], v[54:55] op_sel_hi:[1,0,1] neg_lo:[1,0,0] neg_hi:[1,0,0]
  v_pk_fma_f32 v[224:225], v[224:225], v[36:37], v[56:57] op_sel_hi:[1,0,1]
  v_pk_fma_f32 v[226:227], v[226:227], v[36:37], v[58:59] op_sel_hi:[1,0,1]
  v_pk_fma_f32 v[228:229], v[228:229], v[36:37], v[60:61] op_sel_hi:[1,0,1]
  v_pk_fma_f32 v[230:231], v[230:231], v[36:37], v[62:63] op_sel_hi:[1,0,1]
  v_pk_mul_f32 v[56:57], v[224:225], v[224:225]
  v_pk_mul_f32 v[58:59], v[226:227], v[226:227]
  v_pk_mul_f32 v[60:61], v[228:229], v[228:229]
  v_pk_mul_f32 v[62:63], v[230:231], v[230:231]
  v_pk_fma_f32 v[56:57], v[56:57], s[94:95], v[38:39]
  v_pk_fma_f32 v[58:59], v[58:59], s[94:95], v[38:39]
  v_pk_fma_f32 v[60:61], v[60:61], s[94:95], v[38:39]
  v_pk_fma_f32 v[62:63], v[62:63], s[94:95], v[38:39]
  v_pk_mul_f32 v[56:57], v[56:57], v[224:225]
  v_pk_mul_f32 v[58:59], v[58:59], v[226:227]
  v_pk_mul_f32 v[60:61], v[60:61], v[228:229]
  v_pk_mul_f32 v[62:63], v[62:63], v[230:231]
  v_exp_f32 v56, v56
  v_exp_f32 v57, v57
  v_exp_f32 v58, v58
  v_exp_f32 v59, v59
  v_exp_f32 v60, v60
  v_exp_f32 v61, v61
  v_exp_f32 v62, v62
  v_exp_f32 v63, v63
  v_pk_add_f32 v[56:57], v[56:57], 1.0 op_sel_hi:[1,0]
  v_pk_add_f32 v[58:59], v[58:59], 1.0 op_sel_hi:[1,0]
  v_pk_add_f32 v[60:61], v[60:61], 1.0 op_sel_hi:[1,0]
  v_pk_add_f32 v[62:63], v[62:63], 1.0 op_sel_hi:[1,0]
  v_rcp_f32 v56, v56
  v_rcp_f32 v57, v57
  v_rcp_f32 v58, v58
  v_rcp_f32 v59, v59
  v_rcp_f32 v60, v60
  v_rcp_f32 v61, v61
  v_rcp_f32 v62, v62
  v_rcp_f32 v63, v63
  v_pk_mul_f32 v[56:57], v[56:57], v[224:225]
  v_pk_mul_f32 v[58:59], v[58:59], v[226:227]
  v_pk_mul_f32 v[60:61], v[60:61], v[228:229]
  v_pk_mul_f32 v[62:63], v[62:63], v[230:231]
  v_cvt_pk_bf16_f32 v104, v56, v57
  v_cvt_pk_bf16_f32 v105, v58, v59
  v_cvt_pk_bf16_f32 v106, v60, v61
  v_cvt_pk_bf16_f32 v107, v62, v63
  s_add_u32 s93, s92, 262144
  buffer_store_dwordx4 v[104:107], v5, s[20:23], s93 offen sc1
  s_nop 0
  ds_read_b128 v[40:43], v32 offset:384
  ds_read_b128 v[48:51], v32 offset:896
  ds_read_b128 v[44:47], v32 offset:400
  ds_read_b128 v[52:55], v32 offset:912
  s_waitcnt lgkmcnt(4)
  v_pk_fma_f32 v[56:57], v[72:73], v[34:35], v[80:81] op_sel_hi:[1,0,1] neg_lo:[1,0,0] neg_hi:[1,0,0]
  v_pk_fma_f32 v[58:59], v[74:75], v[34:35], v[82:83] op_sel_hi:[1,0,1] neg_lo:[1,0,0] neg_hi:[1,0,0]
  v_pk_fma_f32 v[60:61], v[76:77], v[34:35], v[84:85] op_sel_hi:[1,0,1] neg_lo:[1,0,0] neg_hi:[1,0,0]
  v_pk_fma_f32 v[62:63], v[78:79], v[34:35], v[86:87] op_sel_hi:[1,0,1] neg_lo:[1,0,0] neg_hi:[1,0,0]
  v_pk_fma_f32 v[232:233], v[232:233], v[36:37], v[56:57] op_sel_hi:[1,0,1]
  v_pk_fma_f32 v[234:235], v[234:235], v[36:37], v[58:59] op_sel_hi:[1,0,1]
  v_pk_fma_f32 v[236:237], v[236:237], v[36:37], v[60:61] op_sel_hi:[1,0,1]
  v_pk_fma_f32 v[238:239], v[238:239], v[36:37], v[62:63] op_sel_hi:[1,0,1]
  v_pk_mul_f32 v[56:57], v[232:233], v[232:233]
  v_pk_mul_f32 v[58:59], v[234:235], v[234:235]
  v_pk_mul_f32 v[60:61], v[236:237], v[236:237]
  v_pk_mul_f32 v[62:63], v[238:239], v[238:239]
  v_pk_fma_f32 v[56:57], v[56:57], s[94:95], v[38:39]
  v_pk_fma_f32 v[58:59], v[58:59], s[94:95], v[38:39]
  v_pk_fma_f32 v[60:61], v[60:61], s[94:95], v[38:39]
  v_pk_fma_f32 v[62:63], v[62:63], s[94:95], v[38:39]
  v_pk_mul_f32 v[56:57], v[56:57], v[232:233]
  v_pk_mul_f32 v[58:59], v[58:59], v[234:235]
  v_pk_mul_f32 v[60:61], v[60:61], v[236:237]
  v_pk_mul_f32 v[62:63], v[62:63], v[238:239]
  v_exp_f32 v56, v56
  v_exp_f32 v57, v57
  v_exp_f32 v58, v58
  v_exp_f32 v59, v59
  v_exp_f32 v60, v60
  v_exp_f32 v61, v61
  v_exp_f32 v62, v62
  v_exp_f32 v63, v63
  v_pk_add_f32 v[56:57], v[56:57], 1.0 op_sel_hi:[1,0]
  v_pk_add_f32 v[58:59], v[58:59], 1.0 op_sel_hi:[1,0]
  v_pk_add_f32 v[60:61], v[60:61], 1.0 op_sel_hi:[1,0]
  v_pk_add_f32 v[62:63], v[62:63], 1.0 op_sel_hi:[1,0]
  v_rcp_f32 v56, v56
  v_rcp_f32 v57, v57
  v_rcp_f32 v58, v58
  v_rcp_f32 v59, v59
  v_rcp_f32 v60, v60
  v_rcp_f32 v61, v61
  v_rcp_f32 v62, v62
  v_rcp_f32 v63, v63
  v_pk_mul_f32 v[56:57], v[56:57], v[232:233]
  v_pk_mul_f32 v[58:59], v[58:59], v[234:235]
  v_pk_mul_f32 v[60:61], v[60:61], v[236:237]
  v_pk_mul_f32 v[62:63], v[62:63], v[238:239]
  v_cvt_pk_bf16_f32 v108, v56, v57
  v_cvt_pk_bf16_f32 v109, v58, v59
  v_cvt_pk_bf16_f32 v110, v60, v61
  v_cvt_pk_bf16_f32 v111, v62, v63
  s_add_u32 s93, s92, 327680
  buffer_store_dwordx4 v[108:111], v5, s[20:23], s93 offen sc1
  s_nop 0
  ds_read_b128 v[72:75], v32 offset:448
  ds_read_b128 v[80:83], v32 offset:960
  ds_read_b128 v[76:79], v32 offset:464
  ds_read_b128 v[84:87], v32 offset:976
  s_waitcnt lgkmcnt(4)
  v_pk_fma_f32 v[56:57], v[40:41], v[34:35], v[48:49] op_sel_hi:[1,0,1] neg_lo:[1,0,0] neg_hi:[1,0,0]
  v_pk_fma_f32 v[58:59], v[42:43], v[34:35], v[50:51] op_sel_hi:[1,0,1] neg_lo:[1,0,0] neg_hi:[1,0,0]
  v_pk_fma_f32 v[60:61], v[44:45], v[34:35], v[52:53] op_sel_hi:[1,0,1] neg_lo:[1,0,0] neg_hi:[1,0,0]
  v_pk_fma_f32 v[62:63], v[46:47], v[34:35], v[54:55] op_sel_hi:[1,0,1] neg_lo:[1,0,0] neg_hi:[1,0,0]
  v_pk_fma_f32 v[240:241], v[240:241], v[36:37], v[56:57] op_sel_hi:[1,0,1]
  v_pk_fma_f32 v[242:243], v[242:243], v[36:37], v[58:59] op_sel_hi:[1,0,1]
  v_pk_fma_f32 v[244:245], v[244:245], v[36:37], v[60:61] op_sel_hi:[1,0,1]
  v_pk_fma_f32 v[246:247], v[246:247], v[36:37], v[62:63] op_sel_hi:[1,0,1]
  v_pk_mul_f32 v[56:57], v[240:241], v[240:241]
  v_pk_mul_f32 v[58:59], v[242:243], v[242:243]
  v_pk_mul_f32 v[60:61], v[244:245], v[244:245]
  v_pk_mul_f32 v[62:63], v[246:247], v[246:247]
  v_pk_fma_f32 v[56:57], v[56:57], s[94:95], v[38:39]
  v_pk_fma_f32 v[58:59], v[58:59], s[94:95], v[38:39]
  v_pk_fma_f32 v[60:61], v[60:61], s[94:95], v[38:39]
  v_pk_fma_f32 v[62:63], v[62:63], s[94:95], v[38:39]
  v_pk_mul_f32 v[56:57], v[56:57], v[240:241]
  v_pk_mul_f32 v[58:59], v[58:59], v[242:243]
  v_pk_mul_f32 v[60:61], v[60:61], v[244:245]
  v_pk_mul_f32 v[62:63], v[62:63], v[246:247]
  v_exp_f32 v56, v56
  v_exp_f32 v57, v57
  v_exp_f32 v58, v58
  v_exp_f32 v59, v59
  v_exp_f32 v60, v60
  v_exp_f32 v61, v61
  v_exp_f32 v62, v62
  v_exp_f32 v63, v63
  v_pk_add_f32 v[56:57], v[56:57], 1.0 op_sel_hi:[1,0]
  v_pk_add_f32 v[58:59], v[58:59], 1.0 op_sel_hi:[1,0]
  v_pk_add_f32 v[60:61], v[60:61], 1.0 op_sel_hi:[1,0]
  v_pk_add_f32 v[62:63], v[62:63], 1.0 op_sel_hi:[1,0]
  v_rcp_f32 v56, v56
  v_rcp_f32 v57, v57
  v_rcp_f32 v58, v58
  v_rcp_f32 v59, v59
  v_rcp_f32 v60, v60
  v_rcp_f32 v61, v61
  v_rcp_f32 v62, v62
  v_rcp_f32 v63, v63
  v_pk_mul_f32 v[56:57], v[56:57], v[240:241]
  v_pk_mul_f32 v[58:59], v[58:59], v[242:243]
  v_pk_mul_f32 v[60:61], v[60:61], v[244:245]
  v_pk_mul_f32 v[62:63], v[62:63], v[246:247]
  v_cvt_pk_bf16_f32 v112, v56, v57
  v_cvt_pk_bf16_f32 v113, v58, v59
  v_cvt_pk_bf16_f32 v114, v60, v61
  v_cvt_pk_bf16_f32 v115, v62, v63
  s_add_u32 s93, s92, 393216
  buffer_store_dwordx4 v[112:115], v5, s[20:23], s93 offen sc1
  s_nop 0
  s_waitcnt lgkmcnt(0)
  v_pk_fma_f32 v[56:57], v[72:73], v[34:35], v[80:81] op_sel_hi:[1,0,1] neg_lo:[1,0,0] neg_hi:[1,0,0]
  v_pk_fma_f32 v[58:59], v[74:75], v[34:35], v[82:83] op_sel_hi:[1,0,1] neg_lo:[1,0,0] neg_hi:[1,0,0]
  v_pk_fma_f32 v[60:61], v[76:77], v[34:35], v[84:85] op_sel_hi:[1,0,1] neg_lo:[1,0,0] neg_hi:[1,0,0]
  v_pk_fma_f32 v[62:63], v[78:79], v[34:35], v[86:87] op_sel_hi:[1,0,1] neg_lo:[1,0,0] neg_hi:[1,0,0]
  v_pk_fma_f32 v[248:249], v[248:249], v[36:37], v[56:57] op_sel_hi:[1,0,1]
  v_pk_fma_f32 v[250:251], v[250:251], v[36:37], v[58:59] op_sel_hi:[1,0,1]
  v_pk_fma_f32 v[252:253], v[252:253], v[36:37], v[60:61] op_sel_hi:[1,0,1]
  v_pk_fma_f32 v[254:255], v[254:255], v[36:37], v[62:63] op_sel_hi:[1,0,1]
  v_pk_mul_f32 v[56:57], v[248:249], v[248:249]
  v_pk_mul_f32 v[58:59], v[250:251], v[250:251]
  v_pk_mul_f32 v[60:61], v[252:253], v[252:253]
  v_pk_mul_f32 v[62:63], v[254:255], v[254:255]
  v_pk_fma_f32 v[56:57], v[56:57], s[94:95], v[38:39]
  v_pk_fma_f32 v[58:59], v[58:59], s[94:95], v[38:39]
  v_pk_fma_f32 v[60:61], v[60:61], s[94:95], v[38:39]
  v_pk_fma_f32 v[62:63], v[62:63], s[94:95], v[38:39]
  v_pk_mul_f32 v[56:57], v[56:57], v[248:249]
  v_pk_mul_f32 v[58:59], v[58:59], v[250:251]
  v_pk_mul_f32 v[60:61], v[60:61], v[252:253]
  v_pk_mul_f32 v[62:63], v[62:63], v[254:255]
  v_exp_f32 v56, v56
  v_exp_f32 v57, v57
  v_exp_f32 v58, v58
  v_exp_f32 v59, v59
  v_exp_f32 v60, v60
  v_exp_f32 v61, v61
  v_exp_f32 v62, v62
  v_exp_f32 v63, v63
  v_pk_add_f32 v[56:57], v[56:57], 1.0 op_sel_hi:[1,0]
  v_pk_add_f32 v[58:59], v[58:59], 1.0 op_sel_hi:[1,0]
  v_pk_add_f32 v[60:61], v[60:61], 1.0 op_sel_hi:[1,0]
  v_pk_add_f32 v[62:63], v[62:63], 1.0 op_sel_hi:[1,0]
  v_rcp_f32 v56, v56
  v_rcp_f32 v57, v57
  v_rcp_f32 v58, v58
  v_rcp_f32 v59, v59
  v_rcp_f32 v60, v60
  v_rcp_f32 v61, v61
  v_rcp_f32 v62, v62
  v_rcp_f32 v63, v63
  v_pk_mul_f32 v[56:57], v[56:57], v[248:249]
  v_pk_mul_f32 v[58:59], v[58:59], v[250:251]
  v_pk_mul_f32 v[60:61], v[60:61], v[252:253]
  v_pk_mul_f32 v[62:63], v[62:63], v[254:255]
  v_cvt_pk_bf16_f32 v116, v56, v57
  v_cvt_pk_bf16_f32 v117, v58, v59
  v_cvt_pk_bf16_f32 v118, v60, v61
  v_cvt_pk_bf16_f32 v119, v62, v63
  s_add_u32 s93, s92, 458752
  buffer_store_dwordx4 v[116:119], v5, s[20:23], s93 offen sc1
  s_nop 0
  v_mov_b32 v176, v5
  v_mbcnt_lo_u32_b32 v2, -1, 0
  v_mbcnt_hi_u32_b32 v2, -1, v2
  s_lshl_b32 s36, s3, 6
  v_add_u32 v0, s36, v2
  s_branch L_gelu_done
L_consumer_a:
  s_barrier
  ds_read_b128 v[32:35], v4 offset:0
  v_xor_b32 v4, 32, v4
  ds_read_b64_tr_b16 v[8:9], v2 offset:0
  ds_read_b64_tr_b16 v[10:11], v2 offset:512
  ds_read_b64_tr_b16 v[12:13], v3 offset:0
  ds_read_b64_tr_b16 v[14:15], v3 offset:512
  ds_read_b128 v[36:39], v4 offset:0
  v_xor_b32 v4, 96, v4
  ds_read_b64_tr_b16 v[16:17], v2 offset:2048
  ds_read_b64_tr_b16 v[18:19], v2 offset:2560
  ds_read_b64_tr_b16 v[20:21], v3 offset:2048
  ds_read_b64_tr_b16 v[22:23], v3 offset:2560
  s_waitcnt lgkmcnt(7)
  v_mfma_f32_32x32x16_bf16 v[192:207], v[8:11], v[32:35], 0
  ds_read_b128 v[40:43], v4 offset:0
  v_xor_b32 v4, 32, v4
  ds_read_b64_tr_b16 v[24:25], v2 offset:4096
  ds_read_b64_tr_b16 v[26:27], v2 offset:4608
  s_waitcnt lgkmcnt(8)
  v_mfma_f32_32x32x16_bf16 v[208:223], v[12:15], v[32:35], 0
  ds_read_b64_tr_b16 v[8:9], v3 offset:4096
  ds_read_b64_tr_b16 v[10:11], v3 offset:4608
  s_waitcnt lgkmcnt(7)
  v_mfma_f32_32x32x16_bf16 v[192:207], v[16:19], v[36:39], v[192:207]
  ds_read_b128 v[44:47], v4 offset:0
  v_xor_b32 v4, 96, v4
  ds_read_b64_tr_b16 v[12:13], v2 offset:6144
  ds_read_b64_tr_b16 v[14:15], v2 offset:6656
  s_waitcnt lgkmcnt(8)
  v_mfma_f32_32x32x16_bf16 v[208:223], v[20:23], v[36:39], v[208:223]
  ds_read_b64_tr_b16 v[16:17], v3 offset:6144
  ds_read_b64_tr_b16 v[18:19], v3 offset:6656
  s_waitcnt lgkmcnt(7)
  v_mfma_f32_32x32x16_bf16 v[192:207], v[24:27], v[40:43], v[192:207]
  s_barrier
  ds_read_b128 v[48:51], v4 offset:16384
  v_xor_b32 v4, 32, v4
  ds_read_b64_tr_b16 v[20:21], v2 offset:8192
  ds_read_b64_tr_b16 v[22:23], v2 offset:8704
  s_waitcnt lgkmcnt(8)
  v_mfma_f32_32x32x16_bf16 v[208:223], v[8:11], v[40:43], v[208:223]
  ds_read_b64_tr_b16 v[24:25], v3 offset:8192
  ds_read_b64_tr_b16 v[26:27], v3 offset:8704
  s_waitcnt lgkmcnt(7)
  v_mfma_f32_32x32x16_bf16 v[192:207], v[12:15], v[44:47], v[192:207]
  ds_read_b128 v[52:55], v4 offset:16384
  v_xor_b32 v4, 96, v4
  ds_read_b64_tr_b16 v[8:9], v2 offset:10240
  ds_read_b64_tr_b16 v[10:11], v2 offset:10752
  s_waitcnt lgkmcnt(8)
  v_mfma_f32_32x32x16_bf16 v[208:223], v[16:19], v[44:47], v[208:223]
  ds_read_b64_tr_b16 v[12:13], v3 offset:10240
  ds_read_b64_tr_b16 v[14:15], v3 offset:10752
  s_waitcnt lgkmcnt(7)
  v_mfma_f32_32x32x16_bf16 v[192:207], v[20:23], v[48:51], v[192:207]
  ds_read_b128 v[56:59], v4 offset:16384
  v_xor_b32 v4, 32, v4
  ds_read_b64_tr_b16 v[16:17], v2 offset:12288
  ds_read_b64_tr_b16 v[18:19], v2 offset:12800
  s_waitcnt lgkmcnt(8)
  v_mfma_f32_32x32x16_bf16 v[208:223], v[24:27], v[48:51], v[208:223]
  ds_read_b64_tr_b16 v[20:21], v3 offset:12288
  ds_read_b64_tr_b16 v[22:23], v3 offset:12800
  s_waitcnt lgkmcnt(7)
  v_mfma_f32_32x32x16_bf16 v[192:207], v[8:11], v[52:55], v[192:207]
  ds_read_b128 v[60:63], v4 offset:16384
  v_xor_b32 v4, 96, v4
  ds_read_b64_tr_b16 v[24:25], v2 offset:14336
  ds_read_b64_tr_b16 v[26:27], v2 offset:14848
  s_waitcnt lgkmcnt(8)
  v_mfma_f32_32x32x16_bf16 v[208:223], v[12:15], v[52:55], v[208:223]
  ds_read_b64_tr_b16 v[8:9], v3 offset:14336
  ds_read_b64_tr_b16 v[10:11], v3 offset:14848
  s_waitcnt lgkmcnt(7)
  v_mfma_f32_32x32x16_bf16 v[192:207], v[16:19], v[56:59], v[192:207]
  s_barrier
  ds_read_b128 v[64:67], v4 offset:32768
  v_xor_b32 v4, 32, v4
  ds_read_b64_tr_b16 v[12:13], v2 offset:16384
  ds_read_b64_tr_b16 v[14:15], v2 offset:16896
  s_waitcnt lgkmcnt(8)
  v_mfma_f32_32x32x16_bf16 v[208:223], v[20:23], v[56:59], v[208:223]
  ds_read_b64_tr_b16 v[16:17], v3 offset:16384
  ds_read_b64_tr_b16 v[18:19], v3 offset:16896
  s_waitcnt lgkmcnt(7)
  v_mfma_f32_32x32x16_bf16 v[192:207], v[24:27], v[60:63], v[192:207]
  ds_read_b128 v[68:71], v4 offset:32768
  v_xor_b32 v4, 96, v4
  ds_read_b64_tr_b16 v[20:21], v2 offset:18432
  ds_read_b64_tr_b16 v[22:23], v2 offset:18944
  s_waitcnt lgkmcnt(8)
  v_mfma_f32_32x32x16_bf16 v[208:223], v[8:11], v[60:63], v[208:223]
  ds_read_b64_tr_b16 v[24:25], v3 offset:18432
  ds_read_b64_tr_b16 v[26:27], v3 offset:18944
  s_waitcnt lgkmcnt(7)
  v_mfma_f32_32x32x16_bf16 v[192:207], v[12:15], v[64:67], v[192:207]
  ds_read_b128 v[72:75], v4 offset:32768
  v_xor_b32 v4, 32, v4
  ds_read_b64_tr_b16 v[8:9], v2 offset:20480
  ds_read_b64_tr_b16 v[10:11], v2 offset:20992
  s_waitcnt lgkmcnt(8)
  v_mfma_f32_32x32x16_bf16 v[208:223], v[16:19], v[64:67], v[208:223]
  ds_read_b64_tr_b16 v[12:13], v3 offset:20480
  ds_read_b64_tr_b16 v[14:15], v3 offset:20992
  s_waitcnt lgkmcnt(7)
  v_mfma_f32_32x32x16_bf16 v[192:207], v[20:23], v[68:71], v[192:207]
  ds_read_b128 v[76:79], v4 offset:32768
  v_xor_b32 v4, 96, v4
  ds_read_b64_tr_b16 v[16:17], v2 offset:22528
  ds_read_b64_tr_b16 v[18:19], v2 offset:23040
  s_waitcnt lgkmcnt(8)
  v_mfma_f32_32x32x16_bf16 v[208:223], v[24:27], v[68:71], v[208:223]
  ds_read_b64_tr_b16 v[20:21], v3 offset:22528
  ds_read_b64_tr_b16 v[22:23], v3 offset:23040
  s_waitcnt lgkmcnt(7)
  v_mfma_f32_32x32x16_bf16 v[192:207], v[8:11], v[72:75], v[192:207]
  s_barrier
  ds_read_b128 v[80:83], v4 offset:49152
  v_xor_b32 v4, 32, v4
  ds_read_b64_tr_b16 v[24:25], v2 offset:24576
  ds_read_b64_tr_b16 v[26:27], v2 offset:25088
  s_waitcnt lgkmcnt(8)
  v_mfma_f32_32x32x16_bf16 v[208:223], v[12:15], v[72:75], v[208:223]
  ds_read_b64_tr_b16 v[8:9], v3 offset:24576
  ds_read_b64_tr_b16 v[10:11], v3 offset:25088
  s_waitcnt lgkmcnt(7)
  v_mfma_f32_32x32x16_bf16 v[192:207], v[16:19], v[76:79], v[192:207]
  ds_read_b128 v[84:87], v4 offset:49152
  v_xor_b32 v4, 96, v4
  ds_read_b64_tr_b16 v[12:13], v2 offset:26624
  ds_read_b64_tr_b16 v[14:15], v2 offset:27136
  s_waitcnt lgkmcnt(8)
  v_mfma_f32_32x32x16_bf16 v[208:223], v[20:23], v[76:79], v[208:223]
  ds_read_b64_tr_b16 v[16:17], v3 offset:26624
  ds_read_b64_tr_b16 v[18:19], v3 offset:27136
  s_waitcnt lgkmcnt(7)
  v_mfma_f32_32x32x16_bf16 v[192:207], v[24:27], v[80:83], v[192:207]
  ds_read_b128 v[88:91], v4 offset:49152
  v_xor_b32 v4, 32, v4
  ds_read_b64_tr_b16 v[20:21], v2 offset:28672
  ds_read_b64_tr_b16 v[22:23], v2 offset:29184
  s_waitcnt lgkmcnt(8)
  v_mfma_f32_32x32x16_bf16 v[208:223], v[8:11], v[80:83], v[208:223]
  ds_read_b64_tr_b16 v[24:25], v3 offset:28672
  ds_read_b64_tr_b16 v[26:27], v3 offset:29184
  s_waitcnt lgkmcnt(7)
  v_mfma_f32_32x32x16_bf16 v[192:207], v[12:15], v[84:87], v[192:207]
  ds_read_b128 v[92:95], v4 offset:49152
  v_xor_b32 v4, 96, v4
  ds_read_b64_tr_b16 v[8:9], v2 offset:30720
  ds_read_b64_tr_b16 v[10:11], v2 offset:31232
  s_waitcnt lgkmcnt(8)
  v_mfma_f32_32x32x16_bf16 v[208:223], v[16:19], v[84:87], v[208:223]
  ds_read_b64_tr_b16 v[12:13], v3 offset:30720
  ds_read_b64_tr_b16 v[14:15], v3 offset:31232
  s_waitcnt lgkmcnt(7)
  v_mfma_f32_32x32x16_bf16 v[192:207], v[20:23], v[88:91], v[192:207]
  s_barrier
  ds_read_b128 v[96:99], v4 offset:0
  v_xor_b32 v4, 32, v4
  ds_read_b64_tr_b16 v[16:17], v2 offset:0
  ds_read_b64_tr_b16 v[18:19], v2 offset:512
  s_waitcnt lgkmcnt(8)
  v_mfma_f32_32x32x16_bf16 v[208:223], v[24:27], v[88:91], v[208:223]
  ds_read_b64_tr_b16 v[20:21], v3 offset:0
  ds_read_b64_tr_b16 v[22:23], v3 offset:512
  s_waitcnt lgkmcnt(7)
  v_mfma_f32_32x32x16_bf16 v[192:207], v[8:11], v[92:95], v[192:207]
  ds_read_b128 v[100:103], v4 offset:0
  v_xor_b32 v4, 96, v4
  ds_read_b64_tr_b16 v[24:25], v2 offset:2048
  ds_read_b64_tr_b16 v[26:27], v2 offset:2560
  s_waitcnt lgkmcnt(8)
  v_mfma_f32_32x32x16_bf16 v[208:223], v[12:15], v[92:95], v[208:223]
  ds_read_b64_tr_b16 v[8:9], v3 offset:2048
  ds_read_b64_tr_b16 v[10:11], v3 offset:2560
  s_waitcnt lgkmcnt(7)
  v_mfma_f32_32x32x16_bf16 v[192:207], v[16:19], v[96:99], v[192:207]
  ds_read_b128 v[104:107], v4 offset:0
  v_xor_b32 v4, 32, v4
  ds_read_b64_tr_b16 v[12:13], v2 offset:4096
  ds_read_b64_tr_b16 v[14:15], v2 offset:4608
  s_waitcnt lgkmcnt(8)
  v_mfma_f32_32x32x16_bf16 v[208:223], v[20:23], v[96:99], v[208:223]
  ds_read_b64_tr_b16 v[16:17], v3 offset:4096
  ds_read_b64_tr_b16 v[18:19], v3 offset:4608
  s_waitcnt lgkmcnt(7)
  v_mfma_f32_32x32x16_bf16 v[192:207], v[24:27], v[100:103], v[192:207]
  ds_read_b128 v[108:111], v4 offset:0
  v_xor_b32 v4, 96, v4
  ds_read_b64_tr_b16 v[20:21], v2 offset:6144
  ds_read_b64_tr_b16 v[22:23], v2 offset:6656
  s_waitcnt lgkmcnt(8)
  v_mfma_f32_32x32x16_bf16 v[208:223], v[8:11], v[100:103], v[208:223]
  ds_read_b64_tr_b16 v[24:25], v3 offset:6144
  ds_read_b64_tr_b16 v[26:27], v3 offset:6656
  s_waitcnt lgkmcnt(7)
  v_mfma_f32_32x32x16_bf16 v[192:207], v[12:15], v[104:107], v[192:207]
  s_barrier
  ds_read_b128 v[112:115], v4 offset:16384
  v_xor_b32 v4, 32, v4
  ds_read_b64_tr_b16 v[8:9], v2 offset:8192
  ds_read_b64_tr_b16 v[10:11], v2 offset:8704
  s_waitcnt lgkmcnt(8)
  v_mfma_f32_32x32x16_bf16 v[208:223], v[16:19], v[104:107], v[208:223]
  ds_read_b64_tr_b16 v[12:13], v3 offset:8192
  ds_read_b64_tr_b16 v[14:15], v3 offset:8704
  s_waitcnt lgkmcnt(7)
  v_mfma_f32_32x32x16_bf16 v[192:207], v[20:23], v[108:111], v[192:207]
  ds_read_b128 v[116:119], v4 offset:16384
  v_xor_b32 v4, 96, v4
  ds_read_b64_tr_b16 v[16:17], v2 offset:10240
  ds_read_b64_tr_b16 v[18:19], v2 offset:10752
  s_waitcnt lgkmcnt(8)
  v_mfma_f32_32x32x16_bf16 v[208:223], v[24:27], v[108:111], v[208:223]
  ds_read_b64_tr_b16 v[20:21], v3 offset:10240
  ds_read_b64_tr_b16 v[22:23], v3 offset:10752
  s_waitcnt lgkmcnt(7)
  v_mfma_f32_32x32x16_bf16 v[192:207], v[8:11], v[112:115], v[192:207]
  ds_read_b128 v[120:123], v4 offset:16384
  v_xor_b32 v4, 32, v4
  ds_read_b64_tr_b16 v[24:25], v2 offset:12288
  ds_read_b64_tr_b16 v[26:27], v2 offset:12800
  s_waitcnt lgkmcnt(8)
  v_mfma_f32_32x32x16_bf16 v[208:223], v[12:15], v[112:115], v[208:223]
  ds_read_b64_tr_b16 v[8:9], v3 offset:12288
  ds_read_b64_tr_b16 v[10:11], v3 offset:12800
  s_waitcnt lgkmcnt(7)
  v_mfma_f32_32x32x16_bf16 v[192:207], v[16:19], v[116:119], v[192:207]
  ds_read_b128 v[124:127], v4 offset:16384
  v_xor_b32 v4, 96, v4
  ds_read_b64_tr_b16 v[12:13], v2 offset:14336
  ds_read_b64_tr_b16 v[14:15], v2 offset:14848
  s_waitcnt lgkmcnt(8)
  v_mfma_f32_32x32x16_bf16 v[208:223], v[20:23], v[116:119], v[208:223]
  ds_read_b64_tr_b16 v[16:17], v3 offset:14336
  ds_read_b64_tr_b16 v[18:19], v3 offset:14848
  s_waitcnt lgkmcnt(7)
  v_mfma_f32_32x32x16_bf16 v[192:207], v[24:27], v[120:123], v[192:207]
  s_barrier
  ds_read_b128 v[128:131], v4 offset:32768
  v_xor_b32 v4, 32, v4
  ds_read_b64_tr_b16 v[20:21], v2 offset:16384
  ds_read_b64_tr_b16 v[22:23], v2 offset:16896
  s_waitcnt lgkmcnt(8)
  v_mfma_f32_32x32x16_bf16 v[208:223], v[8:11], v[120:123], v[208:223]
  ds_read_b64_tr_b16 v[24:25], v3 offset:16384
  ds_read_b64_tr_b16 v[26:27], v3 offset:16896
  s_waitcnt lgkmcnt(7)
  v_mfma_f32_32x32x16_bf16 v[192:207], v[12:15], v[124:127], v[192:207]
  ds_read_b128 v[132:135], v4 offset:32768
  v_xor_b32 v4, 96, v4
  ds_read_b64_tr_b16 v[8:9], v2 offset:18432
  ds_read_b64_tr_b16 v[10:11], v2 offset:18944
  s_waitcnt lgkmcnt(8)
  v_mfma_f32_32x32x16_bf16 v[208:223], v[16:19], v[124:127], v[208:223]
  ds_read_b64_tr_b16 v[12:13], v3 offset:18432
  ds_read_b64_tr_b16 v[14:15], v3 offset:18944
  s_waitcnt lgkmcnt(7)
  v_mfma_f32_32x32x16_bf16 v[192:207], v[20:23], v[128:131], v[192:207]
  ds_read_b128 v[136:139], v4 offset:32768
  v_xor_b32 v4, 32, v4
  ds_read_b64_tr_b16 v[16:17], v2 offset:20480
  ds_read_b64_tr_b16 v[18:19], v2 offset:20992
  s_waitcnt lgkmcnt(8)
  v_mfma_f32_32x32x16_bf16 v[208:223], v[24:27], v[128:131], v[208:223]
  ds_read_b64_tr_b16 v[20:21], v3 offset:20480
  ds_read_b64_tr_b16 v[22:23], v3 offset:20992
  s_waitcnt lgkmcnt(7)
  v_mfma_f32_32x32x16_bf16 v[192:207], v[8:11], v[132:135], v[192:207]
  ds_read_b128 v[140:143], v4 offset:32768
  v_xor_b32 v4, 96, v4
  ds_read_b64_tr_b16 v[24:25], v2 offset:22528
  ds_read_b64_tr_b16 v[26:27], v2 offset:23040
  s_waitcnt lgkmcnt(8)
  v_mfma_f32_32x32x16_bf16 v[208:223], v[12:15], v[132:135], v[208:223]
  ds_read_b64_tr_b16 v[8:9], v3 offset:22528
  ds_read_b64_tr_b16 v[10:11], v3 offset:23040
  s_waitcnt lgkmcnt(7)
  v_mfma_f32_32x32x16_bf16 v[192:207], v[16:19], v[136:139], v[192:207]
  s_barrier
  ds_read_b128 v[144:147], v4 offset:49152
  v_xor_b32 v4, 32, v4
  ds_read_b64_tr_b16 v[12:13], v2 offset:24576
  ds_read_b64_tr_b16 v[14:15], v2 offset:25088
  s_waitcnt lgkmcnt(8)
  v_mfma_f32_32x32x16_bf16 v[208:223], v[20:23], v[136:139], v[208:223]
  ds_read_b64_tr_b16 v[16:17], v3 offset:24576
  ds_read_b64_tr_b16 v[18:19], v3 offset:25088
  s_waitcnt lgkmcnt(7)
  v_mfma_f32_32x32x16_bf16 v[192:207], v[24:27], v[140:143], v[192:207]
  ds_read_b128 v[148:151], v4 offset:49152
  v_xor_b32 v4, 96, v4
  ds_read_b64_tr_b16 v[20:21], v2 offset:26624
  ds_read_b64_tr_b16 v[22:23], v2 offset:27136
  s_waitcnt lgkmcnt(8)
  v_mfma_f32_32x32x16_bf16 v[208:223], v[8:11], v[140:143], v[208:223]
  ds_read_b64_tr_b16 v[24:25], v3 offset:26624
  ds_read_b64_tr_b16 v[26:27], v3 offset:27136
  s_waitcnt lgkmcnt(7)
  v_mfma_f32_32x32x16_bf16 v[192:207], v[12:15], v[144:147], v[192:207]
  ds_read_b128 v[152:155], v4 offset:49152
  v_xor_b32 v4, 32, v4
  ds_read_b64_tr_b16 v[8:9], v2 offset:28672
  ds_read_b64_tr_b16 v[10:11], v2 offset:29184
  s_waitcnt lgkmcnt(8)
  v_mfma_f32_32x32x16_bf16 v[208:223], v[16:19], v[144:147], v[208:223]
  ds_read_b64_tr_b16 v[12:13], v3 offset:28672
  ds_read_b64_tr_b16 v[14:15], v3 offset:29184
  s_waitcnt lgkmcnt(7)
  v_mfma_f32_32x32x16_bf16 v[192:207], v[20:23], v[148:151], v[192:207]
  ds_read_b128 v[156:159], v4 offset:49152
  v_xor_b32 v4, 96, v4
  ds_read_b64_tr_b16 v[16:17], v2 offset:30720
  ds_read_b64_tr_b16 v[18:19], v2 offset:31232
  s_waitcnt lgkmcnt(8)
  v_mfma_f32_32x32x16_bf16 v[208:223], v[24:27], v[148:151], v[208:223]
  ds_read_b64_tr_b16 v[20:21], v3 offset:30720
  ds_read_b64_tr_b16 v[22:23], v3 offset:31232
  s_waitcnt lgkmcnt(7)
  v_mfma_f32_32x32x16_bf16 v[192:207], v[8:11], v[152:155], v[192:207]
  s_barrier
  ds_read_b128 v[160:163], v4 offset:0
  v_xor_b32 v4, 32, v4
  ds_read_b64_tr_b16 v[24:25], v2 offset:0
  ds_read_b64_tr_b16 v[26:27], v2 offset:512
  s_waitcnt lgkmcnt(8)
  v_mfma_f32_32x32x16_bf16 v[208:223], v[12:15], v[152:155], v[208:223]
  ds_read_b64_tr_b16 v[8:9], v3 offset:0
  ds_read_b64_tr_b16 v[10:11], v3 offset:512
  s_waitcnt lgkmcnt(7)
  v_mfma_f32_32x32x16_bf16 v[192:207], v[16:19], v[156:159], v[192:207]
  ds_read_b128 v[164:167], v4 offset:0
  v_xor_b32 v4, 96, v4
  ds_read_b64_tr_b16 v[12:13], v2 offset:2048
  ds_read_b64_tr_b16 v[14:15], v2 offset:2560
  s_waitcnt lgkmcnt(8)
  v_mfma_f32_32x32x16_bf16 v[208:223], v[20:23], v[156:159], v[208:223]
  ds_read_b64_tr_b16 v[16:17], v3 offset:2048
  ds_read_b64_tr_b16 v[18:19], v3 offset:2560
  s_waitcnt lgkmcnt(7)
  v_mfma_f32_32x32x16_bf16 v[192:207], v[24:27], v[160:163], v[192:207]
  ds_read_b128 v[168:171], v4 offset:0
  v_xor_b32 v4, 32, v4
  ds_read_b64_tr_b16 v[20:21], v2 offset:4096
  ds_read_b64_tr_b16 v[22:23], v2 offset:4608
  s_waitcnt lgkmcnt(8)
  v_mfma_f32_32x32x16_bf16 v[208:223], v[8:11], v[160:163], v[208:223]
  ds_read_b64_tr_b16 v[24:25], v3 offset:4096
  ds_read_b64_tr_b16 v[26:27], v3 offset:4608
  s_waitcnt lgkmcnt(7)
  v_mfma_f32_32x32x16_bf16 v[192:207], v[12:15], v[164:167], v[192:207]
  ds_read_b128 v[172:175], v4 offset:0
  v_xor_b32 v4, 96, v4
  ds_read_b64_tr_b16 v[8:9], v2 offset:6144
  ds_read_b64_tr_b16 v[10:11], v2 offset:6656
  s_waitcnt lgkmcnt(8)
  v_mfma_f32_32x32x16_bf16 v[208:223], v[16:19], v[164:167], v[208:223]
  ds_read_b64_tr_b16 v[12:13], v3 offset:6144
  ds_read_b64_tr_b16 v[14:15], v3 offset:6656
  s_waitcnt lgkmcnt(7)
  v_mfma_f32_32x32x16_bf16 v[192:207], v[20:23], v[168:171], v[192:207]
  s_barrier
  ds_read_b128 v[176:179], v4 offset:16384
  v_xor_b32 v4, 32, v4
  ds_read_b64_tr_b16 v[16:17], v2 offset:8192
  ds_read_b64_tr_b16 v[18:19], v2 offset:8704
  s_waitcnt lgkmcnt(8)
  v_mfma_f32_32x32x16_bf16 v[208:223], v[24:27], v[168:171], v[208:223]
  ds_read_b64_tr_b16 v[20:21], v3 offset:8192
  ds_read_b64_tr_b16 v[22:23], v3 offset:8704
  s_waitcnt lgkmcnt(7)
  v_mfma_f32_32x32x16_bf16 v[192:207], v[8:11], v[172:175], v[192:207]
  ds_read_b128 v[180:183], v4 offset:16384
  v_xor_b32 v4, 96, v4
  ds_read_b64_tr_b16 v[24:25], v2 offset:10240
  ds_read_b64_tr_b16 v[26:27], v2 offset:10752
  s_waitcnt lgkmcnt(8)
  v_mfma_f32_32x32x16_bf16 v[208:223], v[12:15], v[172:175], v[208:223]
  ds_read_b64_tr_b16 v[8:9], v3 offset:10240
  ds_read_b64_tr_b16 v[10:11], v3 offset:10752
  s_waitcnt lgkmcnt(7)
  v_mfma_f32_32x32x16_bf16 v[192:207], v[16:19], v[176:179], v[192:207]
  ds_read_b128 v[184:187], v4 offset:16384
  v_xor_b32 v4, 32, v4
  ds_read_b64_tr_b16 v[12:13], v2 offset:12288
  ds_read_b64_tr_b16 v[14:15], v2 offset:12800
  s_waitcnt lgkmcnt(8)
  v_mfma_f32_32x32x16_bf16 v[208:223], v[20:23], v[176:179], v[208:223]
  ds_read_b64_tr_b16 v[16:17], v3 offset:12288
  ds_read_b64_tr_b16 v[18:19], v3 offset:12800
  s_waitcnt lgkmcnt(7)
  v_mfma_f32_32x32x16_bf16 v[192:207], v[24:27], v[180:183], v[192:207]
  ds_read_b128 v[188:191], v4 offset:16384
  v_xor_b32 v4, 96, v4
  ds_read_b64_tr_b16 v[20:21], v2 offset:14336
  ds_read_b64_tr_b16 v[22:23], v2 offset:14848
  s_waitcnt lgkmcnt(8)
  v_mfma_f32_32x32x16_bf16 v[208:223], v[8:11], v[180:183], v[208:223]
  ds_read_b64_tr_b16 v[24:25], v3 offset:14336
  ds_read_b64_tr_b16 v[26:27], v3 offset:14848
  s_waitcnt lgkmcnt(7)
  v_mfma_f32_32x32x16_bf16 v[192:207], v[12:15], v[184:187], v[192:207]
  s_barrier
  v_add_u32 v2, 0x8000, v2
  v_add_u32 v3, 0x8000, v3
  ds_read_b64_tr_b16 v[8:9], v2 offset:0
  ds_read_b64_tr_b16 v[10:11], v2 offset:512
  s_waitcnt lgkmcnt(7)
  v_mfma_f32_32x32x16_bf16 v[208:223], v[16:19], v[184:187], v[208:223]
  ds_read_b64_tr_b16 v[12:13], v3 offset:0
  ds_read_b64_tr_b16 v[14:15], v3 offset:512
  s_waitcnt lgkmcnt(6)
  v_mfma_f32_32x32x16_bf16 v[192:207], v[20:23], v[188:191], v[192:207]
  ds_read_b64_tr_b16 v[16:17], v2 offset:2048
  ds_read_b64_tr_b16 v[18:19], v2 offset:2560
  s_waitcnt lgkmcnt(6)
  v_mfma_f32_32x32x16_bf16 v[208:223], v[24:27], v[188:191], v[208:223]
  ds_read_b64_tr_b16 v[20:21], v3 offset:2048
  ds_read_b64_tr_b16 v[22:23], v3 offset:2560
  s_waitcnt lgkmcnt(6)
  v_mfma_f32_32x32x16_bf16 v[224:239], v[8:11], v[32:35], 0
  ds_read_b64_tr_b16 v[24:25], v2 offset:4096
  ds_read_b64_tr_b16 v[26:27], v2 offset:4608
  s_waitcnt lgkmcnt(6)
  v_mfma_f32_32x32x16_bf16 v[240:255], v[12:15], v[32:35], 0
  s_waitcnt vmcnt(0)
  ds_read_b64_tr_b16 v[8:9], v3 offset:4096
  ds_read_b64_tr_b16 v[10:11], v3 offset:4608
  s_waitcnt lgkmcnt(6)
  v_mfma_f32_32x32x16_bf16 v[224:239], v[16:19], v[36:39], v[224:239]
  ds_read_b64_tr_b16 v[12:13], v2 offset:6144
  ds_read_b64_tr_b16 v[14:15], v2 offset:6656
  s_waitcnt lgkmcnt(6)
  v_mfma_f32_32x32x16_bf16 v[240:255], v[20:23], v[36:39], v[240:255]
  ds_read_b64_tr_b16 v[16:17], v3 offset:6144
  ds_read_b64_tr_b16 v[18:19], v3 offset:6656
  s_waitcnt lgkmcnt(6)
  v_mfma_f32_32x32x16_bf16 v[224:239], v[24:27], v[40:43], v[224:239]
  ds_read_b64_tr_b16 v[20:21], v2 offset:8192
  ds_read_b64_tr_b16 v[22:23], v2 offset:8704
  s_waitcnt lgkmcnt(6)
  v_mfma_f32_32x32x16_bf16 v[240:255], v[8:11], v[40:43], v[240:255]
  ds_read_b64_tr_b16 v[24:25], v3 offset:8192
  ds_read_b64_tr_b16 v[26:27], v3 offset:8704
  s_waitcnt lgkmcnt(6)
  v_mfma_f32_32x32x16_bf16 v[224:239], v[12:15], v[44:47], v[224:239]
  ds_read_b64_tr_b16 v[8:9], v2 offset:10240
  ds_read_b64_tr_b16 v[10:11], v2 offset:10752
  s_waitcnt lgkmcnt(6)
  v_mfma_f32_32x32x16_bf16 v[240:255], v[16:19], v[44:47], v[240:255]
  ds_read_b64_tr_b16 v[12:13], v3 offset:10240
  ds_read_b64_tr_b16 v[14:15], v3 offset:10752
  s_waitcnt lgkmcnt(6)
  v_mfma_f32_32x32x16_bf16 v[224:239], v[20:23], v[48:51], v[224:239]
  v_mul_f32 v192, s30, v192
  ds_read_b64_tr_b16 v[16:17], v2 offset:12288
  ds_read_b64_tr_b16 v[18:19], v2 offset:12800
  s_waitcnt lgkmcnt(6)
  v_mfma_f32_32x32x16_bf16 v[240:255], v[24:27], v[48:51], v[240:255]
  v_mul_f32 v193, s30, v193
  ds_read_b64_tr_b16 v[20:21], v3 offset:12288
  ds_read_b64_tr_b16 v[22:23], v3 offset:12800
  s_waitcnt lgkmcnt(6)
  v_mfma_f32_32x32x16_bf16 v[224:239], v[8:11], v[52:55], v[224:239]
  v_mul_f32 v194, s30, v194
  ds_read_b64_tr_b16 v[24:25], v2 offset:14336
  ds_read_b64_tr_b16 v[26:27], v2 offset:14848
  s_waitcnt lgkmcnt(6)
  v_mfma_f32_32x32x16_bf16 v[240:255], v[12:15], v[52:55], v[240:255]
  v_mul_f32 v195, s30, v195
  ds_read_b64_tr_b16 v[8:9], v3 offset:14336
  ds_read_b64_tr_b16 v[10:11], v3 offset:14848
  s_waitcnt lgkmcnt(6)
  v_mfma_f32_32x32x16_bf16 v[224:239], v[16:19], v[56:59], v[224:239]
  v_mul_f32 v196, s30, v196
  s_barrier
  ds_read_b64_tr_b16 v[12:13], v2 offset:16384
  ds_read_b64_tr_b16 v[14:15], v2 offset:16896
  s_waitcnt lgkmcnt(6)
  v_mfma_f32_32x32x16_bf16 v[240:255], v[20:23], v[56:59], v[240:255]
  v_mul_f32 v197, s30, v197
  ds_read_b64_tr_b16 v[16:17], v3 offset:16384
  ds_read_b64_tr_b16 v[18:19], v3 offset:16896
  s_waitcnt lgkmcnt(6)
  v_mfma_f32_32x32x16_bf16 v[224:239], v[24:27], v[60:63], v[224:239]
  v_mul_f32 v198, s30, v198
  ds_read_b64_tr_b16 v[20:21], v2 offset:18432
  ds_read_b64_tr_b16 v[22:23], v2 offset:18944
  s_waitcnt lgkmcnt(6)
  v_mfma_f32_32x32x16_bf16 v[240:255], v[8:11], v[60:63], v[240:255]
  ds_read_b64_tr_b16 v[24:25], v3 offset:18432
  ds_read_b64_tr_b16 v[26:27], v3 offset:18944
  s_waitcnt lgkmcnt(6)
  v_mfma_f32_32x32x16_bf16 v[224:239], v[12:15], v[64:67], v[224:239]
  v_mul_f32 v199, s30, v199
  ds_read_b64_tr_b16 v[8:9], v2 offset:20480
  ds_read_b64_tr_b16 v[10:11], v2 offset:20992
  s_waitcnt lgkmcnt(6)
  v_mfma_f32_32x32x16_bf16 v[240:255], v[16:19], v[64:67], v[240:255]
  v_cvt_pk_bf16_f32 v28, v192, v193
  ds_read_b64_tr_b16 v[12:13], v3 offset:20480
  ds_read_b64_tr_b16 v[14:15], v3 offset:20992
  s_waitcnt lgkmcnt(6)
  v_mfma_f32_32x32x16_bf16 v[224:239], v[20:23], v[68:71], v[224:239]
  v_cvt_pk_bf16_f32 v29, v194, v195
  ds_read_b64_tr_b16 v[16:17], v2 offset:22528
  ds_read_b64_tr_b16 v[18:19], v2 offset:23040
  s_waitcnt lgkmcnt(6)
  v_mfma_f32_32x32x16_bf16 v[240:255], v[24:27], v[68:71], v[240:255]
  v_cvt_pk_bf16_f32 v30, v196, v197
  ds_read_b64_tr_b16 v[20:21], v3 offset:22528
  ds_read_b64_tr_b16 v[22:23], v3 offset:23040
  s_waitcnt lgkmcnt(6)
  v_mfma_f32_32x32x16_bf16 v[224:239], v[8:11], v[72:75], v[224:239]
  v_cvt_pk_bf16_f32 v31, v198, v199
  ds_read_b64_tr_b16 v[24:25], v2 offset:24576
  ds_read_b64_tr_b16 v[26:27], v2 offset:25088
  s_waitcnt lgkmcnt(6)
  v_mfma_f32_32x32x16_bf16 v[240:255], v[12:15], v[72:75], v[240:255]
  s_add_u32 s93, s92, 0
  ds_read_b64_tr_b16 v[8:9], v3 offset:24576
  ds_read_b64_tr_b16 v[10:11], v3 offset:25088
  s_waitcnt lgkmcnt(6)
  v_mfma_f32_32x32x16_bf16 v[224:239], v[16:19], v[76:79], v[224:239]
  buffer_store_dwordx4 v[28:31], v5, s[12:15], s93 offen sc1
  ds_read_b64_tr_b16 v[12:13], v2 offset:26624
  ds_read_b64_tr_b16 v[14:15], v2 offset:27136
  s_waitcnt lgkmcnt(6)
  v_mfma_f32_32x32x16_bf16 v[240:255], v[20:23], v[76:79], v[240:255]
  ds_read_b64_tr_b16 v[16:17], v3 offset:26624
  ds_read_b64_tr_b16 v[18:19], v3 offset:27136
  s_waitcnt lgkmcnt(6)
  v_mfma_f32_32x32x16_bf16 v[224:239], v[24:27], v[80:83], v[224:239]
  ds_read_b64_tr_b16 v[20:21], v2 offset:28672
  ds_read_b64_tr_b16 v[22:23], v2 offset:29184
  s_waitcnt lgkmcnt(6)
  v_mfma_f32_32x32x16_bf16 v[240:255], v[8:11], v[80:83], v[240:255]
  ds_read_b64_tr_b16 v[24:25], v3 offset:28672
  ds_read_b64_tr_b16 v[26:27], v3 offset:29184
  s_waitcnt lgkmcnt(6)
  v_mfma_f32_32x32x16_bf16 v[224:239], v[12:15], v[84:87], v[224:239]
  v_mul_f32 v200, s30, v200
  ds_read_b64_tr_b16 v[8:9], v2 offset:30720
  ds_read_b64_tr_b16 v[10:11], v2 offset:31232
  s_waitcnt lgkmcnt(6)
  v_mfma_f32_32x32x16_bf16 v[240:255], v[16:19], v[84:87], v[240:255]
  v_mul_f32 v201, s30, v201
  ds_read_b64_tr_b16 v[12:13], v3 offset:30720
  ds_read_b64_tr_b16 v[14:15], v3 offset:31232
  s_waitcnt lgkmcnt(6)
  v_mfma_f32_32x32x16_bf16 v[224:239], v[20:23], v[88:91], v[224:239]
  v_mul_f32 v202, s30, v202
  s_barrier
  ds_read_b64_tr_b16 v[16:17], v2 offset:32768
  ds_read_b64_tr_b16 v[18:19], v2 offset:33280
  s_waitcnt lgkmcnt(6)
  v_mfma_f32_32x32x16_bf16 v[240:255], v[24:27], v[88:91], v[240:255]
  v_mul_f32 v203, s30, v203
  ds_read_b64_tr_b16 v[20:21], v3 offset:32768
  ds_read_b64_tr_b16 v[22:23], v3 offset:33280
  s_waitcnt lgkmcnt(6)
  v_mfma_f32_32x32x16_bf16 v[224:239], v[8:11], v[92:95], v[224:239]
  v_mul_f32 v204, s30, v204
  ds_read_b64_tr_b16 v[24:25], v2 offset:34816
  ds_read_b64_tr_b16 v[26:27], v2 offset:35328
  s_waitcnt lgkmcnt(6)
  v_mfma_f32_32x32x16_bf16 v[240:255], v[12:15], v[92:95], v[240:255]
  v_mul_f32 v205, s30, v205
  ds_read_b64_tr_b16 v[8:9], v3 offset:34816
  ds_read_b64_tr_b16 v[10:11], v3 offset:35328
  s_waitcnt lgkmcnt(6)
  v_mfma_f32_32x32x16_bf16 v[224:239], v[16:19], v[96:99], v[224:239]
  v_mul_f32 v206, s30, v206
  ds_read_b64_tr_b16 v[12:13], v2 offset:36864
  ds_read_b64_tr_b16 v[14:15], v2 offset:37376
  s_waitcnt lgkmcnt(6)
  v_mfma_f32_32x32x16_bf16 v[240:255], v[20:23], v[96:99], v[240:255]
  ds_read_b64_tr_b16 v[16:17], v3 offset:36864
  ds_read_b64_tr_b16 v[18:19], v3 offset:37376
  s_waitcnt lgkmcnt(6)
  v_mfma_f32_32x32x16_bf16 v[224:239], v[24:27], v[100:103], v[224:239]
  v_mul_f32 v207, s30, v207
  ds_read_b64_tr_b16 v[20:21], v2 offset:38912
  ds_read_b64_tr_b16 v[22:23], v2 offset:39424
  s_waitcnt lgkmcnt(6)
  v_mfma_f32_32x32x16_bf16 v[240:255], v[8:11], v[100:103], v[240:255]
  v_cvt_pk_bf16_f32 v28, v200, v201
  ds_read_b64_tr_b16 v[24:25], v3 offset:38912
  ds_read_b64_tr_b16 v[26:27], v3 offset:39424
  s_waitcnt lgkmcnt(6)
  v_mfma_f32_32x32x16_bf16 v[224:239], v[12:15], v[104:107], v[224:239]
  v_cvt_pk_bf16_f32 v29, v202, v203
  ds_read_b64_tr_b16 v[8:9], v2 offset:40960
  ds_read_b64_tr_b16 v[10:11], v2 offset:41472
  s_waitcnt lgkmcnt(6)
  v_mfma_f32_32x32x16_bf16 v[240:255], v[16:19], v[104:107], v[240:255]
  v_cvt_pk_bf16_f32 v30, v204, v205
  ds_read_b64_tr_b16 v[12:13], v3 offset:40960
  ds_read_b64_tr_b16 v[14:15], v3 offset:41472
  s_waitcnt lgkmcnt(6)
  v_mfma_f32_32x32x16_bf16 v[224:239], v[20:23], v[108:111], v[224:239]
  v_cvt_pk_bf16_f32 v31, v206, v207
  ds_read_b64_tr_b16 v[16:17], v2 offset:43008
  ds_read_b64_tr_b16 v[18:19], v2 offset:43520
  s_waitcnt lgkmcnt(6)
  v_mfma_f32_32x32x16_bf16 v[240:255], v[24:27], v[108:111], v[240:255]
  s_add_u32 s93, s92, 65536
  ds_read_b64_tr_b16 v[20:21], v3 offset:43008
  ds_read_b64_tr_b16 v[22:23], v3 offset:43520
  s_waitcnt lgkmcnt(6)
  v_mfma_f32_32x32x16_bf16 v[224:239], v[8:11], v[112:115], v[224:239]
  buffer_store_dwordx4 v[28:31], v5, s[12:15], s93 offen sc1
  ds_read_b64_tr_b16 v[24:25], v2 offset:45056
  ds_read_b64_tr_b16 v[26:27], v2 offset:45568
  s_waitcnt lgkmcnt(6)
  v_mfma_f32_32x32x16_bf16 v[240:255], v[12:15], v[112:115], v[240:255]
  ds_read_b64_tr_b16 v[8:9], v3 offset:45056
  ds_read_b64_tr_b16 v[10:11], v3 offset:45568
  s_waitcnt lgkmcnt(6)
  v_mfma_f32_32x32x16_bf16 v[224:239], v[16:19], v[116:119], v[224:239]
  ds_read_b64_tr_b16 v[12:13], v2 offset:47104
  ds_read_b64_tr_b16 v[14:15], v2 offset:47616
  s_waitcnt lgkmcnt(6)
  v_mfma_f32_32x32x16_bf16 v[240:255], v[20:23], v[116:119], v[240:255]
  ds_read_b64_tr_b16 v[16:17], v3 offset:47104
  ds_read_b64_tr_b16 v[18:19], v3 offset:47616
  s_waitcnt lgkmcnt(6)
  v_mfma_f32_32x32x16_bf16 v[224:239], v[24:27], v[120:123], v[224:239]
  v_mul_f32 v208, s30, v208
  s_barrier
  ds_read_b64_tr_b16 v[20:21], v2 offset:49152
  ds_read_b64_tr_b16 v[22:23], v2 offset:49664
  s_waitcnt lgkmcnt(6)
  v_mfma_f32_32x32x16_bf16 v[240:255], v[8:11], v[120:123], v[240:255]
  v_mul_f32 v209, s30, v209
  ds_read_b64_tr_b16 v[24:25], v3 offset:49152
  ds_read_b64_tr_b16 v[26:27], v3 offset:49664
  s_waitcnt lgkmcnt(6)
  v_mfma_f32_32x32x16_bf16 v[224:239], v[12:15], v[124:127], v[224:239]
  v_mul_f32 v210, s30, v210
  ds_read_b64_tr_b16 v[8:9], v2 offset:51200
  ds_read_b64_tr_b16 v[10:11], v2 offset:51712
  s_waitcnt lgkmcnt(6)
  v_mfma_f32_32x32x16_bf16 v[240:255], v[16:19], v[124:127], v[240:255]
  v_mul_f32 v211, s30, v211
  ds_read_b64_tr_b16 v[12:13], v3 offset:51200
  ds_read_b64_tr_b16 v[14:15], v3 offset:51712
  s_waitcnt lgkmcnt(6)
  v_mfma_f32_32x32x16_bf16 v[224:239], v[20:23], v[128:131], v[224:239]
  v_mul_f32 v212, s30, v212
  ds_read_b64_tr_b16 v[16:17], v2 offset:53248
  ds_read_b64_tr_b16 v[18:19], v2 offset:53760
  s_waitcnt lgkmcnt(6)
  v_mfma_f32_32x32x16_bf16 v[240:255], v[24:27], v[128:131], v[240:255]
  v_mul_f32 v213, s30, v213
  ds_read_b64_tr_b16 v[20:21], v3 offset:53248
  ds_read_b64_tr_b16 v[22:23], v3 offset:53760
  s_waitcnt lgkmcnt(6)
  v_mfma_f32_32x32x16_bf16 v[224:239], v[8:11], v[132:135], v[224:239]
  v_mul_f32 v214, s30, v214
  ds_read_b64_tr_b16 v[24:25], v2 offset:55296
  ds_read_b64_tr_b16 v[26:27], v2 offset:55808
  s_waitcnt lgkmcnt(6)
  v_mfma_f32_32x32x16_bf16 v[240:255], v[12:15], v[132:135], v[240:255]
  ds_read_b64_tr_b16 v[8:9], v3 offset:55296
  ds_read_b64_tr_b16 v[10:11], v3 offset:55808
  s_waitcnt lgkmcnt(6)
  v_mfma_f32_32x32x16_bf16 v[224:239], v[16:19], v[136:139], v[224:239]
  v_mul_f32 v215, s30, v215
  ds_read_b64_tr_b16 v[12:13], v2 offset:57344
  ds_read_b64_tr_b16 v[14:15], v2 offset:57856
  s_waitcnt lgkmcnt(6)
  v_mfma_f32_32x32x16_bf16 v[240:255], v[20:23], v[136:139], v[240:255]
  v_cvt_pk_bf16_f32 v28, v208, v209
  ds_read_b64_tr_b16 v[16:17], v3 offset:57344
  ds_read_b64_tr_b16 v[18:19], v3 offset:57856
  s_waitcnt lgkmcnt(6)
  v_mfma_f32_32x32x16_bf16 v[224:239], v[24:27], v[140:143], v[224:239]
  v_cvt_pk_bf16_f32 v29, v210, v211
  ds_read_b64_tr_b16 v[20:21], v2 offset:59392
  ds_read_b64_tr_b16 v[22:23], v2 offset:59904
  s_waitcnt lgkmcnt(6)
  v_mfma_f32_32x32x16_bf16 v[240:255], v[8:11], v[140:143], v[240:255]
  v_cvt_pk_bf16_f32 v30, v212, v213
  ds_read_b64_tr_b16 v[24:25], v3 offset:59392
  ds_read_b64_tr_b16 v[26:27], v3 offset:59904
  s_waitcnt lgkmcnt(6)
  v_mfma_f32_32x32x16_bf16 v[224:239], v[12:15], v[144:147], v[224:239]
  v_cvt_pk_bf16_f32 v31, v214, v215
  ds_read_b64_tr_b16 v[8:9], v2 offset:61440
  ds_read_b64_tr_b16 v[10:11], v2 offset:61952
  s_waitcnt lgkmcnt(6)
  v_mfma_f32_32x32x16_bf16 v[240:255], v[16:19], v[144:147], v[240:255]
  s_add_u32 s93, s92, 131072
  ds_read_b64_tr_b16 v[12:13], v3 offset:61440
  ds_read_b64_tr_b16 v[14:15], v3 offset:61952
  s_waitcnt lgkmcnt(6)
  v_mfma_f32_32x32x16_bf16 v[224:239], v[20:23], v[148:151], v[224:239]
  buffer_store_dwordx4 v[28:31], v5, s[12:15], s93 offen sc1
  ds_read_b64_tr_b16 v[16:17], v2 offset:63488
  ds_read_b64_tr_b16 v[18:19], v2 offset:64000
  s_waitcnt lgkmcnt(6)
  v_mfma_f32_32x32x16_bf16 v[240:255], v[24:27], v[148:151], v[240:255]
  ds_read_b64_tr_b16 v[20:21], v3 offset:63488
  ds_read_b64_tr_b16 v[22:23], v3 offset:64000
  s_waitcnt lgkmcnt(6)
  v_mfma_f32_32x32x16_bf16 v[224:239], v[8:11], v[152:155], v[224:239]
  s_barrier
  v_add_u32 v2, 0xffffc000, v2
  v_add_u32 v3, 0xffffc000, v3
  ds_read_b64_tr_b16 v[24:25], v2 offset:0
  ds_read_b64_tr_b16 v[26:27], v2 offset:512
  s_waitcnt lgkmcnt(6)
  v_mfma_f32_32x32x16_bf16 v[240:255], v[12:15], v[152:155], v[240:255]
  ds_read_b64_tr_b16 v[8:9], v3 offset:0
  ds_read_b64_tr_b16 v[10:11], v3 offset:512
  s_waitcnt lgkmcnt(6)
  v_mfma_f32_32x32x16_bf16 v[224:239], v[16:19], v[156:159], v[224:239]
  v_mul_f32 v216, s30, v216
  ds_read_b64_tr_b16 v[12:13], v2 offset:2048
  ds_read_b64_tr_b16 v[14:15], v2 offset:2560
  s_waitcnt lgkmcnt(6)
  v_mfma_f32_32x32x16_bf16 v[240:255], v[20:23], v[156:159], v[240:255]
  v_mul_f32 v217, s30, v217
  ds_read_b64_tr_b16 v[16:17], v3 offset:2048
  ds_read_b64_tr_b16 v[18:19], v3 offset:2560
  s_waitcnt lgkmcnt(6)
  v_mfma_f32_32x32x16_bf16 v[224:239], v[24:27], v[160:163], v[224:239]
  v_mul_f32 v218, s30, v218
  ds_read_b64_tr_b16 v[20:21], v2 offset:4096
  ds_read_b64_tr_b16 v[22:23], v2 offset:4608
  s_waitcnt lgkmcnt(6)
  v_mfma_f32_32x32x16_bf16 v[240:255], v[8:11], v[160:163], v[240:255]
  v_mul_f32 v219, s30, v219
  ds_read_b64_tr_b16 v[24:25], v3 offset:4096
  ds_read_b64_tr_b16 v[26:27], v3 offset:4608
  s_waitcnt lgkmcnt(6)
  v_mfma_f32_32x32x16_bf16 v[224:239], v[12:15], v[164:167], v[224:239]
  v_mul_f32 v220, s30, v220
  ds_read_b64_tr_b16 v[8:9], v2 offset:6144
  ds_read_b64_tr_b16 v[10:11], v2 offset:6656
  s_waitcnt lgkmcnt(6)
  v_mfma_f32_32x32x16_bf16 v[240:255], v[16:19], v[164:167], v[240:255]
  v_mul_f32 v221, s30, v221
  ds_read_b64_tr_b16 v[12:13], v3 offset:6144
  ds_read_b64_tr_b16 v[14:15], v3 offset:6656
  s_waitcnt lgkmcnt(6)
  v_mfma_f32_32x32x16_bf16 v[224:239], v[20:23], v[168:171], v[224:239]
  v_mul_f32 v222, s30, v222
  ds_read_b64_tr_b16 v[16:17], v2 offset:8192
  ds_read_b64_tr_b16 v[18:19], v2 offset:8704
  s_waitcnt lgkmcnt(6)
  v_mfma_f32_32x32x16_bf16 v[240:255], v[24:27], v[168:171], v[240:255]
  ds_read_b64_tr_b16 v[20:21], v3 offset:8192
  ds_read_b64_tr_b16 v[22:23], v3 offset:8704
  s_waitcnt lgkmcnt(6)
  v_mfma_f32_32x32x16_bf16 v[224:239], v[8:11], v[172:175], v[224:239]
  v_mul_f32 v223, s30, v223
  ds_read_b64_tr_b16 v[24:25], v2 offset:10240
  ds_read_b64_tr_b16 v[26:27], v2 offset:10752
  s_waitcnt lgkmcnt(6)
  v_mfma_f32_32x32x16_bf16 v[240:255], v[12:15], v[172:175], v[240:255]
  v_cvt_pk_bf16_f32 v28, v216, v217
  ds_read_b64_tr_b16 v[8:9], v3 offset:10240
  ds_read_b64_tr_b16 v[10:11], v3 offset:10752
  s_waitcnt lgkmcnt(6)
  v_mfma_f32_32x32x16_bf16 v[224:239], v[16:19], v[176:179], v[224:239]
  v_cvt_pk_bf16_f32 v29, v218, v219
  ds_read_b64_tr_b16 v[12:13], v2 offset:12288
  ds_read_b64_tr_b16 v[14:15], v2 offset:12800
  s_waitcnt lgkmcnt(6)
  v_mfma_f32_32x32x16_bf16 v[240:255], v[20:23], v[176:179], v[240:255]
  v_cvt_pk_bf16_f32 v30, v220, v221
  ds_read_b64_tr_b16 v[16:17], v3 offset:12288
  ds_read_b64_tr_b16 v[18:19], v3 offset:12800
  s_waitcnt lgkmcnt(6)
  v_mfma_f32_32x32x16_bf16 v[224:239], v[24:27], v[180:183], v[224:239]
  v_cvt_pk_bf16_f32 v31, v222, v223
  ds_read_b64_tr_b16 v[20:21], v2 offset:14336
  ds_read_b64_tr_b16 v[22:23], v2 offset:14848
  s_waitcnt lgkmcnt(6)
  v_mfma_f32_32x32x16_bf16 v[240:255], v[8:11], v[180:183], v[240:255]
  s_add_u32 s93, s92, 196608
  ds_read_b64_tr_b16 v[24:25], v3 offset:14336
  ds_read_b64_tr_b16 v[26:27], v3 offset:14848
  s_waitcnt lgkmcnt(6)
  v_mfma_f32_32x32x16_bf16 v[224:239], v[12:15], v[184:187], v[224:239]
  buffer_store_dwordx4 v[28:31], v5, s[12:15], s93 offen sc1
  s_waitcnt lgkmcnt(4)
  v_mfma_f32_32x32x16_bf16 v[240:255], v[16:19], v[184:187], v[240:255]
  s_waitcnt lgkmcnt(2)
  v_mfma_f32_32x32x16_bf16 v[224:239], v[20:23], v[188:191], v[224:239]
  s_waitcnt lgkmcnt(0)
  v_mfma_f32_32x32x16_bf16 v[240:255], v[24:27], v[188:191], v[240:255]
  s_nop 15
  v_mul_f32 v224, s30, v224
  v_mul_f32 v225, s30, v225
  v_mul_f32 v226, s30, v226
  v_mul_f32 v227, s30, v227
  v_mul_f32 v228, s30, v228
  v_mul_f32 v229, s30, v229
  v_mul_f32 v230, s30, v230
  v_mul_f32 v231, s30, v231
  v_cvt_pk_bf16_f32 v28, v224, v225
  v_cvt_pk_bf16_f32 v29, v226, v227
  v_cvt_pk_bf16_f32 v30, v228, v229
  v_cvt_pk_bf16_f32 v31, v230, v231
  s_add_u32 s93, s92, 262144
  buffer_store_dwordx4 v[28:31], v5, s[12:15], s93 offen sc1
  s_nop 0
  v_mul_f32 v232, s30, v232
  v_mul_f32 v233, s30, v233
  v_mul_f32 v234, s30, v234
  v_mul_f32 v235, s30, v235
  v_mul_f32 v236, s30, v236
  v_mul_f32 v237, s30, v237
  v_mul_f32 v238, s30, v238
  v_mul_f32 v239, s30, v239
  v_cvt_pk_bf16_f32 v28, v232, v233
  v_cvt_pk_bf16_f32 v29, v234, v235
  v_cvt_pk_bf16_f32 v30, v236, v237
  v_cvt_pk_bf16_f32 v31, v238, v239
  s_add_u32 s93, s92, 327680
  buffer_store_dwordx4 v[28:31], v5, s[12:15], s93 offen sc1
  s_nop 0
  v_mul_f32 v240, s30, v240
  v_mul_f32 v241, s30, v241
  v_mul_f32 v242, s30, v242
  v_mul_f32 v243, s30, v243
  v_mul_f32 v244, s30, v244
  v_mul_f32 v245, s30, v245
  v_mul_f32 v246, s30, v246
  v_mul_f32 v247, s30, v247
  v_cvt_pk_bf16_f32 v28, v240, v241
  v_cvt_pk_bf16_f32 v29, v242, v243
  v_cvt_pk_bf16_f32 v30, v244, v245
  v_cvt_pk_bf16_f32 v31, v246, v247
  s_add_u32 s93, s92, 393216
  buffer_store_dwordx4 v[28:31], v5, s[12:15], s93 offen sc1
  s_nop 0
  v_mul_f32 v248, s30, v248
  v_mul_f32 v249, s30, v249
  v_mul_f32 v250, s30, v250
  v_mul_f32 v251, s30, v251
  v_mul_f32 v252, s30, v252
  v_mul_f32 v253, s30, v253
  v_mul_f32 v254, s30, v254
  v_mul_f32 v255, s30, v255
  v_cvt_pk_bf16_f32 v28, v248, v249
  v_cvt_pk_bf16_f32 v29, v250, v251
  v_cvt_pk_bf16_f32 v30, v252, v253
  v_cvt_pk_bf16_f32 v31, v254, v255
  s_add_u32 s93, s92, 458752
  buffer_store_dwordx4 v[28:31], v5, s[12:15], s93 offen sc1
  s_nop 0
  v_mbcnt_lo_u32_b32 v2, -1, 0
  v_mbcnt_hi_u32_b32 v2, -1, v2
  s_lshl_b32 s36, s3, 6
  v_add_u32 v0, s36, v2
  s_branch L_A_only_done
L_gelu_done:
  s_lshr_b32 s26, s3, 2
  s_xor_b32 s26, s26, 1
  s_and_b32 s27, s3, 3
  s_lshl_b32 s28, s59, 2
  s_add_u32 s28, s28, s27
  s_mul_i32 s23, s58, 5
  s_mul_i32 s29, s26, 3
  v_and_b32 v3, 31, v2
  v_lshrrev_b32 v4, 5, v2
  s_lshl_b32 s30, s28, 9
  v_lshl_add_u32 v6, v3, 4, s30
  s_add_u32 s31, s23, s29
  v_add_u32 v7, s31, v4
  v_lshl_add_u32 v18, v7, 15, v6
  s_add_u32 s31, s23, 2
  s_lshl_b32 s31, s31, 15
  s_lshl_b32 s32, s26, 3
  s_add_u32 s31, s31, s32
  v_add_u32 v19, s31, v6
  s_lshl_b32 s30, s27, 9
  v_add_u32 v6, s29, v4
  v_mul_u32_u24 v6, 6208, v6
  v_lshl_add_u32 v6, v3, 4, v6
  v_add_u32 v14, s30, v6
  s_add_u32 s31, s30, 12416
  s_add_u32 s31, s31, s32
  v_lshl_add_u32 v15, v3, 4, s31
  v_and_b32 v5, 3, v2
  v_bfe_u32 v6, v2, 4, 1
  v_bfe_u32 v7, v2, 2, 2
  v_and_b32 v20, 1, v5
  v_add_u32 v20, s29, v20
  v_mul_u32_u24 v20, 6208, v20
  v_lshrrev_b32 v21, 1, v5
  v_lshl_add_u32 v20, v21, 3, v20
  s_add_u32 s31, s32, 12416
  s_lshl_b32 s33, s26, 7
  s_sub_u32 s33, 31168, s33
  v_mov_b32 v21, s33
  v_mov_b32 v22, s31
  v_cmp_eq_u32 vcc, 0, v5
  v_lshl_add_u32 v7, v4, 2, v7
  s_nop 0
  v_cndmask_b32 v21, v21, v22, vcc
  v_cmp_eq_u32 vcc, 0, v6
  s_add_u32 s31, s30, 31232
  s_nop 0
  v_cndmask_b32 v20, v21, v20, vcc
  v_lshl_add_u32 v20, v7, 4, v20
  v_add_u32 v16, s31, v20
  v_and_b32 v7, 31, v2
  v_lshrrev_b32 v5, 5, v2
  v_lshlrev_b32 v5, 2, v5
  v_sub_u32 v5, v7, v5
  v_mov_b32 v6, 0xf149f2ca
  v_subrev_u32 v112, 0, v5
  v_ashrrev_i32 v112, 31, v112
  v_and_b32 v112, v6, v112
  v_xor_b32 v96, v6, v112
  v_subrev_u32 v113, 1, v5
  v_ashrrev_i32 v113, 31, v113
  v_and_b32 v113, v6, v113
  v_xor_b32 v97, v6, v113
  v_subrev_u32 v114, 2, v5
  v_ashrrev_i32 v114, 31, v114
  v_and_b32 v114, v6, v114
  v_xor_b32 v98, v6, v114
  v_subrev_u32 v115, 3, v5
  v_ashrrev_i32 v115, 31, v115
  v_and_b32 v115, v6, v115
  v_xor_b32 v99, v6, v115
  v_subrev_u32 v116, 8, v5
  v_ashrrev_i32 v116, 31, v116
  v_and_b32 v116, v6, v116
  v_xor_b32 v100, v6, v116
  v_subrev_u32 v117, 9, v5
  v_ashrrev_i32 v117, 31, v117
  v_and_b32 v117, v6, v117
  v_xor_b32 v101, v6, v117
  v_subrev_u32 v118, 10, v5
  v_ashrrev_i32 v118, 31, v118
  v_and_b32 v118, v6, v118
  v_xor_b32 v102, v6, v118
  v_subrev_u32 v119, 11, v5
  v_ashrrev_i32 v119, 31, v119
  v_and_b32 v119, v6, v119
  v_xor_b32 v103, v6, v119
  v_subrev_u32 v120, 16, v5
  v_ashrrev_i32 v120, 31, v120
  v_and_b32 v120, v6, v120
  v_xor_b32 v104, v6, v120
  v_subrev_u32 v121, 17, v5
  v_ashrrev_i32 v121, 31, v121
  v_and_b32 v121, v6, v121
  v_xor_b32 v105, v6, v121
  v_subrev_u32 v122, 18, v5
  v_ashrrev_i32 v122, 31, v122
  v_and_b32 v122, v6, v122
  v_xor_b32 v106, v6, v122
  v_subrev_u32 v123, 19, v5
  v_ashrrev_i32 v123, 31, v123
  v_and_b32 v123, v6, v123
  v_xor_b32 v107, v6, v123
  v_subrev_u32 v124, 24, v5
  v_ashrrev_i32 v124, 31, v124
  v_and_b32 v124, v6, v124
  v_xor_b32 v108, v6, v124
  v_subrev_u32 v125, 25, v5
  v_ashrrev_i32 v125, 31, v125
  v_and_b32 v125, v6, v125
  v_xor_b32 v109, v6, v125
  v_subrev_u32 v126, 26, v5
  v_ashrrev_i32 v126, 31, v126
  v_and_b32 v126, v6, v126
  v_xor_b32 v110, v6, v126
  v_subrev_u32 v127, 27, v5
  v_ashrrev_i32 v127, 31, v127
  v_and_b32 v127, v6, v127
  v_xor_b32 v111, v6, v127
  s_barrier
  s_branch L_attn
L_A_only_done:
  s_lshl_b32 s42, s56, 7
  s_lshl_b32 s22, s57, 2
  s_add_u32 s42, s42, s22
  s_add_u32 s42, s42, 0
  s_cmp_eq_u32 s3, 0
  s_cbranch_scc0 L_sgr_10
  v_mov_b32 v5, 0
  buffer_load_dword v4, v5, s[48:51], 0 offen sc1
  s_waitcnt vmcnt(0)
  s_mov_b32 s43, 0
L_rdyt_11:
  v_cmp_eq_u32 vcc, 0, v4
  s_nop 0
  s_cmp_eq_u64 vcc, 0
  s_cbranch_scc1 L_rdyd_12
  s_add_u32 s43, s43, 1
  s_cmp_ge_u32 s43, 200000
  s_cbranch_scc1 L_rdyd_12
  s_sleep 2
  buffer_load_dword v4, v5, s[48:51], 0 offen sc1
  s_waitcnt vmcnt(0)
  s_branch L_rdyt_11
L_rdyd_12:
L_sgr_10:
  s_waitcnt vmcnt(0) lgkmcnt(0)
  s_barrier
  s_cmp_eq_u32 s3, 0
  s_cbranch_scc0 L_sg_9
  v_mov_b32 v4, 1
  v_mov_b32 v5, 0
  v_cmp_eq_u32 vcc, 0, v2
  s_and_saveexec_b64 s[36:37], vcc
  buffer_store_dword v4, v5, s[44:47], s42 offen sc1
  s_mov_b64 exec, s[36:37]
L_sg_9:
  s_mov_b32 s52, s56
  s_add_u32 s32, s86, 20971520
  s_addc_u32 s33, s87, 0
  s_mov_b32 s34, 3031040
  s_mov_b32 s35, 0x20000
  s_mov_b32 s26, 107374183
  s_add_u32 s25, s3, 0
  s_lshl_b32 s27, s25, 6
  v_add_u32 v3, s27, v2
  v_mul_hi_u32 v4, v3, s26
  v_mul_u32_u24 v5, 40, v4
  v_sub_u32 v5, v3, v5
  v_mul_u32_u24 v4, 1280, v4
  v_lshl_add_u32 v8, v5, 4, v4
  s_add_u32 s25, s3, 8
  s_lshl_b32 s27, s25, 6
  v_add_u32 v3, s27, v2
  v_mul_hi_u32 v4, v3, s26
  v_mul_u32_u24 v5, 40, v4
  v_sub_u32 v5, v3, v5
  v_mul_u32_u24 v4, 1280, v4
  v_lshl_add_u32 v9, v5, 4, v4
  s_add_u32 s25, s3, 16
  s_lshl_b32 s27, s25, 6
  v_add_u32 v3, s27, v2
  v_mul_hi_u32 v4, v3, s26
  v_mul_u32_u24 v5, 40, v4
  v_sub_u32 v5, v3, v5
  v_mul_u32_u24 v4, 1280, v4
  v_lshl_add_u32 v10, v5, 4, v4
  s_add_u32 s53, s52, 80
  s_mov_b32 s24, 0
L_rpl_13:
  s_lshr_b32 s20, s53, 1
  s_and_b32 s21, s53, 1
  s_cmp_lt_u32 s20, 54
  s_cselect_b32 s12, s76, s68
  s_cselect_b32 s13, s77, s69
  s_mov_b32 s14, 819200
  s_cselect_b32 s14, 2211840, s14
  s_mov_b32 s15, 0x20000
  s_cselect_b32 s22, 0, 54
  s_sub_u32 s22, s20, s22
  s_mul_i32 s22, s22, 40960
  s_mul_i32 s23, s21, 640
  s_add_u32 s22, s22, s23
  s_add_u32 s25, s3, 0
  s_lshl_b32 s25, s25, 10
  s_add_u32 m0, s25, s24
  s_nop 0
  buffer_load_dwordx4 v8, s[12:15], s22 offen lds
L_rp_14:
  s_add_u32 s25, s3, 8
  s_lshl_b32 s25, s25, 10
  s_add_u32 m0, s25, s24
  s_nop 0
  buffer_load_dwordx4 v9, s[12:15], s22 offen lds
L_rp_15:
  s_cmp_ge_u32 s3, 4
  s_cbranch_scc1 L_rp_16
  s_add_u32 s25, s3, 16
  s_lshl_b32 s25, s25, 10
  s_add_u32 m0, s25, s24
  s_nop 0
  buffer_load_dwordx4 v10, s[12:15], s22 offen lds
L_rp_16:
  s_add_u32 s24, s24, 20480
  s_add_u32 s53, s53, 16
  s_cmp_lt_u32 s53, 148
  s_cbranch_scc1 L_rpl_13
  v_lshrrev_b32 v3, 4, v2
  v_bfe_u32 v4, v2, 2, 2
  v_and_b32 v5, 3, v2
  v_lshl_add_u32 v3, v3, 3, v4
  v_mul_u32_u24 v3, 640, v3
  v_lshl_add_u32 v3, v5, 3, v3
  v_lshlrev_b32 v6, 4, v2
  s_waitcnt vmcnt(0)
  s_barrier
  s_add_u32 s53, s52, 80
  s_mov_b32 s24, 0
L_rps_17:
  s_lshr_b32 s20, s53, 1
  s_and_b32 s21, s53, 1
  s_add_u32 s25, s3, 0
  s_lshl_b32 s27, s25, 5
  s_add_u32 s27, s27, s24
  v_add_u32 v4, s27, v3
  ds_read_b64_tr_b16 v[12:13], v4
  ds_read_b64_tr_b16 v[14:15], v4 offset:2560
  s_mul_i32 s28, s21, 20
  s_add_u32 s28, s28, s25
  s_mul_i32 s29, s28, 52
  s_lshr_b32 s29, s29, 8
  s_mul_i32 s30, s29, 5
  s_sub_u32 s30, s28, s30
  s_mul_i32 s29, s29, 74
  s_add_u32 s29, s29, s20
  s_mul_i32 s29, s29, 5
  s_add_u32 s29, s29, s30
  s_lshl_b32 s29, s29, 10
  s_waitcnt lgkmcnt(0)
  buffer_store_dwordx4 v[12:15], v6, s[32:35], s29 offen sc1
L_rq_18:
  s_add_u32 s25, s3, 8
  s_lshl_b32 s27, s25, 5
  s_add_u32 s27, s27, s24
  v_add_u32 v4, s27, v3
  ds_read_b64_tr_b16 v[16:17], v4
  ds_read_b64_tr_b16 v[18:19], v4 offset:2560
  s_mul_i32 s28, s21, 20
  s_add_u32 s28, s28, s25
  s_mul_i32 s29, s28, 52
  s_lshr_b32 s29, s29, 8
  s_mul_i32 s30, s29, 5
  s_sub_u32 s30, s28, s30
  s_mul_i32 s29, s29, 74
  s_add_u32 s29, s29, s20
  s_mul_i32 s29, s29, 5
  s_add_u32 s29, s29, s30
  s_lshl_b32 s29, s29, 10
  s_waitcnt lgkmcnt(0)
  buffer_store_dwordx4 v[16:19], v6, s[32:35], s29 offen sc1
L_rq_19:
  s_cmp_ge_u32 s3, 4
  s_cbranch_scc1 L_rq_20
  s_add_u32 s25, s3, 16
  s_lshl_b32 s27, s25, 5
  s_add_u32 s27, s27, s24
  v_add_u32 v4, s27, v3
  ds_read_b64_tr_b16 v[20:21], v4
  ds_read_b64_tr_b16 v[22:23], v4 offset:2560
  s_mul_i32 s28, s21, 20
  s_add_u32 s28, s28, s25
  s_mul_i32 s29, s28, 52
  s_lshr_b32 s29, s29, 8
  s_mul_i32 s30, s29, 5
  s_sub_u32 s30, s28, s30
  s_mul_i32 s29, s29, 74
  s_add_u32 s29, s29, s20
  s_mul_i32 s29, s29, 5
  s_add_u32 s29, s29, s30
  s_lshl_b32 s29, s29, 10
  s_waitcnt lgkmcnt(0)
  buffer_store_dwordx4 v[20:23], v6, s[32:35], s29 offen sc1
L_rq_20:
  s_add_u32 s24, s24, 20480
  s_add_u32 s53, s53, 16
  s_cmp_lt_u32 s53, 148
  s_cbranch_scc1 L_rps_17
  s_lshl_b32 s42, s52, 2
  s_add_u32 s42, s42, 6336
  s_waitcnt vmcnt(0) lgkmcnt(0)
  s_barrier
  s_cmp_eq_u32 s3, 0
  s_cbranch_scc0 L_sg_21
  v_mov_b32 v4, 1
  v_mov_b32 v5, 0
  v_cmp_eq_u32 vcc, 0, v2
  s_and_saveexec_b64 s[36:37], vcc
  buffer_store_dword v4, v5, s[44:47], s42 offen sc1
  s_mov_b64 exec, s[36:37]
L_sg_21:
  s_branch L_aux_done
L_aux1:
  s_mov_b32 s54, 0
  s_waitcnt lgkmcnt(0)
  s_add_u32 s44, s86, 26214400
  s_addc_u32 s45, s87, 0
  s_mov_b32 s46, 7296
  s_mov_b32 s47, 0x20000
  s_mov_b32 s48, s84
  s_mov_b32 s49, s85
  s_mov_b32 s50, 256
  s_mov_b32 s51, 0x20000
  s_and_b32 s20, s2, 7
  s_lshr_b32 s21, s2, 3
  s_and_b32 s22, s21, 1
  s_lshl_b32 s20, s20, 1
  s_add_u32 s58, s20, s22
  s_lshr_b32 s59, s21, 1
  s_and_b32 s20, s2, 7
  s_lshr_b32 s21, s2, 3
  s_and_b32 s22, s20, 1
  s_lshl_b32 s22, s22, 2
  s_and_b32 s23, s21, 3
  s_add_u32 s61, s22, s23
  s_lshr_b32 s20, s20, 1
  s_lshl_b32 s20, s20, 3
  s_lshr_b32 s21, s21, 2
  s_add_u32 s60, s20, s21
  s_cmp_eq_u32 s2, 15
  s_cbranch_scc0 L_noinit
  v_lshlrev_b32 v3, 4, v0
  v_mov_b32 v4, 0
  v_mov_b32 v5, 0
  v_mov_b32 v6, 0
  v_mov_b32 v7, 0
  buffer_store_dwordx4 v[4:7], v3, s[44:47], 0 offen sc1
  s_waitcnt vmcnt(0)
  s_barrier
  s_cmp_eq_u32 s3, 0
  s_cbranch_scc0 L_fi_22
  v_mov_b32 v4, 1
  v_mov_b32 v3, 0
  v_cmp_eq_u32 vcc, 0, v2
  s_and_saveexec_b64 s[36:37], vcc
  buffer_store_dword v4, v3, s[48:51], 0 offen sc1
  s_mov_b64 exec, s[36:37]
L_fi_22:
L_noinit:
  s_mov_b32 s52, s2
  s_cmp_ge_u32 s52, 14
  s_cbranch_scc1 L_nocolsum
  s_mov_b32 s16, s72
  s_mov_b32 s17, s73
  s_mov_b32 s18, 2211840
  s_mov_b32 s19, 0x20000
  s_add_u32 s32, s86, 25165824
  s_addc_u32 s33, s87, 0
  s_mov_b32 s34, 40960
  s_mov_b32 s35, 0x20000
  v_lshrrev_b32 v3, 4, v2
  v_and_b32 v4, 15, v2
  s_lshl_b32 s21, s3, 2
  v_add_u32 v13, s21, v3
  v_mul_u32_u24 v14, 3456, v13
  v_lshl_add_u32 v14, v4, 4, v14
  s_lshl_b32 s23, s52, 8
  buffer_load_dwordx4 v[40:43], v14, s[16:19], s23 offen
  s_add_u32 s23, s23, 110592
  buffer_load_dwordx4 v[44:47], v14, s[16:19], s23 offen
  s_add_u32 s23, s23, 110592
  buffer_load_dwordx4 v[48:51], v14, s[16:19], s23 offen
  s_add_u32 s23, s23, 110592
  buffer_load_dwordx4 v[52:55], v14, s[16:19], s23 offen
  s_add_u32 s23, s23, 110592
  buffer_load_dwordx4 v[56:59], v14, s[16:19], s23 offen
  s_add_u32 s23, s23, 110592
  buffer_load_dwordx4 v[60:63], v14, s[16:19], s23 offen
  s_add_u32 s23, s23, 110592
  buffer_load_dwordx4 v[64:67], v14, s[16:19], s23 offen
  s_add_u32 s23, s23, 110592
  buffer_load_dwordx4 v[68:71], v14, s[16:19], s23 offen
  s_add_u32 s23, s23, 110592
  buffer_load_dwordx4 v[72:75], v14, s[16:19], s23 offen
  s_add_u32 s23, s23, 110592
  buffer_load_dwordx4 v[76:79], v14, s[16:19], s23 offen
  s_add_u32 s23, s23, 110592
  buffer_load_dwordx4 v[80:83], v14, s[16:19], s23 offen
  s_add_u32 s23, s23, 110592
  buffer_load_dwordx4 v[84:87], v14, s[16:19], s23 offen
  s_add_u32 s23, s23, 110592
  buffer_load_dwordx4 v[88:91], v14, s[16:19], s23 offen
  s_add_u32 s23, s23, 110592
  buffer_load_dwordx4 v[92:95], v14, s[16:19], s23 offen
  s_add_u32 s23, s23, 110592
  buffer_load_dwordx4 v[96:99], v14, s[16:19], s23 offen
  s_add_u32 s23, s23, 110592
  buffer_load_dwordx4 v[100:103], v14, s[16:19], s23 offen
  s_add_u32 s23, s23, 110592
  buffer_load_dwordx4 v[104:107], v14, s[16:19], s23 offen
  s_add_u32 s23, s23, 110592
  buffer_load_dwordx4 v[108:111], v14, s[16:19], s23 offen
  s_add_u32 s23, s23, 110592
  buffer_load_dwordx4 v[112:115], v14, s[16:19], s23 offen
  s_add_u32 s23, s23, 110592
  buffer_load_dwordx4 v[116:119], v14, s[16:19], s23 offen
  s_add_u32 s23, s23, 110592
  v_mov_b32 v28, 0
  v_mov_b32 v29, 0
  v_mov_b32 v30, 0
  v_mov_b32 v31, 0
  v_mov_b32 v32, 0
  v_mov_b32 v33, 0
  v_mov_b32 v34, 0
  v_mov_b32 v35, 0
  s_waitcnt vmcnt(19)
  v_lshlrev_b32 v8, 16, v40
  v_and_b32 v9, 0xffff0000, v40
  v_add_f32 v28, v28, v8
  v_add_f32 v29, v29, v9
  v_lshlrev_b32 v8, 16, v41
  v_and_b32 v9, 0xffff0000, v41
  v_add_f32 v30, v30, v8
  v_add_f32 v31, v31, v9
  v_lshlrev_b32 v8, 16, v42
  v_and_b32 v9, 0xffff0000, v42
  v_add_f32 v32, v32, v8
  v_add_f32 v33, v33, v9
  v_lshlrev_b32 v8, 16, v43
  v_and_b32 v9, 0xffff0000, v43
  v_add_f32 v34, v34, v8
  v_add_f32 v35, v35, v9
  s_waitcnt vmcnt(18)
  v_lshlrev_b32 v8, 16, v44
  v_and_b32 v9, 0xffff0000, v44
  v_add_f32 v28, v28, v8
  v_add_f32 v29, v29, v9
  v_lshlrev_b32 v8, 16, v45
  v_and_b32 v9, 0xffff0000, v45
  v_add_f32 v30, v30, v8
  v_add_f32 v31, v31, v9
  v_lshlrev_b32 v8, 16, v46
  v_and_b32 v9, 0xffff0000, v46
  v_add_f32 v32, v32, v8
  v_add_f32 v33, v33, v9
  v_lshlrev_b32 v8, 16, v47
  v_and_b32 v9, 0xffff0000, v47
  v_add_f32 v34, v34, v8
  v_add_f32 v35, v35, v9
  s_waitcnt vmcnt(17)
  v_lshlrev_b32 v8, 16, v48
  v_and_b32 v9, 0xffff0000, v48
  v_add_f32 v28, v28, v8
  v_add_f32 v29, v29, v9
  v_lshlrev_b32 v8, 16, v49
  v_and_b32 v9, 0xffff0000, v49
  v_add_f32 v30, v30, v8
  v_add_f32 v31, v31, v9
  v_lshlrev_b32 v8, 16, v50
  v_and_b32 v9, 0xffff0000, v50
  v_add_f32 v32, v32, v8
  v_add_f32 v33, v33, v9
  v_lshlrev_b32 v8, 16, v51
  v_and_b32 v9, 0xffff0000, v51
  v_add_f32 v34, v34, v8
  v_add_f32 v35, v35, v9
  s_waitcnt vmcnt(16)
  v_lshlrev_b32 v8, 16, v52
  v_and_b32 v9, 0xffff0000, v52
  v_add_f32 v28, v28, v8
  v_add_f32 v29, v29, v9
  v_lshlrev_b32 v8, 16, v53
  v_and_b32 v9, 0xffff0000, v53
  v_add_f32 v30, v30, v8
  v_add_f32 v31, v31, v9
  v_lshlrev_b32 v8, 16, v54
  v_and_b32 v9, 0xffff0000, v54
  v_add_f32 v32, v32, v8
  v_add_f32 v33, v33, v9
  v_lshlrev_b32 v8, 16, v55
  v_and_b32 v9, 0xffff0000, v55
  v_add_f32 v34, v34, v8
  v_add_f32 v35, v35, v9
  s_waitcnt vmcnt(15)
  v_lshlrev_b32 v8, 16, v56
  v_and_b32 v9, 0xffff0000, v56
  v_add_f32 v28, v28, v8
  v_add_f32 v29, v29, v9
  v_lshlrev_b32 v8, 16, v57
  v_and_b32 v9, 0xffff0000, v57
  v_add_f32 v30, v30, v8
  v_add_f32 v31, v31, v9
  v_lshlrev_b32 v8, 16, v58
  v_and_b32 v9, 0xffff0000, v58
  v_add_f32 v32, v32, v8
  v_add_f32 v33, v33, v9
  v_lshlrev_b32 v8, 16, v59
  v_and_b32 v9, 0xffff0000, v59
  v_add_f32 v34, v34, v8
  v_add_f32 v35, v35, v9
  s_waitcnt vmcnt(14)
  v_lshlrev_b32 v8, 16, v60
  v_and_b32 v9, 0xffff0000, v60
  v_add_f32 v28, v28, v8
  v_add_f32 v29, v29, v9
  v_lshlrev_b32 v8, 16, v61
  v_and_b32 v9, 0xffff0000, v61
  v_add_f32 v30, v30, v8
  v_add_f32 v31, v31, v9
  v_lshlrev_b32 v8, 16, v62
  v_and_b32 v9, 0xffff0000, v62
  v_add_f32 v32, v32, v8
  v_add_f32 v33, v33, v9
  v_lshlrev_b32 v8, 16, v63
  v_and_b32 v9, 0xffff0000, v63
  v_add_f32 v34, v34, v8
  v_add_f32 v35, v35, v9
  s_waitcnt vmcnt(13)
  v_lshlrev_b32 v8, 16, v64
  v_and_b32 v9, 0xffff0000, v64
  v_add_f32 v28, v28, v8
  v_add_f32 v29, v29, v9
  v_lshlrev_b32 v8, 16, v65
  v_and_b32 v9, 0xffff0000, v65
  v_add_f32 v30, v30, v8
  v_add_f32 v31, v31, v9
  v_lshlrev_b32 v8, 16, v66
  v_and_b32 v9, 0xffff0000, v66
  v_add_f32 v32, v32, v8
  v_add_f32 v33, v33, v9
  v_lshlrev_b32 v8, 16, v67
  v_and_b32 v9, 0xffff0000, v67
  v_add_f32 v34, v34, v8
  v_add_f32 v35, v35, v9
  s_waitcnt vmcnt(12)
  v_lshlrev_b32 v8, 16, v68
  v_and_b32 v9, 0xffff0000, v68
  v_add_f32 v28, v28, v8
  v_add_f32 v29, v29, v9
  v_lshlrev_b32 v8, 16, v69
  v_and_b32 v9, 0xffff0000, v69
  v_add_f32 v30, v30, v8
  v_add_f32 v31, v31, v9
  v_lshlrev_b32 v8, 16, v70
  v_and_b32 v9, 0xffff0000, v70
  v_add_f32 v32, v32, v8
  v_add_f32 v33, v33, v9
  v_lshlrev_b32 v8, 16, v71
  v_and_b32 v9, 0xffff0000, v71
  v_add_f32 v34, v34, v8
  v_add_f32 v35, v35, v9
  s_waitcnt vmcnt(11)
  v_lshlrev_b32 v8, 16, v72
  v_and_b32 v9, 0xffff0000, v72
  v_add_f32 v28, v28, v8
  v_add_f32 v29, v29, v9
  v_lshlrev_b32 v8, 16, v73
  v_and_b32 v9, 0xffff0000, v73
  v_add_f32 v30, v30, v8
  v_add_f32 v31, v31, v9
  v_lshlrev_b32 v8, 16, v74
  v_and_b32 v9, 0xffff0000, v74
  v_add_f32 v32, v32, v8
  v_add_f32 v33, v33, v9
  v_lshlrev_b32 v8, 16, v75
  v_and_b32 v9, 0xffff0000, v75
  v_add_f32 v34, v34, v8
  v_add_f32 v35, v35, v9
  s_waitcnt vmcnt(10)
  v_lshlrev_b32 v8, 16, v76
  v_and_b32 v9, 0xffff0000, v76
  v_add_f32 v28, v28, v8
  v_add_f32 v29, v29, v9
  v_lshlrev_b32 v8, 16, v77
  v_and_b32 v9, 0xffff0000, v77
  v_add_f32 v30, v30, v8
  v_add_f32 v31, v31, v9
  v_lshlrev_b32 v8, 16, v78
  v_and_b32 v9, 0xffff0000, v78
  v_add_f32 v32, v32, v8
  v_add_f32 v33, v33, v9
  v_lshlrev_b32 v8, 16, v79
  v_and_b32 v9, 0xffff0000, v79
  v_add_f32 v34, v34, v8
  v_add_f32 v35, v35, v9
  s_waitcnt vmcnt(9)
  v_lshlrev_b32 v8, 16, v80
  v_and_b32 v9, 0xffff0000, v80
  v_add_f32 v28, v28, v8
  v_add_f32 v29, v29, v9
  v_lshlrev_b32 v8, 16, v81
  v_and_b32 v9, 0xffff0000, v81
  v_add_f32 v30, v30, v8
  v_add_f32 v31, v31, v9
  v_lshlrev_b32 v8, 16, v82
  v_and_b32 v9, 0xffff0000, v82
  v_add_f32 v32, v32, v8
  v_add_f32 v33, v33, v9
  v_lshlrev_b32 v8, 16, v83
  v_and_b32 v9, 0xffff0000, v83
  v_add_f32 v34, v34, v8
  v_add_f32 v35, v35, v9
  s_waitcnt vmcnt(8)
  v_lshlrev_b32 v8, 16, v84
  v_and_b32 v9, 0xffff0000, v84
  v_add_f32 v28, v28, v8
  v_add_f32 v29, v29, v9
  v_lshlrev_b32 v8, 16, v85
  v_and_b32 v9, 0xffff0000, v85
  v_add_f32 v30, v30, v8
  v_add_f32 v31, v31, v9
  v_lshlrev_b32 v8, 16, v86
  v_and_b32 v9, 0xffff0000, v86
  v_add_f32 v32, v32, v8
  v_add_f32 v33, v33, v9
  v_lshlrev_b32 v8, 16, v87
  v_and_b32 v9, 0xffff0000, v87
  v_add_f32 v34, v34, v8
  v_add_f32 v35, v35, v9
  s_waitcnt vmcnt(7)
  v_lshlrev_b32 v8, 16, v88
  v_and_b32 v9, 0xffff0000, v88
  v_add_f32 v28, v28, v8
  v_add_f32 v29, v29, v9
  v_lshlrev_b32 v8, 16, v89
  v_and_b32 v9, 0xffff0000, v89
  v_add_f32 v30, v30, v8
  v_add_f32 v31, v31, v9
  v_lshlrev_b32 v8, 16, v90
  v_and_b32 v9, 0xffff0000, v90
  v_add_f32 v32, v32, v8
  v_add_f32 v33, v33, v9
  v_lshlrev_b32 v8, 16, v91
  v_and_b32 v9, 0xffff0000, v91
  v_add_f32 v34, v34, v8
  v_add_f32 v35, v35, v9
  s_waitcnt vmcnt(6)
  v_lshlrev_b32 v8, 16, v92
  v_and_b32 v9, 0xffff0000, v92
  v_add_f32 v28, v28, v8
  v_add_f32 v29, v29, v9
  v_lshlrev_b32 v8, 16, v93
  v_and_b32 v9, 0xffff0000, v93
  v_add_f32 v30, v30, v8
  v_add_f32 v31, v31, v9
  v_lshlrev_b32 v8, 16, v94
  v_and_b32 v9, 0xffff0000, v94
  v_add_f32 v32, v32, v8
  v_add_f32 v33, v33, v9
  v_lshlrev_b32 v8, 16, v95
  v_and_b32 v9, 0xffff0000, v95
  v_add_f32 v34, v34, v8
  v_add_f32 v35, v35, v9
  s_waitcnt vmcnt(5)
  v_lshlrev_b32 v8, 16, v96
  v_and_b32 v9, 0xffff0000, v96
  v_add_f32 v28, v28, v8
  v_add_f32 v29, v29, v9
  v_lshlrev_b32 v8, 16, v97
  v_and_b32 v9, 0xffff0000, v97
  v_add_f32 v30, v30, v8
  v_add_f32 v31, v31, v9
  v_lshlrev_b32 v8, 16, v98
  v_and_b32 v9, 0xffff0000, v98
  v_add_f32 v32, v32, v8
  v_add_f32 v33, v33, v9
  v_lshlrev_b32 v8, 16, v99
  v_and_b32 v9, 0xffff0000, v99
  v_add_f32 v34, v34, v8
  v_add_f32 v35, v35, v9
  s_waitcnt vmcnt(4)
  v_lshlrev_b32 v8, 16, v100
  v_and_b32 v9, 0xffff0000, v100
  v_add_f32 v28, v28, v8
  v_add_f32 v29, v29, v9
  v_lshlrev_b32 v8, 16, v101
  v_and_b32 v9, 0xffff0000, v101
  v_add_f32 v30, v30, v8
  v_add_f32 v31, v31, v9
  v_lshlrev_b32 v8, 16, v102
  v_and_b32 v9, 0xffff0000, v102
  v_add_f32 v32, v32, v8
  v_add_f32 v33, v33, v9
  v_lshlrev_b32 v8, 16, v103
  v_and_b32 v9, 0xffff0000, v103
  v_add_f32 v34, v34, v8
  v_add_f32 v35, v35, v9
  s_waitcnt vmcnt(3)
  v_lshlrev_b32 v8, 16, v104
  v_and_b32 v9, 0xffff0000, v104
  v_add_f32 v28, v28, v8
  v_add_f32 v29, v29, v9
  v_lshlrev_b32 v8, 16, v105
  v_and_b32 v9, 0xffff0000, v105
  v_add_f32 v30, v30, v8
  v_add_f32 v31, v31, v9
  v_lshlrev_b32 v8, 16, v106
  v_and_b32 v9, 0xffff0000, v106
  v_add_f32 v32, v32, v8
  v_add_f32 v33, v33, v9
  v_lshlrev_b32 v8, 16, v107
  v_and_b32 v9, 0xffff0000, v107
  v_add_f32 v34, v34, v8
  v_add_f32 v35, v35, v9
  s_waitcnt vmcnt(2)
  v_lshlrev_b32 v8, 16, v108
  v_and_b32 v9, 0xffff0000, v108
  v_add_f32 v28, v28, v8
  v_add_f32 v29, v29, v9
  v_lshlrev_b32 v8, 16, v109
  v_and_b32 v9, 0xffff0000, v109
  v_add_f32 v30, v30, v8
  v_add_f32 v31, v31, v9
  v_lshlrev_b32 v8, 16, v110
  v_and_b32 v9, 0xffff0000, v110
  v_add_f32 v32, v32, v8
  v_add_f32 v33, v33, v9
  v_lshlrev_b32 v8, 16, v111
  v_and_b32 v9, 0xffff0000, v111
  v_add_f32 v34, v34, v8
  v_add_f32 v35, v35, v9
  s_waitcnt vmcnt(1)
  v_lshlrev_b32 v8, 16, v112
  v_and_b32 v9, 0xffff0000, v112
  v_add_f32 v28, v28, v8
  v_add_f32 v29, v29, v9
  v_lshlrev_b32 v8, 16, v113
  v_and_b32 v9, 0xffff0000, v113
  v_add_f32 v30, v30, v8
  v_add_f32 v31, v31, v9
  v_lshlrev_b32 v8, 16, v114
  v_and_b32 v9, 0xffff0000, v114
  v_add_f32 v32, v32, v8
  v_add_f32 v33, v33, v9
  v_lshlrev_b32 v8, 16, v115
  v_and_b32 v9, 0xffff0000, v115
  v_add_f32 v34, v34, v8
  v_add_f32 v35, v35, v9
  s_waitcnt vmcnt(0)
  v_lshlrev_b32 v8, 16, v116
  v_and_b32 v9, 0xffff0000, v116
  v_add_f32 v28, v28, v8
  v_add_f32 v29, v29, v9
  v_lshlrev_b32 v8, 16, v117
  v_and_b32 v9, 0xffff0000, v117
  v_add_f32 v30, v30, v8
  v_add_f32 v31, v31, v9
  v_lshlrev_b32 v8, 16, v118
  v_and_b32 v9, 0xffff0000, v118
  v_add_f32 v32, v32, v8
  v_add_f32 v33, v33, v9
  v_lshlrev_b32 v8, 16, v119
  v_and_b32 v9, 0xffff0000, v119
  v_add_f32 v34, v34, v8
  v_add_f32 v35, v35, v9
  v_lshlrev_b32 v7, 9, v13
  v_lshl_add_u32 v7, v4, 5, v7
  ds_write_b128 v7, v[28:31]
  ds_write_b128 v7, v[32:35] offset:16
  s_waitcnt lgkmcnt(0)
  s_barrier
  s_cmp_ge_u32 s3, 2
  s_cbranch_scc1 L_cs_23
  v_lshlrev_b32 v7, 2, v0
  ds_read_b32 v40, v7 offset:0
  ds_read_b32 v41, v7 offset:512
  ds_read_b32 v42, v7 offset:1024
  ds_read_b32 v43, v7 offset:1536
  ds_read_b32 v44, v7 offset:2048
  ds_read_b32 v45, v7 offset:2560
  ds_read_b32 v46, v7 offset:3072
  ds_read_b32 v47, v7 offset:3584
  ds_read_b32 v48, v7 offset:4096
  ds_read_b32 v49, v7 offset:4608
  ds_read_b32 v50, v7 offset:5120
  ds_read_b32 v51, v7 offset:5632
  ds_read_b32 v52, v7 offset:6144
  ds_read_b32 v53, v7 offset:6656
  ds_read_b32 v54, v7 offset:7168
  ds_read_b32 v55, v7 offset:7680
  ds_read_b32 v56, v7 offset:8192
  ds_read_b32 v57, v7 offset:8704
  ds_read_b32 v58, v7 offset:9216
  ds_read_b32 v59, v7 offset:9728
  ds_read_b32 v60, v7 offset:10240
  ds_read_b32 v61, v7 offset:10752
  ds_read_b32 v62, v7 offset:11264
  ds_read_b32 v63, v7 offset:11776
  ds_read_b32 v64, v7 offset:12288
  ds_read_b32 v65, v7 offset:12800
  ds_read_b32 v66, v7 offset:13312
  ds_read_b32 v67, v7 offset:13824
  ds_read_b32 v68, v7 offset:14336
  ds_read_b32 v69, v7 offset:14848
  ds_read_b32 v70, v7 offset:15360
  ds_read_b32 v71, v7 offset:15872
  s_lshl_b32 s21, s52, 7
  v_add_u32 v8, s21, v0
  v_lshlrev_b32 v9, 1, v8
  s_mov_b32 s16, s74
  s_mov_b32 s17, s75
  s_mov_b32 s18, 3456
  s_mov_b32 s19, 0x20000
  buffer_load_ushort v20, v9, s[16:19], 0 offen
  s_waitcnt lgkmcnt(0)
  v_add_f32 v40, v40, v41
  v_add_f32 v40, v40, v42
  v_add_f32 v40, v40, v43
  v_add_f32 v40, v40, v44
  v_add_f32 v40, v40, v45
  v_add_f32 v40, v40, v46
  v_add_f32 v40, v40, v47
  v_add_f32 v40, v40, v48
  v_add_f32 v40, v40, v49
  v_add_f32 v40, v40, v50
  v_add_f32 v40, v40, v51
  v_add_f32 v40, v40, v52
  v_add_f32 v40, v40, v53
  v_add_f32 v40, v40, v54
  v_add_f32 v40, v40, v55
  v_add_f32 v40, v40, v56
  v_add_f32 v40, v40, v57
  v_add_f32 v40, v40, v58
  v_add_f32 v40, v40, v59
  v_add_f32 v40, v40, v60
  v_add_f32 v40, v40, v61
  v_add_f32 v40, v40, v62
  v_add_f32 v40, v40, v63
  v_add_f32 v40, v40, v64
  v_add_f32 v40, v40, v65
  v_add_f32 v40, v40, v66
  v_add_f32 v40, v40, v67
  v_add_f32 v40, v40, v68
  v_add_f32 v40, v40, v69
  v_add_f32 v40, v40, v70
  v_add_f32 v40, v40, v71
  v_lshlrev_b32 v8, 2, v8
  v_add_u32 v9, 32768, v8
  v_add_u32 v8, 24576, v8
  s_waitcnt vmcnt(0)
  v_lshlrev_b32 v20, 16, v20
  buffer_store_dword v40, v8, s[32:35], 0 offen sc1
  buffer_store_dword v20, v9, s[32:35], 0 offen sc1
L_cs_23:
L_nocolsum:
  s_mov_b32 s12, s64
  s_mov_b32 s13, s65
  s_mov_b32 s14, 2621440
  s_mov_b32 s15, 0x20000
  s_mov_b32 s28, s80
  s_mov_b32 s29, s81
  s_mov_b32 s30, 1280
  s_mov_b32 s31, 0x20000
  s_add_u32 s32, s86, 25165824
  s_addc_u32 s33, s87, 0
  s_mov_b32 s34, 40960
  s_mov_b32 s35, 0x20000
  v_lshrrev_b32 v3, 4, v2
  v_and_b32 v4, 15, v2
  s_lshl_b32 s21, s3, 2
  v_add_u32 v13, s21, v3
  s_lshl_b32 s20, s52, 7
  v_add_u32 v5, s20, v13
  v_lshlrev_b32 v7, 4, v4
  v_mul_u32_u24 v6, 1280, v5
  v_add_u32 v6, v6, v7
  buffer_load_dwordx4 v[120:123], v7, s[28:31], 0 offen offset:0
  buffer_load_dwordx4 v[124:127], v7, s[28:31], 0 offen offset:256
  buffer_load_dwordx4 v[128:131], v7, s[28:31], 0 offen offset:512
  buffer_load_dwordx4 v[132:135], v7, s[28:31], 0 offen offset:768
  buffer_load_dwordx4 v[136:139], v7, s[28:31], 0 offen offset:1024
  s_mov_b32 s22, 0
  buffer_load_dwordx4 v[40:43], v6, s[12:15], s22 offen offset:0
  buffer_load_dwordx4 v[44:47], v6, s[12:15], s22 offen offset:256
  buffer_load_dwordx4 v[48:51], v6, s[12:15], s22 offen offset:512
  buffer_load_dwordx4 v[52:55], v6, s[12:15], s22 offen offset:768
  buffer_load_dwordx4 v[56:59], v6, s[12:15], s22 offen offset:1024
  s_mov_b32 s22, 40960
  buffer_load_dwordx4 v[60:63], v6, s[12:15], s22 offen offset:0
  buffer_load_dwordx4 v[64:67], v6, s[12:15], s22 offen offset:256
  buffer_load_dwordx4 v[68:71], v6, s[12:15], s22 offen offset:512
  buffer_load_dwordx4 v[72:75], v6, s[12:15], s22 offen offset:768
  buffer_load_dwordx4 v[76:79], v6, s[12:15], s22 offen offset:1024
  s_mov_b32 s22, 81920
  buffer_load_dwordx4 v[80:83], v6, s[12:15], s22 offen offset:0
  buffer_load_dwordx4 v[84:87], v6, s[12:15], s22 offen offset:256
  buffer_load_dwordx4 v[88:91], v6, s[12:15], s22 offen offset:512
  buffer_load_dwordx4 v[92:95], v6, s[12:15], s22 offen offset:768
  buffer_load_dwordx4 v[96:99], v6, s[12:15], s22 offen offset:1024
  s_mov_b32 s22, 122880
  buffer_load_dwordx4 v[100:103], v6, s[12:15], s22 offen offset:0
  buffer_load_dwordx4 v[104:107], v6, s[12:15], s22 offen offset:256
  buffer_load_dwordx4 v[108:111], v6, s[12:15], s22 offen offset:512
  buffer_load_dwordx4 v[112:115], v6, s[12:15], s22 offen offset:768
  buffer_load_dwordx4 v[116:119], v6, s[12:15], s22 offen offset:1024
  v_mov_b32 v8, 0x3f803f80
  v_mov_b32 v16, 0
  v_mov_b32 v17, 0
  v_mov_b32 v18, 0
  v_mov_b32 v19, 0
  v_mov_b32 v20, 0
  v_mov_b32 v21, 0
  v_mov_b32 v22, 0
  v_mov_b32 v23, 0
  v_mov_b32 v24, 0
  v_mov_b32 v25, 0
  v_mov_b32 v26, 0
  v_mov_b32 v27, 0
  s_waitcnt vmcnt(15)
  v_dot2_f32_bf16 v16, v40, v8, v16
  v_dot2_f32_bf16 v17, v40, v40, v17
  v_dot2_f32_bf16 v18, v40, v120, v18
  v_dot2_f32_bf16 v16, v41, v8, v16
  v_dot2_f32_bf16 v17, v41, v41, v17
  v_dot2_f32_bf16 v18, v41, v121, v18
  v_dot2_f32_bf16 v16, v42, v8, v16
  v_dot2_f32_bf16 v17, v42, v42, v17
  v_dot2_f32_bf16 v18, v42, v122, v18
  v_dot2_f32_bf16 v16, v43, v8, v16
  v_dot2_f32_bf16 v17, v43, v43, v17
  v_dot2_f32_bf16 v18, v43, v123, v18
  v_dot2_f32_bf16 v16, v44, v8, v16
  v_dot2_f32_bf16 v17, v44, v44, v17
  v_dot2_f32_bf16 v18, v44, v124, v18
  v_dot2_f32_bf16 v16, v45, v8, v16
  v_dot2_f32_bf16 v17, v45, v45, v17
  v_dot2_f32_bf16 v18, v45, v125, v18
  v_dot2_f32_bf16 v16, v46, v8, v16
  v_dot2_f32_bf16 v17, v46, v46, v17
  v_dot2_f32_bf16 v18, v46, v126, v18
  v_dot2_f32_bf16 v16, v47, v8, v16
  v_dot2_f32_bf16 v17, v47, v47, v17
  v_dot2_f32_bf16 v18, v47, v127, v18
  v_dot2_f32_bf16 v16, v48, v8, v16
  v_dot2_f32_bf16 v17, v48, v48, v17
  v_dot2_f32_bf16 v18, v48, v128, v18
  v_dot2_f32_bf16 v16, v49, v8, v16
  v_dot2_f32_bf16 v17, v49, v49, v17
  v_dot2_f32_bf16 v18, v49, v129, v18
  v_dot2_f32_bf16 v16, v50, v8, v16
  v_dot2_f32_bf16 v17, v50, v50, v17
  v_dot2_f32_bf16 v18, v50, v130, v18
  v_dot2_f32_bf16 v16, v51, v8, v16
  v_dot2_f32_bf16 v17, v51, v51, v17
  v_dot2_f32_bf16 v18, v51, v131, v18
  v_dot2_f32_bf16 v16, v52, v8, v16
  v_dot2_f32_bf16 v17, v52, v52, v17
  v_dot2_f32_bf16 v18, v52, v132, v18
  v_dot2_f32_bf16 v16, v53, v8, v16
  v_dot2_f32_bf16 v17, v53, v53, v17
  v_dot2_f32_bf16 v18, v53, v133, v18
  v_dot2_f32_bf16 v16, v54, v8, v16
  v_dot2_f32_bf16 v17, v54, v54, v17
  v_dot2_f32_bf16 v18, v54, v134, v18
  v_dot2_f32_bf16 v16, v55, v8, v16
  v_dot2_f32_bf16 v17, v55, v55, v17
  v_dot2_f32_bf16 v18, v55, v135, v18
  v_dot2_f32_bf16 v16, v56, v8, v16
  v_dot2_f32_bf16 v17, v56, v56, v17
  v_dot2_f32_bf16 v18, v56, v136, v18
  v_dot2_f32_bf16 v16, v57, v8, v16
  v_dot2_f32_bf16 v17, v57, v57, v17
  v_dot2_f32_bf16 v18, v57, v137, v18
  v_dot2_f32_bf16 v16, v58, v8, v16
  v_dot2_f32_bf16 v17, v58, v58, v17
  v_dot2_f32_bf16 v18, v58, v138, v18
  v_dot2_f32_bf16 v16, v59, v8, v16
  v_dot2_f32_bf16 v17, v59, v59, v17
  v_dot2_f32_bf16 v18, v59, v139, v18
  s_waitcnt vmcnt(10)
  v_dot2_f32_bf16 v19, v60, v8, v19
  v_dot2_f32_bf16 v20, v60, v60, v20
  v_dot2_f32_bf16 v21, v60, v120, v21
  v_dot2_f32_bf16 v19, v61, v8, v19
  v_dot2_f32_bf16 v20, v61, v61, v20
  v_dot2_f32_bf16 v21, v61, v121, v21
  v_dot2_f32_bf16 v19, v62, v8, v19
  v_dot2_f32_bf16 v20, v62, v62, v20
  v_dot2_f32_bf16 v21, v62, v122, v21
  v_dot2_f32_bf16 v19, v63, v8, v19
  v_dot2_f32_bf16 v20, v63, v63, v20
  v_dot2_f32_bf16 v21, v63, v123, v21
  v_dot2_f32_bf16 v19, v64, v8, v19
  v_dot2_f32_bf16 v20, v64, v64, v20
  v_dot2_f32_bf16 v21, v64, v124, v21
  v_dot2_f32_bf16 v19, v65, v8, v19
  v_dot2_f32_bf16 v20, v65, v65, v20
  v_dot2_f32_bf16 v21, v65, v125, v21
  v_dot2_f32_bf16 v19, v66, v8, v19
  v_dot2_f32_bf16 v20, v66, v66, v20
  v_dot2_f32_bf16 v21, v66, v126, v21
  v_dot2_f32_bf16 v19, v67, v8, v19
  v_dot2_f32_bf16 v20, v67, v67, v20
  v_dot2_f32_bf16 v21, v67, v127, v21
  v_dot2_f32_bf16 v19, v68, v8, v19
  v_dot2_f32_bf16 v20, v68, v68, v20
  v_dot2_f32_bf16 v21, v68, v128, v21
  v_dot2_f32_bf16 v19, v69, v8, v19
  v_dot2_f32_bf16 v20, v69, v69, v20
  v_dot2_f32_bf16 v21, v69, v129, v21
  v_dot2_f32_bf16 v19, v70, v8, v19
  v_dot2_f32_bf16 v20, v70, v70, v20
  v_dot2_f32_bf16 v21, v70, v130, v21
  v_dot2_f32_bf16 v19, v71, v8, v19
  v_dot2_f32_bf16 v20, v71, v71, v20
  v_dot2_f32_bf16 v21, v71, v131, v21
  v_dot2_f32_bf16 v19, v72, v8, v19
  v_dot2_f32_bf16 v20, v72, v72, v20
  v_dot2_f32_bf16 v21, v72, v132, v21
  v_dot2_f32_bf16 v19, v73, v8, v19
  v_dot2_f32_bf16 v20, v73, v73, v20
  v_dot2_f32_bf16 v21, v73, v133, v21
  v_dot2_f32_bf16 v19, v74, v8, v19
  v_dot2_f32_bf16 v20, v74, v74, v20
  v_dot2_f32_bf16 v21, v74, v134, v21
  v_dot2_f32_bf16 v19, v75, v8, v19
  v_dot2_f32_bf16 v20, v75, v75, v20
  v_dot2_f32_bf16 v21, v75, v135, v21
  v_dot2_f32_bf16 v19, v76, v8, v19
  v_dot2_f32_bf16 v20, v76, v76, v20
  v_dot2_f32_bf16 v21, v76, v136, v21
  v_dot2_f32_bf16 v19, v77, v8, v19
  v_dot2_f32_bf16 v20, v77, v77, v20
  v_dot2_f32_bf16 v21, v77, v137, v21
  v_dot2_f32_bf16 v19, v78, v8, v19
  v_dot2_f32_bf16 v20, v78, v78, v20
  v_dot2_f32_bf16 v21, v78, v138, v21
  v_dot2_f32_bf16 v19, v79, v8, v19
  v_dot2_f32_bf16 v20, v79, v79, v20
  v_dot2_f32_bf16 v21, v79, v139, v21
  s_waitcnt vmcnt(5)
  v_dot2_f32_bf16 v22, v80, v8, v22
  v_dot2_f32_bf16 v23, v80, v80, v23
  v_dot2_f32_bf16 v24, v80, v120, v24
  v_dot2_f32_bf16 v22, v81, v8, v22
  v_dot2_f32_bf16 v23, v81, v81, v23
  v_dot2_f32_bf16 v24, v81, v121, v24
  v_dot2_f32_bf16 v22, v82, v8, v22
  v_dot2_f32_bf16 v23, v82, v82, v23
  v_dot2_f32_bf16 v24, v82, v122, v24
  v_dot2_f32_bf16 v22, v83, v8, v22
  v_dot2_f32_bf16 v23, v83, v83, v23
  v_dot2_f32_bf16 v24, v83, v123, v24
  v_dot2_f32_bf16 v22, v84, v8, v22
  v_dot2_f32_bf16 v23, v84, v84, v23
  v_dot2_f32_bf16 v24, v84, v124, v24
  v_dot2_f32_bf16 v22, v85, v8, v22
  v_dot2_f32_bf16 v23, v85, v85, v23
  v_dot2_f32_bf16 v24, v85, v125, v24
  v_dot2_f32_bf16 v22, v86, v8, v22
  v_dot2_f32_bf16 v23, v86, v86, v23
  v_dot2_f32_bf16 v24, v86, v126, v24
  v_dot2_f32_bf16 v22, v87, v8, v22
  v_dot2_f32_bf16 v23, v87, v87, v23
  v_dot2_f32_bf16 v24, v87, v127, v24
  v_dot2_f32_bf16 v22, v88, v8, v22
  v_dot2_f32_bf16 v23, v88, v88, v23
  v_dot2_f32_bf16 v24, v88, v128, v24
  v_dot2_f32_bf16 v22, v89, v8, v22
  v_dot2_f32_bf16 v23, v89, v89, v23
  v_dot2_f32_bf16 v24, v89, v129, v24
  v_dot2_f32_bf16 v22, v90, v8, v22
  v_dot2_f32_bf16 v23, v90, v90, v23
  v_dot2_f32_bf16 v24, v90, v130, v24
  v_dot2_f32_bf16 v22, v91, v8, v22
  v_dot2_f32_bf16 v23, v91, v91, v23
  v_dot2_f32_bf16 v24, v91, v131, v24
  v_dot2_f32_bf16 v22, v92, v8, v22
  v_dot2_f32_bf16 v23, v92, v92, v23
  v_dot2_f32_bf16 v24, v92, v132, v24
  v_dot2_f32_bf16 v22, v93, v8, v22
  v_dot2_f32_bf16 v23, v93, v93, v23
  v_dot2_f32_bf16 v24, v93, v133, v24
  v_dot2_f32_bf16 v22, v94, v8, v22
  v_dot2_f32_bf16 v23, v94, v94, v23
  v_dot2_f32_bf16 v24, v94, v134, v24
  v_dot2_f32_bf16 v22, v95, v8, v22
  v_dot2_f32_bf16 v23, v95, v95, v23
  v_dot2_f32_bf16 v24, v95, v135, v24
  v_dot2_f32_bf16 v22, v96, v8, v22
  v_dot2_f32_bf16 v23, v96, v96, v23
  v_dot2_f32_bf16 v24, v96, v136, v24
  v_dot2_f32_bf16 v22, v97, v8, v22
  v_dot2_f32_bf16 v23, v97, v97, v23
  v_dot2_f32_bf16 v24, v97, v137, v24
  v_dot2_f32_bf16 v22, v98, v8, v22
  v_dot2_f32_bf16 v23, v98, v98, v23
  v_dot2_f32_bf16 v24, v98, v138, v24
  v_dot2_f32_bf16 v22, v99, v8, v22
  v_dot2_f32_bf16 v23, v99, v99, v23
  v_dot2_f32_bf16 v24, v99, v139, v24
  s_waitcnt vmcnt(0)
  v_dot2_f32_bf16 v25, v100, v8, v25
  v_dot2_f32_bf16 v26, v100, v100, v26
  v_dot2_f32_bf16 v27, v100, v120, v27
  v_dot2_f32_bf16 v25, v101, v8, v25
  v_dot2_f32_bf16 v26, v101, v101, v26
  v_dot2_f32_bf16 v27, v101, v121, v27
  v_dot2_f32_bf16 v25, v102, v8, v25
  v_dot2_f32_bf16 v26, v102, v102, v26
  v_dot2_f32_bf16 v27, v102, v122, v27
  v_dot2_f32_bf16 v25, v103, v8, v25
  v_dot2_f32_bf16 v26, v103, v103, v26
  v_dot2_f32_bf16 v27, v103, v123, v27
  v_dot2_f32_bf16 v25, v104, v8, v25
  v_dot2_f32_bf16 v26, v104, v104, v26
  v_dot2_f32_bf16 v27, v104, v124, v27
  v_dot2_f32_bf16 v25, v105, v8, v25
  v_dot2_f32_bf16 v26, v105, v105, v26
  v_dot2_f32_bf16 v27, v105, v125, v27
  v_dot2_f32_bf16 v25, v106, v8, v25
  v_dot2_f32_bf16 v26, v106, v106, v26
  v_dot2_f32_bf16 v27, v106, v126, v27
  v_dot2_f32_bf16 v25, v107, v8, v25
  v_dot2_f32_bf16 v26, v107, v107, v26
  v_dot2_f32_bf16 v27, v107, v127, v27
  v_dot2_f32_bf16 v25, v108, v8, v25
  v_dot2_f32_bf16 v26, v108, v108, v26
  v_dot2_f32_bf16 v27, v108, v128, v27
  v_dot2_f32_bf16 v25, v109, v8, v25
  v_dot2_f32_bf16 v26, v109, v109, v26
  v_dot2_f32_bf16 v27, v109, v129, v27
  v_dot2_f32_bf16 v25, v110, v8, v25
  v_dot2_f32_bf16 v26, v110, v110, v26
  v_dot2_f32_bf16 v27, v110, v130, v27
  v_dot2_f32_bf16 v25, v111, v8, v25
  v_dot2_f32_bf16 v26, v111, v111, v26
  v_dot2_f32_bf16 v27, v111, v131, v27
  v_dot2_f32_bf16 v25, v112, v8, v25
  v_dot2_f32_bf16 v26, v112, v112, v26
  v_dot2_f32_bf16 v27, v112, v132, v27
  v_dot2_f32_bf16 v25, v113, v8, v25
  v_dot2_f32_bf16 v26, v113, v113, v26
  v_dot2_f32_bf16 v27, v113, v133, v27
  v_dot2_f32_bf16 v25, v114, v8, v25
  v_dot2_f32_bf16 v26, v114, v114, v26
  v_dot2_f32_bf16 v27, v114, v134, v27
  v_dot2_f32_bf16 v25, v115, v8, v25
  v_dot2_f32_bf16 v26, v115, v115, v26
  v_dot2_f32_bf16 v27, v115, v135, v27
  v_dot2_f32_bf16 v25, v116, v8, v25
  v_dot2_f32_bf16 v26, v116, v116, v26
  v_dot2_f32_bf16 v27, v116, v136, v27
  v_dot2_f32_bf16 v25, v117, v8, v25
  v_dot2_f32_bf16 v26, v117, v117, v26
  v_dot2_f32_bf16 v27, v117, v137, v27
  v_dot2_f32_bf16 v25, v118, v8, v25
  v_dot2_f32_bf16 v26, v118, v118, v26
  v_dot2_f32_bf16 v27, v118, v138, v27
  v_dot2_f32_bf16 v25, v119, v8, v25
  v_dot2_f32_bf16 v26, v119, v119, v26
  v_dot2_f32_bf16 v27, v119, v139, v27
  s_nop 2
  s_nop 1
  v_add_f32_dpp v16, v16, v16 row_ror:8 row_mask:0xf bank_mask:0xf
  v_add_f32_dpp v17, v17, v17 row_ror:8 row_mask:0xf bank_mask:0xf
  v_add_f32_dpp v18, v18, v18 row_ror:8 row_mask:0xf bank_mask:0xf
  v_add_f32_dpp v19, v19, v19 row_ror:8 row_mask:0xf bank_mask:0xf
  v_add_f32_dpp v20, v20, v20 row_ror:8 row_mask:0xf bank_mask:0xf
  v_add_f32_dpp v21, v21, v21 row_ror:8 row_mask:0xf bank_mask:0xf
  v_add_f32_dpp v22, v22, v22 row_ror:8 row_mask:0xf bank_mask:0xf
  v_add_f32_dpp v23, v23, v23 row_ror:8 row_mask:0xf bank_mask:0xf
  v_add_f32_dpp v24, v24, v24 row_ror:8 row_mask:0xf bank_mask:0xf
  v_add_f32_dpp v25, v25, v25 row_ror:8 row_mask:0xf bank_mask:0xf
  v_add_f32_dpp v26, v26, v26 row_ror:8 row_mask:0xf bank_mask:0xf
  v_add_f32_dpp v27, v27, v27 row_ror:8 row_mask:0xf bank_mask:0xf
  s_nop 1
  v_add_f32_dpp v16, v16, v16 row_ror:4 row_mask:0xf bank_mask:0xf
  v_add_f32_dpp v17, v17, v17 row_ror:4 row_mask:0xf bank_mask:0xf
  v_add_f32_dpp v18, v18, v18 row_ror:4 row_mask:0xf bank_mask:0xf
  v_add_f32_dpp v19, v19, v19 row_ror:4 row_mask:0xf bank_mask:0xf
  v_add_f32_dpp v20, v20, v20 row_ror:4 row_mask:0xf bank_mask:0xf
  v_add_f32_dpp v21, v21, v21 row_ror:4 row_mask:0xf bank_mask:0xf
  v_add_f32_dpp v22, v22, v22 row_ror:4 row_mask:0xf bank_mask:0xf
  v_add_f32_dpp v23, v23, v23 row_ror:4 row_mask:0xf bank_mask:0xf
  v_add_f32_dpp v24, v24, v24 row_ror:4 row_mask:0xf bank_mask:0xf
  v_add_f32_dpp v25, v25, v25 row_ror:4 row_mask:0xf bank_mask:0xf
  v_add_f32_dpp v26, v26, v26 row_ror:4 row_mask:0xf bank_mask:0xf
  v_add_f32_dpp v27, v27, v27 row_ror:4 row_mask:0xf bank_mask:0xf
  s_nop 1
  v_add_f32_dpp v16, v16, v16 row_ror:2 row_mask:0xf bank_mask:0xf
  v_add_f32_dpp v17, v17, v17 row_ror:2 row_mask:0xf bank_mask:0xf
  v_add_f32_dpp v18, v18, v18 row_ror:2 row_mask:0xf bank_mask:0xf
  v_add_f32_dpp v19, v19, v19 row_ror:2 row_mask:0xf bank_mask:0xf
  v_add_f32_dpp v20, v20, v20 row_ror:2 row_mask:0xf bank_mask:0xf
  v_add_f32_dpp v21, v21, v21 row_ror:2 row_mask:0xf bank_mask:0xf
  v_add_f32_dpp v22, v22, v22 row_ror:2 row_mask:0xf bank_mask:0xf
  v_add_f32_dpp v23, v23, v23 row_ror:2 row_mask:0xf bank_mask:0xf
  v_add_f32_dpp v24, v24, v24 row_ror:2 row_mask:0xf bank_mask:0xf
  v_add_f32_dpp v25, v25, v25 row_ror:2 row_mask:0xf bank_mask:0xf
  v_add_f32_dpp v26, v26, v26 row_ror:2 row_mask:0xf bank_mask:0xf
  v_add_f32_dpp v27, v27, v27 row_ror:2 row_mask:0xf bank_mask:0xf
  s_nop 1
  v_add_f32_dpp v16, v16, v16 row_ror:1 row_mask:0xf bank_mask:0xf
  v_add_f32_dpp v17, v17, v17 row_ror:1 row_mask:0xf bank_mask:0xf
  v_add_f32_dpp v18, v18, v18 row_ror:1 row_mask:0xf bank_mask:0xf
  v_add_f32_dpp v19, v19, v19 row_ror:1 row_mask:0xf bank_mask:0xf
  v_add_f32_dpp v20, v20, v20 row_ror:1 row_mask:0xf bank_mask:0xf
  v_add_f32_dpp v21, v21, v21 row_ror:1 row_mask:0xf bank_mask:0xf
  v_add_f32_dpp v22, v22, v22 row_ror:1 row_mask:0xf bank_mask:0xf
  v_add_f32_dpp v23, v23, v23 row_ror:1 row_mask:0xf bank_mask:0xf
  v_add_f32_dpp v24, v24, v24 row_ror:1 row_mask:0xf bank_mask:0xf
  v_add_f32_dpp v25, v25, v25 row_ror:1 row_mask:0xf bank_mask:0xf
  v_add_f32_dpp v26, v26, v26 row_ror:1 row_mask:0xf bank_mask:0xf
  v_add_f32_dpp v27, v27, v27 row_ror:1 row_mask:0xf bank_mask:0xf
  v_lshlrev_b32 v9, 2, v5
  v_cmp_eq_u32 vcc, 0, v4
  s_and_saveexec_b64 s[36:37], vcc
  v_mul_f32 v16, 0x3acccccd, v16
  v_mul_f32 v17, 0x3acccccd, v17
  v_fma_f32 v17, -v16, v16, v17
  v_max_f32 v17, 0, v17
  v_add_f32 v17, 0x3727c5ac, v17
  v_rsq_f32 v17, v17
  v_mul_f32 v18, 0xbfb8aa3b, v18
  v_exp_f32 v18, v18
  v_mul_f32 v16, v16, v17
  v_add_f32 v18, 1.0, v18
  v_rcp_f32 v18, v18
  v_add_u32 v10, 8192, v9
  v_add_u32 v11, 16384, v9
  buffer_store_dword v16, v9, s[32:35], 0 offen offset:0 sc1
  buffer_store_dword v17, v10, s[32:35], 0 offen offset:0 sc1
  buffer_store_dword v18, v11, s[32:35], 0 offen offset:0 sc1
  v_mul_f32 v19, 0x3acccccd, v19
  v_mul_f32 v20, 0x3acccccd, v20
  v_fma_f32 v20, -v19, v19, v20
  v_max_f32 v20, 0, v20
  v_add_f32 v20, 0x3727c5ac, v20
  v_rsq_f32 v20, v20
  v_mul_f32 v21, 0xbfb8aa3b, v21
  v_exp_f32 v21, v21
  v_mul_f32 v19, v19, v20
  v_add_f32 v21, 1.0, v21
  v_rcp_f32 v21, v21
  v_add_u32 v10, 8192, v9
  v_add_u32 v11, 16384, v9
  buffer_store_dword v19, v9, s[32:35], 0 offen offset:128 sc1
  buffer_store_dword v20, v10, s[32:35], 0 offen offset:128 sc1
  buffer_store_dword v21, v11, s[32:35], 0 offen offset:128 sc1
  v_mul_f32 v22, 0x3acccccd, v22
  v_mul_f32 v23, 0x3acccccd, v23
  v_fma_f32 v23, -v22, v22, v23
  v_max_f32 v23, 0, v23
  v_add_f32 v23, 0x3727c5ac, v23
  v_rsq_f32 v23, v23
  v_mul_f32 v24, 0xbfb8aa3b, v24
  v_exp_f32 v24, v24
  v_mul_f32 v22, v22, v23
  v_add_f32 v24, 1.0, v24
  v_rcp_f32 v24, v24
  v_add_u32 v10, 8192, v9
  v_add_u32 v11, 16384, v9
  buffer_store_dword v22, v9, s[32:35], 0 offen offset:256 sc1
  buffer_store_dword v23, v10, s[32:35], 0 offen offset:256 sc1
  buffer_store_dword v24, v11, s[32:35], 0 offen offset:256 sc1
  v_mul_f32 v25, 0x3acccccd, v25
  v_mul_f32 v26, 0x3acccccd, v26
  v_fma_f32 v26, -v25, v25, v26
  v_max_f32 v26, 0, v26
  v_add_f32 v26, 0x3727c5ac, v26
  v_rsq_f32 v26, v26
  v_mul_f32 v27, 0xbfb8aa3b, v27
  v_exp_f32 v27, v27
  v_mul_f32 v25, v25, v26
  v_add_f32 v27, 1.0, v27
  v_rcp_f32 v27, v27
  v_add_u32 v10, 8192, v9
  v_add_u32 v11, 16384, v9
  buffer_store_dword v25, v9, s[32:35], 0 offen offset:384 sc1
  buffer_store_dword v26, v10, s[32:35], 0 offen offset:384 sc1
  buffer_store_dword v27, v11, s[32:35], 0 offen offset:384 sc1
  s_mov_b64 exec, s[36:37]
  s_lshl_b32 s42, s52, 2
  s_add_u32 s42, s42, 6144
  s_cmp_eq_u32 s3, 0
  s_cbranch_scc0 L_sgr_25
  v_mov_b32 v5, 0
  buffer_load_dword v4, v5, s[48:51], 0 offen sc1
  s_waitcnt vmcnt(0)
  s_mov_b32 s43, 0
L_rdyt_26:
  v_cmp_eq_u32 vcc, 0, v4
  s_nop 0
  s_cmp_eq_u64 vcc, 0
  s_cbranch_scc1 L_rdyd_27
  s_add_u32 s43, s43, 1
  s_cmp_ge_u32 s43, 200000
  s_cbranch_scc1 L_rdyd_27
  s_sleep 2
  buffer_load_dword v4, v5, s[48:51], 0 offen sc1
  s_waitcnt vmcnt(0)
  s_branch L_rdyt_26
L_rdyd_27:
L_sgr_25:
  s_waitcnt vmcnt(0) lgkmcnt(0)
  s_barrier
  s_cmp_eq_u32 s3, 0
  s_cbranch_scc0 L_sg_24
  v_mov_b32 v4, 1
  v_mov_b32 v5, 0
  v_cmp_eq_u32 vcc, 0, v2
  s_and_saveexec_b64 s[36:37], vcc
  buffer_store_dword v4, v5, s[44:47], s42 offen sc1
  s_mov_b64 exec, s[36:37]
L_sg_24:
  s_add_u32 s32, s86, 20971520
  s_addc_u32 s33, s87, 0
  s_mov_b32 s34, 3031040
  s_mov_b32 s35, 0x20000
  s_mov_b32 s26, 107374183
  s_add_u32 s25, s3, 0
  s_lshl_b32 s27, s25, 6
  v_add_u32 v3, s27, v2
  v_mul_hi_u32 v4, v3, s26
  v_mul_u32_u24 v5, 40, v4
  v_sub_u32 v5, v3, v5
  v_mul_u32_u24 v4, 1280, v4
  v_lshl_add_u32 v8, v5, 4, v4
  s_add_u32 s25, s3, 8
  s_lshl_b32 s27, s25, 6
  v_add_u32 v3, s27, v2
  v_mul_hi_u32 v4, v3, s26
  v_mul_u32_u24 v5, 40, v4
  v_sub_u32 v5, v3, v5
  v_mul_u32_u24 v4, 1280, v4
  v_lshl_add_u32 v9, v5, 4, v4
  s_add_u32 s25, s3, 16
  s_lshl_b32 s27, s25, 6
  v_add_u32 v3, s27, v2
  v_mul_hi_u32 v4, v3, s26
  v_mul_u32_u24 v5, 40, v4
  v_sub_u32 v5, v3, v5
  v_mul_u32_u24 v4, 1280, v4
  v_lshl_add_u32 v10, v5, 4, v4
  s_add_u32 s53, s52, 0
  s_mov_b32 s24, 0
L_rpl_28:
  s_lshr_b32 s20, s53, 1
  s_and_b32 s21, s53, 1
  s_cmp_lt_u32 s20, 54
  s_cselect_b32 s12, s76, s68
  s_cselect_b32 s13, s77, s69
  s_mov_b32 s14, 819200
  s_cselect_b32 s14, 2211840, s14
  s_mov_b32 s15, 0x20000
  s_cselect_b32 s22, 0, 54
  s_sub_u32 s22, s20, s22
  s_mul_i32 s22, s22, 40960
  s_mul_i32 s23, s21, 640
  s_add_u32 s22, s22, s23
  s_add_u32 s25, s3, 0
  s_lshl_b32 s25, s25, 10
  s_add_u32 m0, s25, s24
  s_nop 0
  buffer_load_dwordx4 v8, s[12:15], s22 offen lds
L_rp_29:
  s_add_u32 s25, s3, 8
  s_lshl_b32 s25, s25, 10
  s_add_u32 m0, s25, s24
  s_nop 0
  buffer_load_dwordx4 v9, s[12:15], s22 offen lds
L_rp_30:
  s_cmp_ge_u32 s3, 4
  s_cbranch_scc1 L_rp_31
  s_add_u32 s25, s3, 16
  s_lshl_b32 s25, s25, 10
  s_add_u32 m0, s25, s24
  s_nop 0
  buffer_load_dwordx4 v10, s[12:15], s22 offen lds
L_rp_31:
  s_add_u32 s24, s24, 20480
  s_add_u32 s53, s53, 16
  s_cmp_lt_u32 s53, 80
  s_cbranch_scc1 L_rpl_28
  v_lshrrev_b32 v3, 4, v2
  v_bfe_u32 v4, v2, 2, 2
  v_and_b32 v5, 3, v2
  v_lshl_add_u32 v3, v3, 3, v4
  v_mul_u32_u24 v3, 640, v3
  v_lshl_add_u32 v3, v5, 3, v3
  v_lshlrev_b32 v6, 4, v2
  s_waitcnt vmcnt(0)
  s_barrier
  s_add_u32 s53, s52, 0
  s_mov_b32 s24, 0
L_rps_32:
  s_lshr_b32 s20, s53, 1
  s_and_b32 s21, s53, 1
  s_add_u32 s25, s3, 0
  s_lshl_b32 s27, s25, 5
  s_add_u32 s27, s27, s24
  v_add_u32 v4, s27, v3
  ds_read_b64_tr_b16 v[12:13], v4
  ds_read_b64_tr_b16 v[14:15], v4 offset:2560
  s_mul_i32 s28, s21, 20
  s_add_u32 s28, s28, s25
  s_mul_i32 s29, s28, 52
  s_lshr_b32 s29, s29, 8
  s_mul_i32 s30, s29, 5
  s_sub_u32 s30, s28, s30
  s_mul_i32 s29, s29, 74
  s_add_u32 s29, s29, s20
  s_mul_i32 s29, s29, 5
  s_add_u32 s29, s29, s30
  s_lshl_b32 s29, s29, 10
  s_waitcnt lgkmcnt(0)
  buffer_store_dwordx4 v[12:15], v6, s[32:35], s29 offen sc1
L_rq_33:
  s_add_u32 s25, s3, 8
  s_lshl_b32 s27, s25, 5
  s_add_u32 s27, s27, s24
  v_add_u32 v4, s27, v3
  ds_read_b64_tr_b16 v[16:17], v4
  ds_read_b64_tr_b16 v[18:19], v4 offset:2560
  s_mul_i32 s28, s21, 20
  s_add_u32 s28, s28, s25
  s_mul_i32 s29, s28, 52
  s_lshr_b32 s29, s29, 8
  s_mul_i32 s30, s29, 5
  s_sub_u32 s30, s28, s30
  s_mul_i32 s29, s29, 74
  s_add_u32 s29, s29, s20
  s_mul_i32 s29, s29, 5
  s_add_u32 s29, s29, s30
  s_lshl_b32 s29, s29, 10
  s_waitcnt lgkmcnt(0)
  buffer_store_dwordx4 v[16:19], v6, s[32:35], s29 offen sc1
L_rq_34:
  s_cmp_ge_u32 s3, 4
  s_cbranch_scc1 L_rq_35
  s_add_u32 s25, s3, 16
  s_lshl_b32 s27, s25, 5
  s_add_u32 s27, s27, s24
  v_add_u32 v4, s27, v3
  ds_read_b64_tr_b16 v[20:21], v4
  ds_read_b64_tr_b16 v[22:23], v4 offset:2560
  s_mul_i32 s28, s21, 20
  s_add_u32 s28, s28, s25
  s_mul_i32 s29, s28, 52
  s_lshr_b32 s29, s29, 8
  s_mul_i32 s30, s29, 5
  s_sub_u32 s30, s28, s30
  s_mul_i32 s29, s29, 74
  s_add_u32 s29, s29, s20
  s_mul_i32 s29, s29, 5
  s_add_u32 s29, s29, s30
  s_lshl_b32 s29, s29, 10
  s_waitcnt lgkmcnt(0)
  buffer_store_dwordx4 v[20:23], v6, s[32:35], s29 offen sc1
L_rq_35:
  s_add_u32 s24, s24, 20480
  s_add_u32 s53, s53, 16
  s_cmp_lt_u32 s53, 80
  s_cbranch_scc1 L_rps_32
  s_lshl_b32 s42, s52, 2
  s_add_u32 s42, s42, 6272
  s_waitcnt vmcnt(0) lgkmcnt(0)
  s_barrier
  s_cmp_eq_u32 s3, 0
  s_cbranch_scc0 L_sg_36
  v_mov_b32 v4, 1
  v_mov_b32 v5, 0
  v_cmp_eq_u32 vcc, 0, v2
  s_and_saveexec_b64 s[36:37], vcc
  buffer_store_dword v4, v5, s[44:47], s42 offen sc1
  s_mov_b64 exec, s[36:37]
L_sg_36:
L_aux_done:
  s_cmp_ge_u32 s3, 4
  s_cbranch_scc1 L_cpro_poll
  v_mov_b32 v176, 0
  s_lshr_b32 s26, s3, 2
  s_xor_b32 s26, s26, 1
  s_and_b32 s27, s3, 3
  s_lshl_b32 s28, s59, 2
  s_add_u32 s28, s28, s27
  s_mul_i32 s23, s58, 5
  s_mul_i32 s29, s26, 3
  v_and_b32 v3, 31, v2
  v_lshrrev_b32 v4, 5, v2
  s_lshl_b32 s30, s28, 9
  v_lshl_add_u32 v6, v3, 4, s30
  s_add_u32 s31, s23, s29
  v_add_u32 v7, s31, v4
  v_lshl_add_u32 v18, v7, 15, v6
  s_add_u32 s31, s23, 2
  s_lshl_b32 s31, s31, 15
  s_lshl_b32 s32, s26, 3
  s_add_u32 s31, s31, s32
  v_add_u32 v19, s31, v6
  s_lshl_b32 s30, s27, 9
  v_add_u32 v6, s29, v4
  v_mul_u32_u24 v6, 6208, v6
  v_lshl_add_u32 v6, v3, 4, v6
  v_add_u32 v14, s30, v6
  s_add_u32 s31, s30, 12416
  s_add_u32 s31, s31, s32
  v_lshl_add_u32 v15, v3, 4, s31
  v_and_b32 v5, 3, v2
  v_bfe_u32 v6, v2, 4, 1
  v_bfe_u32 v7, v2, 2, 2
  v_and_b32 v20, 1, v5
  v_add_u32 v20, s29, v20
  v_mul_u32_u24 v20, 6208, v20
  v_lshrrev_b32 v21, 1, v5
  v_lshl_add_u32 v20, v21, 3, v20
  s_add_u32 s31, s32, 12416
  s_lshl_b32 s33, s26, 7
  s_sub_u32 s33, 31168, s33
  v_mov_b32 v21, s33
  v_mov_b32 v22, s31
  v_cmp_eq_u32 vcc, 0, v5
  v_lshl_add_u32 v7, v4, 2, v7
  s_nop 0
  v_cndmask_b32 v21, v21, v22, vcc
  v_cmp_eq_u32 vcc, 0, v6
  s_add_u32 s31, s30, 31232
  s_nop 0
  v_cndmask_b32 v20, v21, v20, vcc
  v_lshl_add_u32 v20, v7, 4, v20
  v_add_u32 v16, s31, v20
  v_and_b32 v7, 31, v2
  v_lshrrev_b32 v5, 5, v2
  v_lshlrev_b32 v5, 2, v5
  v_sub_u32 v5, v7, v5
  v_mov_b32 v6, 0xf149f2ca
  v_subrev_u32 v112, 0, v5
  v_ashrrev_i32 v112, 31, v112
  v_and_b32 v112, v6, v112
  v_xor_b32 v96, v6, v112
  v_subrev_u32 v113, 1, v5
  v_ashrrev_i32 v113, 31, v113
  v_and_b32 v113, v6, v113
  v_xor_b32 v97, v6, v113
  v_subrev_u32 v114, 2, v5
  v_ashrrev_i32 v114, 31, v114
  v_and_b32 v114, v6, v114
  v_xor_b32 v98, v6, v114
  v_subrev_u32 v115, 3, v5
  v_ashrrev_i32 v115, 31, v115
  v_and_b32 v115, v6, v115
  v_xor_b32 v99, v6, v115
  v_subrev_u32 v116, 8, v5
  v_ashrrev_i32 v116, 31, v116
  v_and_b32 v116, v6, v116
  v_xor_b32 v100, v6, v116
  v_subrev_u32 v117, 9, v5
  v_ashrrev_i32 v117, 31, v117
  v_and_b32 v117, v6, v117
  v_xor_b32 v101, v6, v117
  v_subrev_u32 v118, 10, v5
  v_ashrrev_i32 v118, 31, v118
  v_and_b32 v118, v6, v118
  v_xor_b32 v102, v6, v118
  v_subrev_u32 v119, 11, v5
  v_ashrrev_i32 v119, 31, v119
  v_and_b32 v119, v6, v119
  v_xor_b32 v103, v6, v119
  v_subrev_u32 v120, 16, v5
  v_ashrrev_i32 v120, 31, v120
  v_and_b32 v120, v6, v120
  v_xor_b32 v104, v6, v120
  v_subrev_u32 v121, 17, v5
  v_ashrrev_i32 v121, 31, v121
  v_and_b32 v121, v6, v121
  v_xor_b32 v105, v6, v121
  v_subrev_u32 v122, 18, v5
  v_ashrrev_i32 v122, 31, v122
  v_and_b32 v122, v6, v122
  v_xor_b32 v106, v6, v122
  v_subrev_u32 v123, 19, v5
  v_ashrrev_i32 v123, 31, v123
  v_and_b32 v123, v6, v123
  v_xor_b32 v107, v6, v123
  v_subrev_u32 v124, 24, v5
  v_ashrrev_i32 v124, 31, v124
  v_and_b32 v124, v6, v124
  v_xor_b32 v108, v6, v124
  v_subrev_u32 v125, 25, v5
  v_ashrrev_i32 v125, 31, v125
  v_and_b32 v125, v6, v125
  v_xor_b32 v109, v6, v125
  v_subrev_u32 v126, 26, v5
  v_ashrrev_i32 v126, 31, v126
  v_and_b32 v126, v6, v126
  v_xor_b32 v110, v6, v126
  v_subrev_u32 v127, 27, v5
  v_ashrrev_i32 v127, 31, v127
  v_and_b32 v127, v6, v127
  v_xor_b32 v111, v6, v127
  s_barrier
  s_branch L_attn
L_cpro_poll:
  v_mov_b32 v176, 0
  v_mov_b32 v4, 68864
  v_mov_b32 v5, 0
  ds_write_b32 v4, v5 offset:0
  ds_write_b32 v4, v5 offset:4
  ds_write_b32 v4, v5 offset:8
  ds_write_b32 v4, v5 offset:12
  s_lshr_b32 s26, s3, 2
  s_xor_b32 s26, s26, 1
  s_and_b32 s27, s3, 3
  s_lshl_b32 s28, s59, 2
  s_add_u32 s28, s28, s27
  s_mul_i32 s23, s58, 5
  s_mul_i32 s29, s26, 3
  v_and_b32 v3, 31, v2
  v_lshrrev_b32 v4, 5, v2
  s_lshl_b32 s30, s28, 9
  v_lshl_add_u32 v6, v3, 4, s30
  s_add_u32 s31, s23, s29
  v_add_u32 v7, s31, v4
  v_lshl_add_u32 v18, v7, 15, v6
  s_add_u32 s31, s23, 2
  s_lshl_b32 s31, s31, 15
  s_lshl_b32 s32, s26, 3
  s_add_u32 s31, s31, s32
  v_add_u32 v19, s31, v6
  s_lshl_b32 s30, s27, 9
  v_add_u32 v6, s29, v4
  v_mul_u32_u24 v6, 6208, v6
  v_lshl_add_u32 v6, v3, 4, v6
  v_add_u32 v14, s30, v6
  s_add_u32 s31, s30, 12416
  s_add_u32 s31, s31, s32
  v_lshl_add_u32 v15, v3, 4, s31
  v_and_b32 v5, 3, v2
  v_bfe_u32 v6, v2, 4, 1
  v_bfe_u32 v7, v2, 2, 2
  v_and_b32 v20, 1, v5
  v_add_u32 v20, s29, v20
  v_mul_u32_u24 v20, 6208, v20
  v_lshrrev_b32 v21, 1, v5
  v_lshl_add_u32 v20, v21, 3, v20
  s_add_u32 s31, s32, 12416
  s_lshl_b32 s33, s26, 7
  s_sub_u32 s33, 31168, s33
  v_mov_b32 v21, s33
  v_mov_b32 v22, s31
  v_cmp_eq_u32 vcc, 0, v5
  v_lshl_add_u32 v7, v4, 2, v7
  s_nop 0
  v_cndmask_b32 v21, v21, v22, vcc
  v_cmp_eq_u32 vcc, 0, v6
  s_add_u32 s31, s30, 31232
  s_nop 0
  v_cndmask_b32 v20, v21, v20, vcc
  v_lshl_add_u32 v20, v7, 4, v20
  v_add_u32 v16, s31, v20
  v_and_b32 v7, 31, v2
  v_lshrrev_b32 v5, 5, v2
  v_lshlrev_b32 v5, 2, v5
  v_sub_u32 v5, v7, v5
  v_mov_b32 v6, 0xf149f2ca
  v_subrev_u32 v112, 0, v5
  v_ashrrev_i32 v112, 31, v112
  v_and_b32 v112, v6, v112
  v_xor_b32 v96, v6, v112
  v_subrev_u32 v113, 1, v5
  v_ashrrev_i32 v113, 31, v113
  v_and_b32 v113, v6, v113
  v_xor_b32 v97, v6, v113
  v_subrev_u32 v114, 2, v5
  v_ashrrev_i32 v114, 31, v114
  v_and_b32 v114, v6, v114
  v_xor_b32 v98, v6, v114
  v_subrev_u32 v115, 3, v5
  v_ashrrev_i32 v115, 31, v115
  v_and_b32 v115, v6, v115
  v_xor_b32 v99, v6, v115
  v_subrev_u32 v116, 8, v5
  v_ashrrev_i32 v116, 31, v116
  v_and_b32 v116, v6, v116
  v_xor_b32 v100, v6, v116
  v_subrev_u32 v117, 9, v5
  v_ashrrev_i32 v117, 31, v117
  v_and_b32 v117, v6, v117
  v_xor_b32 v101, v6, v117
  v_subrev_u32 v118, 10, v5
  v_ashrrev_i32 v118, 31, v118
  v_and_b32 v118, v6, v118
  v_xor_b32 v102, v6, v118
  v_subrev_u32 v119, 11, v5
  v_ashrrev_i32 v119, 31, v119
  v_and_b32 v119, v6, v119
  v_xor_b32 v103, v6, v119
  v_subrev_u32 v120, 16, v5
  v_ashrrev_i32 v120, 31, v120
  v_and_b32 v120, v6, v120
  v_xor_b32 v104, v6, v120
  v_subrev_u32 v121, 17, v5
  v_ashrrev_i32 v121, 31, v121
  v_and_b32 v121, v6, v121
  v_xor_b32 v105, v6, v121
  v_subrev_u32 v122, 18, v5
  v_ashrrev_i32 v122, 31, v122
  v_and_b32 v122, v6, v122
  v_xor_b32 v106, v6, v122
  v_subrev_u32 v123, 19, v5
  v_ashrrev_i32 v123, 31, v123
  v_and_b32 v123, v6, v123
  v_xor_b32 v107, v6, v123
  v_subrev_u32 v124, 24, v5
  v_ashrrev_i32 v124, 31, v124
  v_and_b32 v124, v6, v124
  v_xor_b32 v108, v6, v124
  v_subrev_u32 v125, 25, v5
  v_ashrrev_i32 v125, 31, v125
  v_and_b32 v125, v6, v125
  v_xor_b32 v109, v6, v125
  v_subrev_u32 v126, 26, v5
  v_ashrrev_i32 v126, 31, v126
  v_and_b32 v126, v6, v126
  v_xor_b32 v110, v6, v126
  v_subrev_u32 v127, 27, v5
  v_ashrrev_i32 v127, 31, v127
  v_and_b32 v127, v6, v127
  v_xor_b32 v111, v6, v127
  v_mov_b32 v23, v2
  v_lshrrev_b32 v22, 4, v23
  v_min_u32 v22, 2, v22
  s_sub_u32 s36, s59, 2
  v_add_u32 v22, s36, v22
  v_max_i32 v22, 0, v22
  v_lshlrev_b32 v22, 7, v22
  v_and_b32 v23, 15, v23
  v_min_u32 v23, 14, v23
  v_lshl_add_u32 v22, v23, 2, v22
  v_add_u32 v22, 0, v22
  v_mov_b32 v24, v22
  s_sub_u32 s8, s3, 4
  v_lshl_add_u32 v4, v2, 2, s8
  v_mul_u32_u24 v5, 43, v4
  v_lshrrev_b32 v5, 8, v5
  v_mul_u32_u24 v6, 6, v5
  v_sub_u32 v6, v4, v6
  v_lshlrev_b32 v6, 10, v6
  v_add_u32 v7, 3, v5
  v_lshrrev_b32 v7, 3, v7
  v_mul_u32_u24 v20, 75, v7
  v_add_u32 v20, v20, v5
  s_mul_i32 s9, s58, 5
  s_add_u32 s9, s9, 80
  v_add_u32 v20, s9, v20
  v_lshlrev_b32 v20, 15, v20
  s_lshl_b32 s9, s59, 11
  s_sub_u32 s9, s9, 4096
  v_add3_u32 v20, v20, v6, s9
  v_mul_u32_u24 v21, 6208, v5
  v_mul_u32_u24 v7, 192, v7
  v_add3_u32 v21, v21, v7, v6
  v_lshlrev_b32 v3, 4, v2
  v_readlane_b32 s12, v20, 0
  v_readlane_b32 s13, v20, 1
  v_readlane_b32 s14, v20, 2
  v_readlane_b32 s15, v20, 3
  v_readlane_b32 s16, v20, 4
  v_readlane_b32 s17, v20, 5
  v_readlane_b32 s18, v20, 6
  v_readlane_b32 s19, v20, 7
  v_readlane_b32 s20, v20, 8
  v_readlane_b32 s21, v20, 9
  v_readlane_b32 s22, v20, 10
  v_readlane_b32 s23, v20, 11
  v_readlane_b32 s24, v20, 12
  v_readlane_b32 s25, v20, 13
  v_readlane_b32 s26, v20, 14
  v_readlane_b32 s27, v21, 0
  v_readlane_b32 s28, v21, 1
  v_readlane_b32 s29, v21, 2
  v_readlane_b32 s30, v21, 3
  v_readlane_b32 s31, v21, 4
  v_readlane_b32 s32, v21, 5
  v_readlane_b32 s33, v21, 6
  v_readlane_b32 s34, v21, 7
  v_readlane_b32 s35, v21, 8
  v_readlane_b32 s36, v21, 9
  v_readlane_b32 s37, v21, 10
  v_readlane_b32 s38, v21, 11
  v_readlane_b32 s39, v21, 12
  v_readlane_b32 s40, v21, 13
  v_readlane_b32 s41, v21, 14
  s_add_u32 s4, s86, 0
  s_addc_u32 s5, s87, 0
  s_mov_b32 s6, 7864320
  s_mov_b32 s7, 0x20000
  s_nop 0
  s_waitcnt lgkmcnt(0)
L_cpro_ready:
  buffer_load_dword v26, v24, s[44:47], 0 offen sc1
  s_waitcnt vmcnt(0)
  s_mov_b32 s43, 0
L_wat_37:
  v_cmp_eq_u32 vcc, 0, v26
  s_nop 0
  s_cmp_eq_u64 vcc, 0
  s_cbranch_scc1 L_wad_38
  s_add_u32 s43, s43, 1
  s_cmp_ge_u32 s43, 200000
  s_cbranch_scc1 L_wad_38
  s_sleep 2
  buffer_load_dword v26, v24, s[44:47], 0 offen sc1
  s_waitcnt vmcnt(0)
  s_branch L_wat_37
L_wad_38:
  s_mov_b32 m0, s27
  s_nop 0
  buffer_load_dwordx4 v3, s[4:7], s12 offen sc1 lds
  s_mov_b32 m0, s28
  s_nop 0
  buffer_load_dwordx4 v3, s[4:7], s13 offen sc1 lds
  s_mov_b32 m0, s29
  s_nop 0
  buffer_load_dwordx4 v3, s[4:7], s14 offen sc1 lds
  s_mov_b32 m0, s30
  s_nop 0
  buffer_load_dwordx4 v3, s[4:7], s15 offen sc1 lds
  s_mov_b32 m0, s31
  s_nop 0
  buffer_load_dwordx4 v3, s[4:7], s16 offen sc1 lds
  s_mov_b32 m0, s32
  s_nop 0
  buffer_load_dwordx4 v3, s[4:7], s17 offen sc1 lds
  s_mov_b32 m0, s33
  s_nop 0
  buffer_load_dwordx4 v3, s[4:7], s18 offen sc1 lds
  s_mov_b32 m0, s34
  s_nop 0
  buffer_load_dwordx4 v3, s[4:7], s19 offen sc1 lds
  s_mov_b32 m0, s35
  s_nop 0
  buffer_load_dwordx4 v3, s[4:7], s20 offen sc1 lds
  s_mov_b32 m0, s36
  s_nop 0
  buffer_load_dwordx4 v3, s[4:7], s21 offen sc1 lds
  s_mov_b32 m0, s37
  s_nop 0
  buffer_load_dwordx4 v3, s[4:7], s22 offen sc1 lds
  s_mov_b32 m0, s38
  s_nop 0
  buffer_load_dwordx4 v3, s[4:7], s23 offen sc1 lds
  s_mov_b32 m0, s39
  s_nop 0
  buffer_load_dwordx4 v3, s[4:7], s24 offen sc1 lds
  s_mov_b32 m0, s40
  s_nop 0
  buffer_load_dwordx4 v3, s[4:7], s25 offen sc1 lds
  s_mov_b32 m0, s41
  s_nop 0
  buffer_load_dwordx4 v3, s[4:7], s26 offen sc1 lds
  s_mul_i32 s8, s58, 5
  s_lshl_b32 s9, s59, 11
  s_add_u32 s10, s3, -4
  s_lshr_b32 s11, s10, 1
  s_add_u32 s12, s11, s8
  s_lshl_b32 s12, s12, 15
  s_add_u32 s12, s12, s9
  s_and_b32 s13, s10, 1
  s_lshl_b32 s13, s13, 10
  s_add_u32 s12, s12, s13
  s_lshl_b32 s10, s10, 10
  s_add_u32 m0, s10, 71680
  s_nop 0
  buffer_load_dwordx4 v3, s[4:7], s12 offen sc1 lds
L_qd_39:
  s_add_u32 s10, s3, 0
  s_lshr_b32 s11, s10, 1
  s_add_u32 s12, s11, s8
  s_lshl_b32 s12, s12, 15
  s_add_u32 s12, s12, s9
  s_and_b32 s13, s10, 1
  s_lshl_b32 s13, s13, 10
  s_add_u32 s12, s12, s13
  s_lshl_b32 s10, s10, 10
  s_add_u32 m0, s10, 71680
  s_nop 0
  buffer_load_dwordx4 v3, s[4:7], s12 offen sc1 lds
L_qd_40:
  s_cmp_ge_u32 s3, 6
  s_cbranch_scc1 L_qd_41
  s_add_u32 s10, s3, 4
  s_lshr_b32 s11, s10, 1
  s_add_u32 s12, s11, s8
  s_lshl_b32 s12, s12, 15
  s_add_u32 s12, s12, s9
  s_and_b32 s13, s10, 1
  s_lshl_b32 s13, s13, 10
  s_add_u32 s12, s12, s13
  s_lshl_b32 s10, s10, 10
  s_add_u32 m0, s10, 71680
  s_nop 0
  buffer_load_dwordx4 v3, s[4:7], s12 offen sc1 lds
L_qd_41:
L_cpro_issued:
  v_subrev_u32 v4, 256, v0
  v_lshlrev_b32 v4, 4, v4
  v_mov_b32 v20, 0x3f80
  v_mov_b32 v21, 0
  v_mov_b32 v22, 0x3f80
  v_mov_b32 v23, 0
  ds_write_b128 v4, v[20:23] offset:62272
  v_cmp_gt_u32 vcc, 2240, v4
  s_and_saveexec_b64 s[42:43], vcc
  v_add_u32 v4, 4096, v4
  ds_write_b128 v4, v[20:23] offset:62272
  s_mov_b64 exec, s[42:43]
  v_and_b32 v3, 31, v2
  v_lshrrev_b32 v4, 5, v2
  s_lshr_b32 s26, s3, 2
  s_xor_b32 s26, s26, 1
  s_and_b32 s27, s3, 3
  s_lshl_b32 s28, s59, 2
  s_add_u32 s28, s28, s27
  s_mul_i32 s29, s26, 3
  s_lshl_b32 s32, s26, 3
  s_waitcnt vmcnt(0) lgkmcnt(0)
  s_barrier
L_attn:
  s_lshl_b32 s30, s27, 9
  s_add_u32 s30, s30, 71680
  v_lshl_add_u32 v5, v3, 4, s30
  v_add_u32 v6, s29, v4
  v_lshl_add_u32 v6, v6, 11, v5
  ds_read_b128 v[8:11], v6
  s_add_u32 s31, s32, 4096
  v_add_u32 v6, s31, v5
  ds_read_b64 v[12:13], v6
  s_waitcnt lgkmcnt(0)
  s_mov_b32 exec_lo, 0
  v_mov_b32 v12, 0
  v_mov_b32 v13, 0
  s_mov_b32 exec_lo, -1
  s_mov_b32 s63, s28
  s_add_u32 s12, s86, 20971520
  s_addc_u32 s13, s87, 0
  s_mov_b32 s14, 3031040
  s_mov_b32 s15, 0x20000
  s_add_u32 s16, s86, 8388608
  s_addc_u32 s17, s87, 0
  s_mov_b32 s18, 7077888
  s_mov_b32 s19, 0x20000
  s_add_u32 s28, s86, 16777216
  s_addc_u32 s29, s87, 0
  s_mov_b32 s30, 2621440
  s_mov_b32 s31, 0x20000
  s_add_u32 s32, s86, 25165824
  s_addc_u32 s33, s87, 0
  s_mov_b32 s34, 40960
  s_mov_b32 s35, 0x20000
  s_mov_b32 s8, s78
  s_mov_b32 s9, s79
  s_mov_b32 s10, 1280
  s_mov_b32 s11, 0x20000
  s_and_b32 s25, s3, 3
  s_lshr_b32 s24, s3, 2
  v_lshlrev_b32 v236, 4, v2
  v_and_b32 v5, 15, v2
  v_lshrrev_b32 v6, 4, v2
  s_lshl_b32 s90, s60, 6
  s_lshl_b32 s91, s25, 4
  s_add_u32 s90, s90, s91
  v_add_u32 v7, s90, v5
  v_lshlrev_b32 v225, 2, v7
  v_add_u32 v225, 16384, v225
  v_lshlrev_b32 v237, 15, v6
  v_lshl_add_u32 v237, v7, 4, v237
  s_lshl_b32 s90, s24, 17
  v_add_u32 v237, s90, v237
  s_mul_i32 s88, s61, 378880
  s_mul_i32 s89, s3, 5120
  s_add_u32 s88, s88, s89
  s_mul_i32 s90, s24, 5120
  s_add_u32 s91, s90, 81920
  v_add_u32 v240, s91, v236
  s_add_u32 s91, s90, 122880
  v_add_u32 v241, s91, v236
  s_add_u32 s91, s90, 0
  v_add_u32 v242, s91, v236
  s_add_u32 s91, s90, 40960
  v_add_u32 v243, s91, v236
  s_lshr_b32 s90, s60, 1
  s_lshl_b32 s90, s90, 7
  v_min_u32 v239, 13, v5
  s_add_u32 s91, s90, 2048
  v_lshl_add_u32 v239, v239, 2, s91
  v_lshlrev_b32 v7, 2, v5
  v_add_u32 v7, 6144, v7
  v_cmp_gt_u32 s[40:41], 32, v2
  s_nop 1
  v_cndmask_b32 v239, v7, v239, s[40:41]
  s_add_u32 s91, s90, 4096
  v_lshl_add_u32 v245, v5, 2, s91
  s_mul_i32 s90, s61, 160
  v_lshl_add_u32 v244, v6, 3, s90
  s_sub_u32 s62, 8, s63
  s_max_i32 s62, s62, 0
  s_cmp_eq_u32 s62, 0
  s_cselect_b32 s40, 0, 0xf149f2ca
  v_mov_b32 v128, s40
  v_mov_b32 v129, s40
  v_mov_b32 v130, s40
  v_mov_b32 v131, s40
  v_mov_b32 v132, s40
  v_mov_b32 v133, s40
  v_mov_b32 v134, s40
  v_mov_b32 v135, s40
  v_mov_b32 v136, s40
  v_mov_b32 v137, s40
  v_mov_b32 v138, s40
  v_mov_b32 v139, s40
  v_mov_b32 v140, s40
  v_mov_b32 v141, s40
  v_mov_b32 v142, s40
  v_mov_b32 v143, s40
  s_cbranch_scc1 L_nf_42
  v_mov_b32 v96, s40
  v_mov_b32 v97, s40
  v_mov_b32 v98, s40
  v_mov_b32 v99, s40
  v_mov_b32 v100, s40
  v_mov_b32 v101, s40
  v_mov_b32 v102, s40
  v_mov_b32 v103, s40
  v_mov_b32 v104, s40
  v_mov_b32 v105, s40
  v_mov_b32 v106, s40
  v_mov_b32 v107, s40
  v_mov_b32 v108, s40
  v_mov_b32 v109, s40
  v_mov_b32 v110, s40
  v_mov_b32 v111, s40
L_nf_42:
  ds_read_b128 v[20:23], v14 offset:0
  ds_read_b64 v[24:25], v15 offset:0
  ds_read_b128 v[26:29], v14 offset:512
  ds_read_b64 v[30:31], v15 offset:512
  ds_read_b64_tr_b16 v[32:33], v16 offset:0
  ds_read_b64_tr_b16 v[34:35], v16 offset:128
  ds_read_b64_tr_b16 v[36:37], v16 offset:256
  ds_read_b64_tr_b16 v[38:39], v16 offset:384
  s_waitcnt lgkmcnt(6)
  v_mfma_f32_32x32x16_bf16 v[64:79], v[20:23], v[8:11], v[96:111]
  v_mfma_f32_32x32x8_bf16 v[64:79], v[24:25], v[12:13], v[64:79]
  s_cmp_eq_u32 s62, 1
  s_cbranch_scc0 L_um_43
  s_nop 7
  v_mov_b32 v128, 0
  v_mov_b32 v129, 0
  v_mov_b32 v130, 0
  v_mov_b32 v131, 0
  v_mov_b32 v132, 0
  v_mov_b32 v133, 0
  v_mov_b32 v134, 0
  v_mov_b32 v135, 0
  v_mov_b32 v136, 0
  v_mov_b32 v137, 0
  v_mov_b32 v138, 0
  v_mov_b32 v139, 0
  v_mov_b32 v140, 0
  v_mov_b32 v141, 0
  v_mov_b32 v142, 0
  v_mov_b32 v143, 0
  s_nop 1
L_um_43:
  s_waitcnt lgkmcnt(4)
  v_mfma_f32_32x32x16_bf16 v[80:95], v[26:29], v[8:11], v[128:143]
  s_nop 7
  s_nop 1
  v_exp_f32 v64, v64
  v_exp_f32 v65, v65
  v_exp_f32 v66, v66
  v_exp_f32 v67, v67
  v_mfma_f32_32x32x8_bf16 v[80:95], v[30:31], v[12:13], v[80:95]
  ds_read_b128 v[20:23], v14 offset:1024
  ds_read_b64 v[24:25], v15 offset:1024
  v_exp_f32 v68, v68
  v_exp_f32 v69, v69
  v_exp_f32 v70, v70
  v_exp_f32 v71, v71
  v_cvt_pk_bf16_f32 v48, v64, v65
  v_cvt_pk_bf16_f32 v49, v66, v67
  v_cvt_pk_bf16_f32 v50, v68, v69
  v_cvt_pk_bf16_f32 v51, v70, v71
  s_waitcnt lgkmcnt(2)
  s_nop 0
  v_mfma_f32_32x32x16_bf16 v[144:159], v[32:35], v[48:51], 0
  ds_read_b64_tr_b16 v[40:41], v16 offset:512
  ds_read_b64_tr_b16 v[42:43], v16 offset:640
  ds_read_b64_tr_b16 v[44:45], v16 offset:768
  ds_read_b64_tr_b16 v[46:47], v16 offset:896
  v_add_u32 v252, 0, v2
  v_min_u32 v252, 31, v252
  v_lshlrev_b32 v252, 2, v252
  v_add_u32 v252, 6272, v252
  buffer_load_dword v248, v252, s[44:47], 0 offen sc1
  v_exp_f32 v72, v72
  v_exp_f32 v73, v73
  v_exp_f32 v74, v74
  v_exp_f32 v75, v75
  v_exp_f32 v76, v76
  v_exp_f32 v77, v77
  v_exp_f32 v78, v78
  v_exp_f32 v79, v79
  v_cvt_pk_bf16_f32 v52, v72, v73
  v_cvt_pk_bf16_f32 v53, v74, v75
  v_cvt_pk_bf16_f32 v54, v76, v77
  v_cvt_pk_bf16_f32 v55, v78, v79
  s_nop 1
  v_mfma_f32_32x32x16_bf16 v[144:159], v[36:39], v[52:55], v[144:159]
  s_cmp_eq_u32 s62, 2
  s_cbranch_scc0 L_um_44
  s_nop 7
  v_mov_b32 v128, 0
  v_mov_b32 v129, 0
  v_mov_b32 v130, 0
  v_mov_b32 v131, 0
  v_mov_b32 v132, 0
  v_mov_b32 v133, 0
  v_mov_b32 v134, 0
  v_mov_b32 v135, 0
  v_mov_b32 v136, 0
  v_mov_b32 v137, 0
  v_mov_b32 v138, 0
  v_mov_b32 v139, 0
  v_mov_b32 v140, 0
  v_mov_b32 v141, 0
  v_mov_b32 v142, 0
  v_mov_b32 v143, 0
  s_nop 1
L_um_44:
  s_waitcnt lgkmcnt(4)
  v_mfma_f32_32x32x16_bf16 v[64:79], v[20:23], v[8:11], v[128:143]
  v_exp_f32 v80, v80
  v_exp_f32 v81, v81
  v_exp_f32 v82, v82
  v_exp_f32 v83, v83
  v_mfma_f32_32x32x8_bf16 v[64:79], v[24:25], v[12:13], v[64:79]
  ds_read_b128 v[26:29], v14 offset:1536
  ds_read_b64 v[30:31], v15 offset:1536
  v_exp_f32 v84, v84
  v_exp_f32 v85, v85
  v_exp_f32 v86, v86
  v_exp_f32 v87, v87
  v_cvt_pk_bf16_f32 v48, v80, v81
  v_cvt_pk_bf16_f32 v49, v82, v83
  v_cvt_pk_bf16_f32 v50, v84, v85
  v_cvt_pk_bf16_f32 v51, v86, v87
  s_waitcnt lgkmcnt(2)
  s_nop 0
  v_mfma_f32_32x32x16_bf16 v[144:159], v[40:43], v[48:51], v[144:159]
  ds_read_b64_tr_b16 v[32:33], v16 offset:1024
  ds_read_b64_tr_b16 v[34:35], v16 offset:1152
  ds_read_b64_tr_b16 v[36:37], v16 offset:1280
  ds_read_b64_tr_b16 v[38:39], v16 offset:1408
  v_exp_f32 v88, v88
  v_exp_f32 v89, v89
  v_exp_f32 v90, v90
  v_exp_f32 v91, v91
  v_exp_f32 v92, v92
  v_exp_f32 v93, v93
  v_exp_f32 v94, v94
  v_exp_f32 v95, v95
  v_cvt_pk_bf16_f32 v52, v88, v89
  v_cvt_pk_bf16_f32 v53, v90, v91
  v_cvt_pk_bf16_f32 v54, v92, v93
  v_cvt_pk_bf16_f32 v55, v94, v95
  s_nop 1
  v_mfma_f32_32x32x16_bf16 v[144:159], v[44:47], v[52:55], v[144:159]
  s_cmp_eq_u32 s62, 3
  s_cbranch_scc0 L_um_45
  s_nop 7
  v_mov_b32 v128, 0
  v_mov_b32 v129, 0
  v_mov_b32 v130, 0
  v_mov_b32 v131, 0
  v_mov_b32 v132, 0
  v_mov_b32 v133, 0
  v_mov_b32 v134, 0
  v_mov_b32 v135, 0
  v_mov_b32 v136, 0
  v_mov_b32 v137, 0
  v_mov_b32 v138, 0
  v_mov_b32 v139, 0
  v_mov_b32 v140, 0
  v_mov_b32 v141, 0
  v_mov_b32 v142, 0
  v_mov_b32 v143, 0
  s_nop 1
L_um_45:
  s_waitcnt lgkmcnt(4)
  v_mfma_f32_32x32x16_bf16 v[80:95], v[26:29], v[8:11], v[128:143]
  v_exp_f32 v64, v64
  v_exp_f32 v65, v65
  v_exp_f32 v66, v66
  v_exp_f32 v67, v67
  v_mfma_f32_32x32x8_bf16 v[80:95], v[30:31], v[12:13], v[80:95]
  ds_read_b128 v[20:23], v14 offset:2048
  ds_read_b64 v[24:25], v15 offset:2048
  v_exp_f32 v68, v68
  v_exp_f32 v69, v69
  v_exp_f32 v70, v70
  v_exp_f32 v71, v71
  v_cvt_pk_bf16_f32 v48, v64, v65
  v_cvt_pk_bf16_f32 v49, v66, v67
  v_cvt_pk_bf16_f32 v50, v68, v69
  v_cvt_pk_bf16_f32 v51, v70, v71
  s_waitcnt lgkmcnt(2)
  s_nop 0
  v_mfma_f32_32x32x16_bf16 v[144:159], v[32:35], v[48:51], v[144:159]
  ds_read_b64_tr_b16 v[40:41], v16 offset:1536
  ds_read_b64_tr_b16 v[42:43], v16 offset:1664
  ds_read_b64_tr_b16 v[44:45], v16 offset:1792
  ds_read_b64_tr_b16 v[46:47], v16 offset:1920
  s_waitcnt vmcnt(0)
  s_cmp_eq_u32 s54, 0
  s_cbranch_scc1 L_sb_46
  s_cmp_ge_u32 s3, 4
  s_cbranch_scc1 L_sb_46
  v_mov_b32 v5, 68864
  v_mov_b32 v6, 1
  s_mov_b64 exec, 1
  ds_add_rtn_u32 v7, v5, v6
  s_waitcnt lgkmcnt(0)
  v_readfirstlane_b32 s40, v7
  s_mov_b64 exec, -1
  s_cmp_eq_u32 s40, 3
  s_cbranch_scc0 L_sb_46
  s_lshl_b32 s42, s56, 7
  s_lshl_b32 s40, s57, 2
  s_add_u32 s42, s42, s40
  s_add_u32 s42, s42, 2048
  v_mov_b32 v6, 1
  v_mov_b32 v7, 0
  s_mov_b64 exec, 1
  buffer_store_dword v6, v7, s[44:47], s42 offen sc1
  s_mov_b64 exec, -1
L_sb_46:
  s_waitcnt vmcnt(0)
  v_cmp_eq_u32 vcc, 0, v248
  s_nop 0
  s_cmp_eq_u64 vcc, 0
  s_cselect_b32 s21, 1, 0
  s_cmp_eq_u32 s21, 0
  s_cbranch_scc1 L_wp_47
  s_add_u32 s40, s88, 0
  s_add_u32 m0, s89, 81920
  s_nop 0
  buffer_load_dwordx4 v236, s[12:15], s40 offen offset:0 sc1 lds
  s_add_u32 m0, s89, 81920
  s_nop 0
  buffer_load_dwordx4 v236, s[12:15], s40 offen offset:1024 sc1 lds
L_wp_47:
  v_exp_f32 v72, v72
  v_exp_f32 v73, v73
  v_exp_f32 v74, v74
  v_exp_f32 v75, v75
  v_exp_f32 v76, v76
  v_exp_f32 v77, v77
  v_exp_f32 v78, v78
  v_exp_f32 v79, v79
  v_cvt_pk_bf16_f32 v52, v72, v73
  v_cvt_pk_bf16_f32 v53, v74, v75
  v_cvt_pk_bf16_f32 v54, v76, v77
  v_cvt_pk_bf16_f32 v55, v78, v79
  s_nop 1
  v_mfma_f32_32x32x16_bf16 v[144:159], v[36:39], v[52:55], v[144:159]
  s_cmp_eq_u32 s62, 4
  s_cbranch_scc0 L_um_48
  s_nop 7
  v_mov_b32 v128, 0
  v_mov_b32 v129, 0
  v_mov_b32 v130, 0
  v_mov_b32 v131, 0
  v_mov_b32 v132, 0
  v_mov_b32 v133, 0
  v_mov_b32 v134, 0
  v_mov_b32 v135, 0
  v_mov_b32 v136, 0
  v_mov_b32 v137, 0
  v_mov_b32 v138, 0
  v_mov_b32 v139, 0
  v_mov_b32 v140, 0
  v_mov_b32 v141, 0
  v_mov_b32 v142, 0
  v_mov_b32 v143, 0
  s_nop 1
L_um_48:
  s_waitcnt lgkmcnt(4)
  v_mfma_f32_32x32x16_bf16 v[64:79], v[20:23], v[8:11], v[128:143]
  v_exp_f32 v80, v80
  v_exp_f32 v81, v81
  v_exp_f32 v82, v82
  v_exp_f32 v83, v83
  v_mfma_f32_32x32x8_bf16 v[64:79], v[24:25], v[12:13], v[64:79]
  ds_read_b128 v[26:29], v14 offset:2560
  ds_read_b64 v[30:31], v15 offset:2560
  v_exp_f32 v84, v84
  v_exp_f32 v85, v85
  v_exp_f32 v86, v86
  v_exp_f32 v87, v87
  v_cvt_pk_bf16_f32 v48, v80, v81
  v_cvt_pk_bf16_f32 v49, v82, v83
  v_cvt_pk_bf16_f32 v50, v84, v85
  v_cvt_pk_bf16_f32 v51, v86, v87
  s_waitcnt lgkmcnt(2)
  s_nop 0
  v_mfma_f32_32x32x16_bf16 v[144:159], v[40:43], v[48:51], v[144:159]
  ds_read_b64_tr_b16 v[32:33], v16 offset:2048
  ds_read_b64_tr_b16 v[34:35], v16 offset:2176
  ds_read_b64_tr_b16 v[36:37], v16 offset:2304
  ds_read_b64_tr_b16 v[38:39], v16 offset:2432
  s_cmp_eq_u32 s21, 0
  s_cbranch_scc1 L_wp_49
  s_add_u32 m0, s89, 81920
  s_nop 0
  buffer_load_dwordx4 v236, s[12:15], s40 offen offset:2048 sc1 lds
  s_add_u32 m0, s89, 81920
  s_nop 0
  buffer_load_dwordx4 v236, s[12:15], s40 offen offset:3072 sc1 lds
L_wp_49:
  buffer_load_dwordx2 v[226:227], v244, s[8:11], 0 offen offset:0
  buffer_load_dwordx2 v[228:229], v244, s[8:11], 0 offen offset:32
  buffer_load_dwordx2 v[230:231], v244, s[8:11], 0 offen offset:64
  buffer_load_dwordx2 v[232:233], v244, s[8:11], 0 offen offset:96
  buffer_load_dwordx2 v[234:235], v244, s[8:11], 0 offen offset:128
  v_exp_f32 v88, v88
  v_exp_f32 v89, v89
  v_exp_f32 v90, v90
  v_exp_f32 v91, v91
  v_exp_f32 v92, v92
  v_exp_f32 v93, v93
  v_exp_f32 v94, v94
  v_exp_f32 v95, v95
  v_cvt_pk_bf16_f32 v52, v88, v89
  v_cvt_pk_bf16_f32 v53, v90, v91
  v_cvt_pk_bf16_f32 v54, v92, v93
  v_cvt_pk_bf16_f32 v55, v94, v95
  s_nop 1
  v_mfma_f32_32x32x16_bf16 v[144:159], v[44:47], v[52:55], v[144:159]
  s_cmp_eq_u32 s62, 5
  s_cbranch_scc0 L_um_50
  s_nop 7
  v_mov_b32 v128, 0
  v_mov_b32 v129, 0
  v_mov_b32 v130, 0
  v_mov_b32 v131, 0
  v_mov_b32 v132, 0
  v_mov_b32 v133, 0
  v_mov_b32 v134, 0
  v_mov_b32 v135, 0
  v_mov_b32 v136, 0
  v_mov_b32 v137, 0
  v_mov_b32 v138, 0
  v_mov_b32 v139, 0
  v_mov_b32 v140, 0
  v_mov_b32 v141, 0
  v_mov_b32 v142, 0
  v_mov_b32 v143, 0
  s_nop 1
L_um_50:
  s_waitcnt lgkmcnt(4)
  v_mfma_f32_32x32x16_bf16 v[80:95], v[26:29], v[8:11], v[128:143]
  v_exp_f32 v64, v64
  v_exp_f32 v65, v65
  v_exp_f32 v66, v66
  v_exp_f32 v67, v67
  v_mfma_f32_32x32x8_bf16 v[80:95], v[30:31], v[12:13], v[80:95]
  ds_read_b128 v[20:23], v14 offset:3072
  ds_read_b64 v[24:25], v15 offset:3072
  v_exp_f32 v68, v68
  v_exp_f32 v69, v69
  v_exp_f32 v70, v70
  v_exp_f32 v71, v71
  v_cvt_pk_bf16_f32 v48, v64, v65
  v_cvt_pk_bf16_f32 v49, v66, v67
  v_cvt_pk_bf16_f32 v50, v68, v69
  v_cvt_pk_bf16_f32 v51, v70, v71
  s_waitcnt lgkmcnt(2)
  s_nop 0
  v_mfma_f32_32x32x16_bf16 v[144:159], v[32:35], v[48:51], v[144:159]
  ds_read_b64_tr_b16 v[40:41], v16 offset:2560
  ds_read_b64_tr_b16 v[42:43], v16 offset:2688
  ds_read_b64_tr_b16 v[44:45], v16 offset:2816
  ds_read_b64_tr_b16 v[46:47], v16 offset:2944
  s_cmp_eq_u32 s21, 0
  s_cbranch_scc1 L_wp_51
  s_add_u32 s41, s40, 4096
  s_add_u32 m0, s89, 86016
  s_nop 0
  buffer_load_dwordx4 v236, s[12:15], s41 offen sc1 lds
L_wp_51:
  v_exp_f32 v72, v72
  v_exp_f32 v73, v73
  v_exp_f32 v74, v74
  v_exp_f32 v75, v75
  v_exp_f32 v76, v76
  v_exp_f32 v77, v77
  v_exp_f32 v78, v78
  v_exp_f32 v79, v79
  v_cvt_pk_bf16_f32 v52, v72, v73
  v_cvt_pk_bf16_f32 v53, v74, v75
  v_cvt_pk_bf16_f32 v54, v76, v77
  v_cvt_pk_bf16_f32 v55, v78, v79
  s_nop 1
  v_mfma_f32_32x32x16_bf16 v[144:159], v[36:39], v[52:55], v[144:159]
  s_cmp_eq_u32 s62, 6
  s_cbranch_scc0 L_um_52
  s_nop 7
  v_mov_b32 v128, 0
  v_mov_b32 v129, 0
  v_mov_b32 v130, 0
  v_mov_b32 v131, 0
  v_mov_b32 v132, 0
  v_mov_b32 v133, 0
  v_mov_b32 v134, 0
  v_mov_b32 v135, 0
  v_mov_b32 v136, 0
  v_mov_b32 v137, 0
  v_mov_b32 v138, 0
  v_mov_b32 v139, 0
  v_mov_b32 v140, 0
  v_mov_b32 v141, 0
  v_mov_b32 v142, 0
  v_mov_b32 v143, 0
  s_nop 1
L_um_52:
  s_waitcnt lgkmcnt(4)
  v_mfma_f32_32x32x16_bf16 v[64:79], v[20:23], v[8:11], v[128:143]
  v_exp_f32 v80, v80
  v_exp_f32 v81, v81
  v_exp_f32 v82, v82
  v_exp_f32 v83, v83
  v_mfma_f32_32x32x8_bf16 v[64:79], v[24:25], v[12:13], v[64:79]
  ds_read_b128 v[26:29], v14 offset:3584
  ds_read_b64 v[30:31], v15 offset:3584
  v_exp_f32 v84, v84
  v_exp_f32 v85, v85
  v_exp_f32 v86, v86
  v_exp_f32 v87, v87
  v_cvt_pk_bf16_f32 v48, v80, v81
  v_cvt_pk_bf16_f32 v49, v82, v83
  v_cvt_pk_bf16_f32 v50, v84, v85
  v_cvt_pk_bf16_f32 v51, v86, v87
  s_waitcnt lgkmcnt(2)
  s_nop 0
  v_mfma_f32_32x32x16_bf16 v[144:159], v[40:43], v[48:51], v[144:159]
  ds_read_b64_tr_b16 v[32:33], v16 offset:3072
  ds_read_b64_tr_b16 v[34:35], v16 offset:3200
  ds_read_b64_tr_b16 v[36:37], v16 offset:3328
  ds_read_b64_tr_b16 v[38:39], v16 offset:3456
  s_cmp_eq_u32 s21, 0
  s_cbranch_scc1 L_wp_53
  s_add_u32 s40, s88, 40960
  s_add_u32 m0, s89, 122880
  s_nop 0
  buffer_load_dwordx4 v236, s[12:15], s40 offen offset:0 sc1 lds
  s_add_u32 m0, s89, 122880
  s_nop 0
  buffer_load_dwordx4 v236, s[12:15], s40 offen offset:1024 sc1 lds
L_wp_53:
  buffer_load_dword v238, v239, s[44:47], 0 offen sc1
  v_exp_f32 v88, v88
  v_exp_f32 v89, v89
  v_exp_f32 v90, v90
  v_exp_f32 v91, v91
  v_exp_f32 v92, v92
  v_exp_f32 v93, v93
  v_exp_f32 v94, v94
  v_exp_f32 v95, v95
  v_cvt_pk_bf16_f32 v52, v88, v89
  v_cvt_pk_bf16_f32 v53, v90, v91
  v_cvt_pk_bf16_f32 v54, v92, v93
  v_cvt_pk_bf16_f32 v55, v94, v95
  s_nop 1
  v_mfma_f32_32x32x16_bf16 v[144:159], v[44:47], v[52:55], v[144:159]
  s_cmp_eq_u32 s62, 7
  s_cbranch_scc0 L_um_54
  s_nop 7
  v_mov_b32 v128, 0
  v_mov_b32 v129, 0
  v_mov_b32 v130, 0
  v_mov_b32 v131, 0
  v_mov_b32 v132, 0
  v_mov_b32 v133, 0
  v_mov_b32 v134, 0
  v_mov_b32 v135, 0
  v_mov_b32 v136, 0
  v_mov_b32 v137, 0
  v_mov_b32 v138, 0
  v_mov_b32 v139, 0
  v_mov_b32 v140, 0
  v_mov_b32 v141, 0
  v_mov_b32 v142, 0
  v_mov_b32 v143, 0
  s_nop 1
L_um_54:
  s_waitcnt lgkmcnt(4)
  v_mfma_f32_32x32x16_bf16 v[80:95], v[26:29], v[8:11], v[128:143]
  v_exp_f32 v64, v64
  v_exp_f32 v65, v65
  v_exp_f32 v66, v66
  v_exp_f32 v67, v67
  v_mfma_f32_32x32x8_bf16 v[80:95], v[30:31], v[12:13], v[80:95]
  ds_read_b128 v[20:23], v14 offset:4096
  ds_read_b64 v[24:25], v15 offset:4096
  v_exp_f32 v68, v68
  v_exp_f32 v69, v69
  v_exp_f32 v70, v70
  v_exp_f32 v71, v71
  v_cvt_pk_bf16_f32 v48, v64, v65
  v_cvt_pk_bf16_f32 v49, v66, v67
  v_cvt_pk_bf16_f32 v50, v68, v69
  v_cvt_pk_bf16_f32 v51, v70, v71
  s_waitcnt lgkmcnt(2)
  s_nop 0
  v_mfma_f32_32x32x16_bf16 v[144:159], v[32:35], v[48:51], v[144:159]
  ds_read_b64_tr_b16 v[40:41], v16 offset:3584
  ds_read_b64_tr_b16 v[42:43], v16 offset:3712
  ds_read_b64_tr_b16 v[44:45], v16 offset:3840
  ds_read_b64_tr_b16 v[46:47], v16 offset:3968
  s_cmp_eq_u32 s21, 0
  s_cbranch_scc1 L_wp_55
  s_add_u32 m0, s89, 122880
  s_nop 0
  buffer_load_dwordx4 v236, s[12:15], s40 offen offset:2048 sc1 lds
  s_add_u32 m0, s89, 122880
  s_nop 0
  buffer_load_dwordx4 v236, s[12:15], s40 offen offset:3072 sc1 lds
L_wp_55:
  v_exp_f32 v72, v72
  v_exp_f32 v73, v73
  v_exp_f32 v74, v74
  v_exp_f32 v75, v75
  v_exp_f32 v76, v76
  v_exp_f32 v77, v77
  v_exp_f32 v78, v78
  v_exp_f32 v79, v79
  v_cvt_pk_bf16_f32 v52, v72, v73
  v_cvt_pk_bf16_f32 v53, v74, v75
  v_cvt_pk_bf16_f32 v54, v76, v77
  v_cvt_pk_bf16_f32 v55, v78, v79
  s_nop 1
  v_mfma_f32_32x32x16_bf16 v[144:159], v[36:39], v[52:55], v[144:159]
  s_waitcnt lgkmcnt(4)
  v_mfma_f32_32x32x16_bf16 v[64:79], v[20:23], v[8:11], v[112:127]
  v_exp_f32 v80, v80
  v_exp_f32 v81, v81
  v_exp_f32 v82, v82
  v_exp_f32 v83, v83
  v_mfma_f32_32x32x8_bf16 v[64:79], v[24:25], v[12:13], v[64:79]
  v_exp_f32 v84, v84
  v_exp_f32 v85, v85
  v_exp_f32 v86, v86
  v_exp_f32 v87, v87
  v_cvt_pk_bf16_f32 v48, v80, v81
  v_cvt_pk_bf16_f32 v49, v82, v83
  v_cvt_pk_bf16_f32 v50, v84, v85
  v_cvt_pk_bf16_f32 v51, v86, v87
  s_waitcnt lgkmcnt(0)
  s_nop 0
  v_mfma_f32_32x32x16_bf16 v[144:159], v[40:43], v[48:51], v[144:159]
  ds_read_b64_tr_b16 v[32:33], v16 offset:4096
  ds_read_b64_tr_b16 v[34:35], v16 offset:4224
  ds_read_b64_tr_b16 v[36:37], v16 offset:4352
  ds_read_b64_tr_b16 v[38:39], v16 offset:4480
  s_cmp_eq_u32 s21, 0
  s_cbranch_scc1 L_wp_56
  s_add_u32 s41, s40, 4096
  s_add_u32 m0, s89, 126976
  s_nop 0
  buffer_load_dwordx4 v236, s[12:15], s41 offen sc1 lds
L_wp_56:
  s_cmp_eq_u32 s21, 0
  s_cbranch_scc1 L_fb_57
  s_waitcnt vmcnt(3)
  s_branch L_fb_58
L_fb_57:
  s_waitcnt vmcnt(0)
L_fb_58:
  s_mov_b32 s43, 0
L_wbt_59:
  v_cmp_eq_u32 vcc, 0, v238
  s_nop 0
  s_cmp_eq_u64 vcc, 0
  s_cbranch_scc1 L_wbd_60
  s_add_u32 s43, s43, 1
  s_cmp_ge_u32 s43, 200000
  s_cbranch_scc1 L_wbd_60
  s_sleep 2
  buffer_load_dword v238, v239, s[44:47], 0 offen sc1
  s_waitcnt vmcnt(0)
  s_branch L_wbt_59
L_wbd_60:
  s_mov_b32 s41, 0
  buffer_load_dwordx4 v[160:163], v237, s[16:19], s41 offen sc1
  s_mov_b32 s41, 262144
  buffer_load_dwordx4 v[164:167], v237, s[16:19], s41 offen sc1
  s_mov_b32 s41, 524288
  buffer_load_dwordx4 v[168:171], v237, s[16:19], s41 offen sc1
  s_mov_b32 s41, 786432
  buffer_load_dwordx4 v[172:175], v237, s[16:19], s41 offen sc1
  buffer_load_dword v224, v225, s[32:35], 0 offen sc1
  s_mov_b32 s41, 1048576
  buffer_load_dwordx4 v[176:179], v237, s[16:19], s41 offen sc1
  s_mov_b32 s41, 1310720
  buffer_load_dwordx4 v[180:183], v237, s[16:19], s41 offen sc1
  s_mov_b32 s41, 1572864
  buffer_load_dwordx4 v[184:187], v237, s[16:19], s41 offen sc1
  s_mov_b32 s41, 1835008
  buffer_load_dwordx4 v[188:191], v237, s[16:19], s41 offen sc1
  v_exp_f32 v88, v88
  v_exp_f32 v89, v89
  v_exp_f32 v90, v90
  v_exp_f32 v91, v91
  v_exp_f32 v92, v92
  v_exp_f32 v93, v93
  v_exp_f32 v94, v94
  v_exp_f32 v95, v95
  v_cvt_pk_bf16_f32 v52, v88, v89
  v_cvt_pk_bf16_f32 v53, v90, v91
  v_cvt_pk_bf16_f32 v54, v92, v93
  v_cvt_pk_bf16_f32 v55, v94, v95
  s_nop 1
  v_mfma_f32_32x32x16_bf16 v[144:159], v[44:47], v[52:55], v[144:159]
  v_exp_f32 v64, v64
  v_exp_f32 v65, v65
  v_exp_f32 v66, v66
  v_exp_f32 v67, v67
  v_exp_f32 v68, v68
  v_exp_f32 v69, v69
  v_exp_f32 v70, v70
  v_exp_f32 v71, v71
  v_cvt_pk_bf16_f32 v48, v64, v65
  v_cvt_pk_bf16_f32 v49, v66, v67
  v_cvt_pk_bf16_f32 v50, v68, v69
  v_cvt_pk_bf16_f32 v51, v70, v71
  s_waitcnt lgkmcnt(0)
  s_nop 0
  v_mfma_f32_32x32x16_bf16 v[144:159], v[32:35], v[48:51], v[144:159]
  v_exp_f32 v72, v72
  v_exp_f32 v73, v73
  v_exp_f32 v74, v74
  v_exp_f32 v75, v75
  v_exp_f32 v76, v76
  v_exp_f32 v77, v77
  v_exp_f32 v78, v78
  v_exp_f32 v79, v79
  v_cvt_pk_bf16_f32 v52, v72, v73
  v_cvt_pk_bf16_f32 v53, v74, v75
  v_cvt_pk_bf16_f32 v54, v76, v77
  v_cvt_pk_bf16_f32 v55, v78, v79
  s_nop 1
  v_mfma_f32_32x32x16_bf16 v[144:159], v[36:39], v[52:55], v[144:159]
  s_nop 11
  v_mov_b32 v5, v152
  v_mov_b32 v6, v152
  s_nop 1
  v_permlane32_swap_b32 v5, v6
  v_mov_b32 v5, 0x17800000
  v_mov_b32 v7, 0x71800000
  v_cmp_nge_f32 s[40:41], v6, v5
  v_cmp_nle_f32 vcc, v6, v7
  s_nop 1
  s_or_b64 vcc, vcc, s[40:41]
  s_cmp_eq_u64 vcc, 0
  s_cbranch_scc0 L_attn_redo
L_attn_fin:
  s_add_u32 s4, s86, 16777216
  s_addc_u32 s5, s87, 0
  s_mov_b32 s6, 2621440
  s_mov_b32 s7, 0x20000
  v_rcp_f32 v6, v6
  s_nop 0
  v_mul_f32 v144, v144, v6
  v_mul_f32 v145, v145, v6
  v_mul_f32 v146, v146, v6
  v_mul_f32 v147, v147, v6
  v_mul_f32 v148, v148, v6
  v_mul_f32 v149, v149, v6
  v_mul_f32 v150, v150, v6
  v_mul_f32 v151, v151, v6
  v_mul_f32 v152, v152, v6
  v_mul_f32 v153, v153, v6
  v_mul_f32 v154, v154, v6
  v_mul_f32 v155, v155, v6
  v_cvt_pk_bf16_f32 v48, v144, v145
  v_cvt_pk_bf16_f32 v49, v146, v147
  v_cvt_pk_bf16_f32 v50, v148, v149
  v_cvt_pk_bf16_f32 v51, v150, v151
  v_cvt_pk_bf16_f32 v52, v152, v153
  v_cvt_pk_bf16_f32 v53, v154, v155
  buffer_store_dwordx4 v[48:51], v18, s[4:7], 0 offen sc1
  s_mov_b32 exec_hi, 0
  buffer_store_dwordx2 v[52:53], v19, s[4:7], 0 offen sc1
  s_mov_b32 exec_hi, -1
  s_branch L_g2
L_attn_redo:
  v_and_b32 v7, 31, v2
  v_lshrrev_b32 v5, 5, v2
  v_lshlrev_b32 v5, 2, v5
  v_sub_u32 v5, v7, v5
  v_mov_b32 v6, 0xf149f2ca
  v_subrev_u32 v112, 0, v5
  v_ashrrev_i32 v112, 31, v112
  v_and_b32 v112, v6, v112
  v_xor_b32 v96, v6, v112
  v_subrev_u32 v113, 1, v5
  v_ashrrev_i32 v113, 31, v113
  v_and_b32 v113, v6, v113
  v_xor_b32 v97, v6, v113
  v_subrev_u32 v114, 2, v5
  v_ashrrev_i32 v114, 31, v114
  v_and_b32 v114, v6, v114
  v_xor_b32 v98, v6, v114
  v_subrev_u32 v115, 3, v5
  v_ashrrev_i32 v115, 31, v115
  v_and_b32 v115, v6, v115
  v_xor_b32 v99, v6, v115
  v_subrev_u32 v116, 8, v5
  v_ashrrev_i32 v116, 31, v116
  v_and_b32 v116, v6, v116
  v_xor_b32 v100, v6, v116
  v_subrev_u32 v117, 9, v5
  v_ashrrev_i32 v117, 31, v117
  v_and_b32 v117, v6, v117
  v_xor_b32 v101, v6, v117
  v_subrev_u32 v118, 10, v5
  v_ashrrev_i32 v118, 31, v118
  v_and_b32 v118, v6, v118
  v_xor_b32 v102, v6, v118
  v_subrev_u32 v119, 11, v5
  v_ashrrev_i32 v119, 31, v119
  v_and_b32 v119, v6, v119
  v_xor_b32 v103, v6, v119
  v_subrev_u32 v120, 16, v5
  v_ashrrev_i32 v120, 31, v120
  v_and_b32 v120, v6, v120
  v_xor_b32 v104, v6, v120
  v_subrev_u32 v121, 17, v5
  v_ashrrev_i32 v121, 31, v121
  v_and_b32 v121, v6, v121
  v_xor_b32 v105, v6, v121
  v_subrev_u32 v122, 18, v5
  v_ashrrev_i32 v122, 31, v122
  v_and_b32 v122, v6, v122
  v_xor_b32 v106, v6, v122
  v_subrev_u32 v123, 19, v5
  v_ashrrev_i32 v123, 31, v123
  v_and_b32 v123, v6, v123
  v_xor_b32 v107, v6, v123
  v_subrev_u32 v124, 24, v5
  v_ashrrev_i32 v124, 31, v124
  v_and_b32 v124, v6, v124
  v_xor_b32 v108, v6, v124
  v_subrev_u32 v125, 25, v5
  v_ashrrev_i32 v125, 31, v125
  v_and_b32 v125, v6, v125
  v_xor_b32 v109, v6, v125
  v_subrev_u32 v126, 26, v5
  v_ashrrev_i32 v126, 31, v126
  v_and_b32 v126, v6, v126
  v_xor_b32 v110, v6, v126
  v_subrev_u32 v127, 27, v5
  v_ashrrev_i32 v127, 31, v127
  v_and_b32 v127, v6, v127
  v_xor_b32 v111, v6, v127
  v_mov_b32 v17, 0xf149f2ca
  v_mov_b32 v64, v17
  v_mov_b32 v80, v17
  v_mov_b32 v144, 0
  v_mov_b32 v65, v17
  v_mov_b32 v81, v17
  v_mov_b32 v145, 0
  v_mov_b32 v66, v17
  v_mov_b32 v82, v17
  v_mov_b32 v146, 0
  v_mov_b32 v67, v17
  v_mov_b32 v83, v17
  v_mov_b32 v147, 0
  v_mov_b32 v68, v17
  v_mov_b32 v84, v17
  v_mov_b32 v148, 0
  v_mov_b32 v69, v17
  v_mov_b32 v85, v17
  v_mov_b32 v149, 0
  v_mov_b32 v70, v17
  v_mov_b32 v86, v17
  v_mov_b32 v150, 0
  v_mov_b32 v71, v17
  v_mov_b32 v87, v17
  v_mov_b32 v151, 0
  v_mov_b32 v72, v17
  v_mov_b32 v88, v17
  v_mov_b32 v152, 0
  v_mov_b32 v73, v17
  v_mov_b32 v89, v17
  v_mov_b32 v153, 0
  v_mov_b32 v74, v17
  v_mov_b32 v90, v17
  v_mov_b32 v154, 0
  v_mov_b32 v75, v17
  v_mov_b32 v91, v17
  v_mov_b32 v155, 0
  v_mov_b32 v76, v17
  v_mov_b32 v92, v17
  v_mov_b32 v156, 0
  v_mov_b32 v77, v17
  v_mov_b32 v93, v17
  v_mov_b32 v157, 0
  v_mov_b32 v78, v17
  v_mov_b32 v94, v17
  v_mov_b32 v158, 0
  v_mov_b32 v79, v17
  v_mov_b32 v95, v17
  v_mov_b32 v159, 0
  s_sub_u32 s62, 8, s63
  s_max_i32 s62, s62, 0
  s_lshl_b32 s40, s62, 9
  v_add_u32 v60, s40, v14
  v_add_u32 v61, s40, v15
  ds_read_b128 v[20:23], v60
  ds_read_b64 v[24:25], v61
  ds_read_b128 v[26:29], v60
  ds_read_b64 v[30:31], v61
  s_cmp_eq_u32 s62, 1
  s_cbranch_scc1 L_e1_61_1
  s_cmp_eq_u32 s62, 2
  s_cbranch_scc1 L_e1_61_2
  s_cmp_eq_u32 s62, 3
  s_cbranch_scc1 L_e1_61_3
  s_cmp_eq_u32 s62, 4
  s_cbranch_scc1 L_e1_61_4
  s_cmp_eq_u32 s62, 5
  s_cbranch_scc1 L_e1_61_5
  s_cmp_eq_u32 s62, 6
  s_cbranch_scc1 L_e1_61_6
  s_cmp_eq_u32 s62, 7
  s_cbranch_scc1 L_e1_61_7
  s_cmp_eq_u32 s62, 8
  s_cbranch_scc1 L_e1_61_8
  s_waitcnt lgkmcnt(0)
  v_mfma_f32_32x32x16_bf16 v[64:79], v[20:23], v[8:11], v[96:111]
  v_mfma_f32_32x32x8_bf16 v[64:79], v[24:25], v[12:13], v[64:79]
  ds_read_b128 v[26:29], v14 offset:512
  ds_read_b64 v[30:31], v15 offset:512
  s_nop 7
  v_max3_f32 v17, v80, v81, v17
  v_max3_f32 v17, v82, v83, v17
  v_max3_f32 v17, v84, v85, v17
  v_max3_f32 v17, v86, v87, v17
  v_max3_f32 v17, v88, v89, v17
  v_max3_f32 v17, v90, v91, v17
  v_max3_f32 v17, v92, v93, v17
  v_max3_f32 v17, v94, v95, v17
L_e1_61_1:
  s_waitcnt lgkmcnt(0)
  v_mfma_f32_32x32x16_bf16 v[80:95], v[26:29], v[8:11], 0
  v_mfma_f32_32x32x8_bf16 v[80:95], v[30:31], v[12:13], v[80:95]
  ds_read_b128 v[20:23], v14 offset:1024
  ds_read_b64 v[24:25], v15 offset:1024
  s_nop 7
  v_max3_f32 v17, v64, v65, v17
  v_max3_f32 v17, v66, v67, v17
  v_max3_f32 v17, v68, v69, v17
  v_max3_f32 v17, v70, v71, v17
  v_max3_f32 v17, v72, v73, v17
  v_max3_f32 v17, v74, v75, v17
  v_max3_f32 v17, v76, v77, v17
  v_max3_f32 v17, v78, v79, v17
L_e1_61_2:
  s_waitcnt lgkmcnt(0)
  v_mfma_f32_32x32x16_bf16 v[64:79], v[20:23], v[8:11], 0
  v_mfma_f32_32x32x8_bf16 v[64:79], v[24:25], v[12:13], v[64:79]
  ds_read_b128 v[26:29], v14 offset:1536
  ds_read_b64 v[30:31], v15 offset:1536
  s_nop 7
  v_max3_f32 v17, v80, v81, v17
  v_max3_f32 v17, v82, v83, v17
  v_max3_f32 v17, v84, v85, v17
  v_max3_f32 v17, v86, v87, v17
  v_max3_f32 v17, v88, v89, v17
  v_max3_f32 v17, v90, v91, v17
  v_max3_f32 v17, v92, v93, v17
  v_max3_f32 v17, v94, v95, v17
L_e1_61_3:
  s_waitcnt lgkmcnt(0)
  v_mfma_f32_32x32x16_bf16 v[80:95], v[26:29], v[8:11], 0
  v_mfma_f32_32x32x8_bf16 v[80:95], v[30:31], v[12:13], v[80:95]
  ds_read_b128 v[20:23], v14 offset:2048
  ds_read_b64 v[24:25], v15 offset:2048
  s_nop 7
  v_max3_f32 v17, v64, v65, v17
  v_max3_f32 v17, v66, v67, v17
  v_max3_f32 v17, v68, v69, v17
  v_max3_f32 v17, v70, v71, v17
  v_max3_f32 v17, v72, v73, v17
  v_max3_f32 v17, v74, v75, v17
  v_max3_f32 v17, v76, v77, v17
  v_max3_f32 v17, v78, v79, v17
L_e1_61_4:
  s_waitcnt lgkmcnt(0)
  v_mfma_f32_32x32x16_bf16 v[64:79], v[20:23], v[8:11], 0
  v_mfma_f32_32x32x8_bf16 v[64:79], v[24:25], v[12:13], v[64:79]
  ds_read_b128 v[26:29], v14 offset:2560
  ds_read_b64 v[30:31], v15 offset:2560
  s_nop 7
  v_max3_f32 v17, v80, v81, v17
  v_max3_f32 v17, v82, v83, v17
  v_max3_f32 v17, v84, v85, v17
  v_max3_f32 v17, v86, v87, v17
  v_max3_f32 v17, v88, v89, v17
  v_max3_f32 v17, v90, v91, v17
  v_max3_f32 v17, v92, v93, v17
  v_max3_f32 v17, v94, v95, v17
L_e1_61_5:
  s_waitcnt lgkmcnt(0)
  v_mfma_f32_32x32x16_bf16 v[80:95], v[26:29], v[8:11], 0
  v_mfma_f32_32x32x8_bf16 v[80:95], v[30:31], v[12:13], v[80:95]
  ds_read_b128 v[20:23], v14 offset:3072
  ds_read_b64 v[24:25], v15 offset:3072
  s_nop 7
  v_max3_f32 v17, v64, v65, v17
  v_max3_f32 v17, v66, v67, v17
  v_max3_f32 v17, v68, v69, v17
  v_max3_f32 v17, v70, v71, v17
  v_max3_f32 v17, v72, v73, v17
  v_max3_f32 v17, v74, v75, v17
  v_max3_f32 v17, v76, v77, v17
  v_max3_f32 v17, v78, v79, v17
L_e1_61_6:
  s_waitcnt lgkmcnt(0)
  v_mfma_f32_32x32x16_bf16 v[64:79], v[20:23], v[8:11], 0
  v_mfma_f32_32x32x8_bf16 v[64:79], v[24:25], v[12:13], v[64:79]
  ds_read_b128 v[26:29], v14 offset:3584
  ds_read_b64 v[30:31], v15 offset:3584
  s_nop 7
  v_max3_f32 v17, v80, v81, v17
  v_max3_f32 v17, v82, v83, v17
  v_max3_f32 v17, v84, v85, v17
  v_max3_f32 v17, v86, v87, v17
  v_max3_f32 v17, v88, v89, v17
  v_max3_f32 v17, v90, v91, v17
  v_max3_f32 v17, v92, v93, v17
  v_max3_f32 v17, v94, v95, v17
L_e1_61_7:
  s_waitcnt lgkmcnt(0)
  v_mfma_f32_32x32x16_bf16 v[80:95], v[26:29], v[8:11], 0
  v_mfma_f32_32x32x8_bf16 v[80:95], v[30:31], v[12:13], v[80:95]
  ds_read_b128 v[20:23], v14 offset:4096
  ds_read_b64 v[24:25], v15 offset:4096
  s_nop 7
  v_max3_f32 v17, v64, v65, v17
  v_max3_f32 v17, v66, v67, v17
  v_max3_f32 v17, v68, v69, v17
  v_max3_f32 v17, v70, v71, v17
  v_max3_f32 v17, v72, v73, v17
  v_max3_f32 v17, v74, v75, v17
  v_max3_f32 v17, v76, v77, v17
  v_max3_f32 v17, v78, v79, v17
L_e1_61_8:
  s_waitcnt lgkmcnt(0)
  v_mfma_f32_32x32x16_bf16 v[64:79], v[20:23], v[8:11], v[112:127]
  v_mfma_f32_32x32x8_bf16 v[64:79], v[24:25], v[12:13], v[64:79]
  s_nop 7
  v_max3_f32 v17, v80, v81, v17
  v_max3_f32 v17, v82, v83, v17
  v_max3_f32 v17, v84, v85, v17
  v_max3_f32 v17, v86, v87, v17
  v_max3_f32 v17, v88, v89, v17
  v_max3_f32 v17, v90, v91, v17
  v_max3_f32 v17, v92, v93, v17
  v_max3_f32 v17, v94, v95, v17
  s_nop 7
  v_max3_f32 v17, v64, v65, v17
  v_max3_f32 v17, v66, v67, v17
  v_max3_f32 v17, v68, v69, v17
  v_max3_f32 v17, v70, v71, v17
  v_max3_f32 v17, v72, v73, v17
  v_max3_f32 v17, v74, v75, v17
  v_max3_f32 v17, v76, v77, v17
  v_max3_f32 v17, v78, v79, v17
  v_mov_b32 v5, v17
  v_mov_b32 v6, v17
  s_nop 1
  v_permlane32_swap_b32 v5, v6
  s_nop 1
  v_max_f32 v17, v5, v6
  v_sub_f32 v96, v96, v17
  v_sub_f32 v112, v112, v17
  v_sub_f32 v128, 0, v17
  v_sub_f32 v97, v97, v17
  v_sub_f32 v113, v113, v17
  v_sub_f32 v129, 0, v17
  v_sub_f32 v98, v98, v17
  v_sub_f32 v114, v114, v17
  v_sub_f32 v130, 0, v17
  v_sub_f32 v99, v99, v17
  v_sub_f32 v115, v115, v17
  v_sub_f32 v131, 0, v17
  v_sub_f32 v100, v100, v17
  v_sub_f32 v116, v116, v17
  v_sub_f32 v132, 0, v17
  v_sub_f32 v101, v101, v17
  v_sub_f32 v117, v117, v17
  v_sub_f32 v133, 0, v17
  v_sub_f32 v102, v102, v17
  v_sub_f32 v118, v118, v17
  v_sub_f32 v134, 0, v17
  v_sub_f32 v103, v103, v17
  v_sub_f32 v119, v119, v17
  v_sub_f32 v135, 0, v17
  v_sub_f32 v104, v104, v17
  v_sub_f32 v120, v120, v17
  v_sub_f32 v136, 0, v17
  v_sub_f32 v105, v105, v17
  v_sub_f32 v121, v121, v17
  v_sub_f32 v137, 0, v17
  v_sub_f32 v106, v106, v17
  v_sub_f32 v122, v122, v17
  v_sub_f32 v138, 0, v17
  v_sub_f32 v107, v107, v17
  v_sub_f32 v123, v123, v17
  v_sub_f32 v139, 0, v17
  v_sub_f32 v108, v108, v17
  v_sub_f32 v124, v124, v17
  v_sub_f32 v140, 0, v17
  v_sub_f32 v109, v109, v17
  v_sub_f32 v125, v125, v17
  v_sub_f32 v141, 0, v17
  v_sub_f32 v110, v110, v17
  v_sub_f32 v126, v126, v17
  v_sub_f32 v142, 0, v17
  v_sub_f32 v111, v111, v17
  v_sub_f32 v127, v127, v17
  v_sub_f32 v143, 0, v17
  ds_read_b128 v[20:23], v60
  ds_read_b64 v[24:25], v61
  ds_read_b128 v[26:29], v60
  ds_read_b64 v[30:31], v61
  s_cmp_eq_u32 s62, 1
  s_cbranch_scc1 L_e2_62_1
  s_cmp_eq_u32 s62, 2
  s_cbranch_scc1 L_e2_62_2
  s_cmp_eq_u32 s62, 3
  s_cbranch_scc1 L_e2_62_3
  s_cmp_eq_u32 s62, 4
  s_cbranch_scc1 L_e2_62_4
  s_cmp_eq_u32 s62, 5
  s_cbranch_scc1 L_e2_62_5
  s_cmp_eq_u32 s62, 6
  s_cbranch_scc1 L_e2_62_6
  s_cmp_eq_u32 s62, 7
  s_cbranch_scc1 L_e2_62_7
  s_cmp_eq_u32 s62, 8
  s_cbranch_scc1 L_e2_62_8
  s_waitcnt lgkmcnt(0)
  v_mfma_f32_32x32x16_bf16 v[64:79], v[20:23], v[8:11], v[96:111]
  v_mfma_f32_32x32x8_bf16 v[64:79], v[24:25], v[12:13], v[64:79]
  ds_read_b64_tr_b16 v[32:33], v16 offset:0
  ds_read_b64_tr_b16 v[34:35], v16 offset:128
  ds_read_b64_tr_b16 v[36:37], v16 offset:256
  ds_read_b64_tr_b16 v[38:39], v16 offset:384
  ds_read_b128 v[26:29], v14 offset:512
  ds_read_b64 v[30:31], v15 offset:512
  s_nop 7
  v_exp_f32 v64, v64
  v_exp_f32 v65, v65
  v_exp_f32 v66, v66
  v_exp_f32 v67, v67
  v_exp_f32 v68, v68
  v_exp_f32 v69, v69
  v_exp_f32 v70, v70
  v_exp_f32 v71, v71
  v_exp_f32 v72, v72
  v_exp_f32 v73, v73
  v_exp_f32 v74, v74
  v_exp_f32 v75, v75
  v_exp_f32 v76, v76
  v_exp_f32 v77, v77
  v_exp_f32 v78, v78
  v_exp_f32 v79, v79
  v_cvt_pk_bf16_f32 v48, v64, v65
  v_cvt_pk_bf16_f32 v49, v66, v67
  v_cvt_pk_bf16_f32 v50, v68, v69
  v_cvt_pk_bf16_f32 v51, v70, v71
  v_cvt_pk_bf16_f32 v52, v72, v73
  v_cvt_pk_bf16_f32 v53, v74, v75
  v_cvt_pk_bf16_f32 v54, v76, v77
  v_cvt_pk_bf16_f32 v55, v78, v79
  s_waitcnt lgkmcnt(2)
  v_mfma_f32_32x32x16_bf16 v[144:159], v[32:35], v[48:51], v[144:159]
  v_mfma_f32_32x32x16_bf16 v[144:159], v[36:39], v[52:55], v[144:159]
L_e2_62_1:
  s_waitcnt lgkmcnt(0)
  v_mfma_f32_32x32x16_bf16 v[80:95], v[26:29], v[8:11], v[128:143]
  v_mfma_f32_32x32x8_bf16 v[80:95], v[30:31], v[12:13], v[80:95]
  ds_read_b64_tr_b16 v[40:41], v16 offset:512
  ds_read_b64_tr_b16 v[42:43], v16 offset:640
  ds_read_b64_tr_b16 v[44:45], v16 offset:768
  ds_read_b64_tr_b16 v[46:47], v16 offset:896
  ds_read_b128 v[20:23], v14 offset:1024
  ds_read_b64 v[24:25], v15 offset:1024
  s_nop 7
  v_exp_f32 v80, v80
  v_exp_f32 v81, v81
  v_exp_f32 v82, v82
  v_exp_f32 v83, v83
  v_exp_f32 v84, v84
  v_exp_f32 v85, v85
  v_exp_f32 v86, v86
  v_exp_f32 v87, v87
  v_exp_f32 v88, v88
  v_exp_f32 v89, v89
  v_exp_f32 v90, v90
  v_exp_f32 v91, v91
  v_exp_f32 v92, v92
  v_exp_f32 v93, v93
  v_exp_f32 v94, v94
  v_exp_f32 v95, v95
  v_cvt_pk_bf16_f32 v48, v80, v81
  v_cvt_pk_bf16_f32 v49, v82, v83
  v_cvt_pk_bf16_f32 v50, v84, v85
  v_cvt_pk_bf16_f32 v51, v86, v87
  v_cvt_pk_bf16_f32 v52, v88, v89
  v_cvt_pk_bf16_f32 v53, v90, v91
  v_cvt_pk_bf16_f32 v54, v92, v93
  v_cvt_pk_bf16_f32 v55, v94, v95
  s_waitcnt lgkmcnt(2)
  v_mfma_f32_32x32x16_bf16 v[144:159], v[40:43], v[48:51], v[144:159]
  v_mfma_f32_32x32x16_bf16 v[144:159], v[44:47], v[52:55], v[144:159]
L_e2_62_2:
  s_waitcnt lgkmcnt(0)
  v_mfma_f32_32x32x16_bf16 v[64:79], v[20:23], v[8:11], v[128:143]
  v_mfma_f32_32x32x8_bf16 v[64:79], v[24:25], v[12:13], v[64:79]
  ds_read_b64_tr_b16 v[32:33], v16 offset:1024
  ds_read_b64_tr_b16 v[34:35], v16 offset:1152
  ds_read_b64_tr_b16 v[36:37], v16 offset:1280
  ds_read_b64_tr_b16 v[38:39], v16 offset:1408
  ds_read_b128 v[26:29], v14 offset:1536
  ds_read_b64 v[30:31], v15 offset:1536
  s_nop 7
  v_exp_f32 v64, v64
  v_exp_f32 v65, v65
  v_exp_f32 v66, v66
  v_exp_f32 v67, v67
  v_exp_f32 v68, v68
  v_exp_f32 v69, v69
  v_exp_f32 v70, v70
  v_exp_f32 v71, v71
  v_exp_f32 v72, v72
  v_exp_f32 v73, v73
  v_exp_f32 v74, v74
  v_exp_f32 v75, v75
  v_exp_f32 v76, v76
  v_exp_f32 v77, v77
  v_exp_f32 v78, v78
  v_exp_f32 v79, v79
  v_cvt_pk_bf16_f32 v48, v64, v65
  v_cvt_pk_bf16_f32 v49, v66, v67
  v_cvt_pk_bf16_f32 v50, v68, v69
  v_cvt_pk_bf16_f32 v51, v70, v71
  v_cvt_pk_bf16_f32 v52, v72, v73
  v_cvt_pk_bf16_f32 v53, v74, v75
  v_cvt_pk_bf16_f32 v54, v76, v77
  v_cvt_pk_bf16_f32 v55, v78, v79
  s_waitcnt lgkmcnt(2)
  v_mfma_f32_32x32x16_bf16 v[144:159], v[32:35], v[48:51], v[144:159]
  v_mfma_f32_32x32x16_bf16 v[144:159], v[36:39], v[52:55], v[144:159]
L_e2_62_3:
  s_waitcnt lgkmcnt(0)
  v_mfma_f32_32x32x16_bf16 v[80:95], v[26:29], v[8:11], v[128:143]
  v_mfma_f32_32x32x8_bf16 v[80:95], v[30:31], v[12:13], v[80:95]
  ds_read_b64_tr_b16 v[40:41], v16 offset:1536
  ds_read_b64_tr_b16 v[42:43], v16 offset:1664
  ds_read_b64_tr_b16 v[44:45], v16 offset:1792
  ds_read_b64_tr_b16 v[46:47], v16 offset:1920
  ds_read_b128 v[20:23], v14 offset:2048
  ds_read_b64 v[24:25], v15 offset:2048
  s_nop 7
  v_exp_f32 v80, v80
  v_exp_f32 v81, v81
  v_exp_f32 v82, v82
  v_exp_f32 v83, v83
  v_exp_f32 v84, v84
  v_exp_f32 v85, v85
  v_exp_f32 v86, v86
  v_exp_f32 v87, v87
  v_exp_f32 v88, v88
  v_exp_f32 v89, v89
  v_exp_f32 v90, v90
  v_exp_f32 v91, v91
  v_exp_f32 v92, v92
  v_exp_f32 v93, v93
  v_exp_f32 v94, v94
  v_exp_f32 v95, v95
  v_cvt_pk_bf16_f32 v48, v80, v81
  v_cvt_pk_bf16_f32 v49, v82, v83
  v_cvt_pk_bf16_f32 v50, v84, v85
  v_cvt_pk_bf16_f32 v51, v86, v87
  v_cvt_pk_bf16_f32 v52, v88, v89
  v_cvt_pk_bf16_f32 v53, v90, v91
  v_cvt_pk_bf16_f32 v54, v92, v93
  v_cvt_pk_bf16_f32 v55, v94, v95
  s_waitcnt lgkmcnt(2)
  v_mfma_f32_32x32x16_bf16 v[144:159], v[40:43], v[48:51], v[144:159]
  v_mfma_f32_32x32x16_bf16 v[144:159], v[44:47], v[52:55], v[144:159]
L_e2_62_4:
  s_waitcnt lgkmcnt(0)
  v_mfma_f32_32x32x16_bf16 v[64:79], v[20:23], v[8:11], v[128:143]
  v_mfma_f32_32x32x8_bf16 v[64:79], v[24:25], v[12:13], v[64:79]
  ds_read_b64_tr_b16 v[32:33], v16 offset:2048
  ds_read_b64_tr_b16 v[34:35], v16 offset:2176
  ds_read_b64_tr_b16 v[36:37], v16 offset:2304
  ds_read_b64_tr_b16 v[38:39], v16 offset:2432
  ds_read_b128 v[26:29], v14 offset:2560
  ds_read_b64 v[30:31], v15 offset:2560
  s_nop 7
  v_exp_f32 v64, v64
  v_exp_f32 v65, v65
  v_exp_f32 v66, v66
  v_exp_f32 v67, v67
  v_exp_f32 v68, v68
  v_exp_f32 v69, v69
  v_exp_f32 v70, v70
  v_exp_f32 v71, v71
  v_exp_f32 v72, v72
  v_exp_f32 v73, v73
  v_exp_f32 v74, v74
  v_exp_f32 v75, v75
  v_exp_f32 v76, v76
  v_exp_f32 v77, v77
  v_exp_f32 v78, v78
  v_exp_f32 v79, v79
  v_cvt_pk_bf16_f32 v48, v64, v65
  v_cvt_pk_bf16_f32 v49, v66, v67
  v_cvt_pk_bf16_f32 v50, v68, v69
  v_cvt_pk_bf16_f32 v51, v70, v71
  v_cvt_pk_bf16_f32 v52, v72, v73
  v_cvt_pk_bf16_f32 v53, v74, v75
  v_cvt_pk_bf16_f32 v54, v76, v77
  v_cvt_pk_bf16_f32 v55, v78, v79
  s_waitcnt lgkmcnt(2)
  v_mfma_f32_32x32x16_bf16 v[144:159], v[32:35], v[48:51], v[144:159]
  v_mfma_f32_32x32x16_bf16 v[144:159], v[36:39], v[52:55], v[144:159]
L_e2_62_5:
  s_waitcnt lgkmcnt(0)
  v_mfma_f32_32x32x16_bf16 v[80:95], v[26:29], v[8:11], v[128:143]
  v_mfma_f32_32x32x8_bf16 v[80:95], v[30:31], v[12:13], v[80:95]
  ds_read_b64_tr_b16 v[40:41], v16 offset:2560
  ds_read_b64_tr_b16 v[42:43], v16 offset:2688
  ds_read_b64_tr_b16 v[44:45], v16 offset:2816
  ds_read_b64_tr_b16 v[46:47], v16 offset:2944
  ds_read_b128 v[20:23], v14 offset:3072
  ds_read_b64 v[24:25], v15 offset:3072
  s_nop 7
  v_exp_f32 v80, v80
  v_exp_f32 v81, v81
  v_exp_f32 v82, v82
  v_exp_f32 v83, v83
  v_exp_f32 v84, v84
  v_exp_f32 v85, v85
  v_exp_f32 v86, v86
  v_exp_f32 v87, v87
  v_exp_f32 v88, v88
  v_exp_f32 v89, v89
  v_exp_f32 v90, v90
  v_exp_f32 v91, v91
  v_exp_f32 v92, v92
  v_exp_f32 v93, v93
  v_exp_f32 v94, v94
  v_exp_f32 v95, v95
  v_cvt_pk_bf16_f32 v48, v80, v81
  v_cvt_pk_bf16_f32 v49, v82, v83
  v_cvt_pk_bf16_f32 v50, v84, v85
  v_cvt_pk_bf16_f32 v51, v86, v87
  v_cvt_pk_bf16_f32 v52, v88, v89
  v_cvt_pk_bf16_f32 v53, v90, v91
  v_cvt_pk_bf16_f32 v54, v92, v93
  v_cvt_pk_bf16_f32 v55, v94, v95
  s_waitcnt lgkmcnt(2)
  v_mfma_f32_32x32x16_bf16 v[144:159], v[40:43], v[48:51], v[144:159]
  v_mfma_f32_32x32x16_bf16 v[144:159], v[44:47], v[52:55], v[144:159]
L_e2_62_6:
  s_waitcnt lgkmcnt(0)
  v_mfma_f32_32x32x16_bf16 v[64:79], v[20:23], v[8:11], v[128:143]
  v_mfma_f32_32x32x8_bf16 v[64:79], v[24:25], v[12:13], v[64:79]
  ds_read_b64_tr_b16 v[32:33], v16 offset:3072
  ds_read_b64_tr_b16 v[34:35], v16 offset:3200
  ds_read_b64_tr_b16 v[36:37], v16 offset:3328
  ds_read_b64_tr_b16 v[38:39], v16 offset:3456
  ds_read_b128 v[26:29], v14 offset:3584
  ds_read_b64 v[30:31], v15 offset:3584
  s_nop 7
  v_exp_f32 v64, v64
  v_exp_f32 v65, v65
  v_exp_f32 v66, v66
  v_exp_f32 v67, v67
  v_exp_f32 v68, v68
  v_exp_f32 v69, v69
  v_exp_f32 v70, v70
  v_exp_f32 v71, v71
  v_exp_f32 v72, v72
  v_exp_f32 v73, v73
  v_exp_f32 v74, v74
  v_exp_f32 v75, v75
  v_exp_f32 v76, v76
  v_exp_f32 v77, v77
  v_exp_f32 v78, v78
  v_exp_f32 v79, v79
  v_cvt_pk_bf16_f32 v48, v64, v65
  v_cvt_pk_bf16_f32 v49, v66, v67
  v_cvt_pk_bf16_f32 v50, v68, v69
  v_cvt_pk_bf16_f32 v51, v70, v71
  v_cvt_pk_bf16_f32 v52, v72, v73
  v_cvt_pk_bf16_f32 v53, v74, v75
  v_cvt_pk_bf16_f32 v54, v76, v77
  v_cvt_pk_bf16_f32 v55, v78, v79
  s_waitcnt lgkmcnt(2)
  v_mfma_f32_32x32x16_bf16 v[144:159], v[32:35], v[48:51], v[144:159]
  v_mfma_f32_32x32x16_bf16 v[144:159], v[36:39], v[52:55], v[144:159]
L_e2_62_7:
  s_waitcnt lgkmcnt(0)
  v_mfma_f32_32x32x16_bf16 v[80:95], v[26:29], v[8:11], v[128:143]
  v_mfma_f32_32x32x8_bf16 v[80:95], v[30:31], v[12:13], v[80:95]
  ds_read_b64_tr_b16 v[40:41], v16 offset:3584
  ds_read_b64_tr_b16 v[42:43], v16 offset:3712
  ds_read_b64_tr_b16 v[44:45], v16 offset:3840
  ds_read_b64_tr_b16 v[46:47], v16 offset:3968
  ds_read_b128 v[20:23], v14 offset:4096
  ds_read_b64 v[24:25], v15 offset:4096
  s_nop 7
  v_exp_f32 v80, v80
  v_exp_f32 v81, v81
  v_exp_f32 v82, v82
  v_exp_f32 v83, v83
  v_exp_f32 v84, v84
  v_exp_f32 v85, v85
  v_exp_f32 v86, v86
  v_exp_f32 v87, v87
  v_exp_f32 v88, v88
  v_exp_f32 v89, v89
  v_exp_f32 v90, v90
  v_exp_f32 v91, v91
  v_exp_f32 v92, v92
  v_exp_f32 v93, v93
  v_exp_f32 v94, v94
  v_exp_f32 v95, v95
  v_cvt_pk_bf16_f32 v48, v80, v81
  v_cvt_pk_bf16_f32 v49, v82, v83
  v_cvt_pk_bf16_f32 v50, v84, v85
  v_cvt_pk_bf16_f32 v51, v86, v87
  v_cvt_pk_bf16_f32 v52, v88, v89
  v_cvt_pk_bf16_f32 v53, v90, v91
  v_cvt_pk_bf16_f32 v54, v92, v93
  v_cvt_pk_bf16_f32 v55, v94, v95
  s_waitcnt lgkmcnt(2)
  v_mfma_f32_32x32x16_bf16 v[144:159], v[40:43], v[48:51], v[144:159]
  v_mfma_f32_32x32x16_bf16 v[144:159], v[44:47], v[52:55], v[144:159]
L_e2_62_8:
  s_waitcnt lgkmcnt(0)
  v_mfma_f32_32x32x16_bf16 v[64:79], v[20:23], v[8:11], v[112:127]
  v_mfma_f32_32x32x8_bf16 v[64:79], v[24:25], v[12:13], v[64:79]
  ds_read_b64_tr_b16 v[32:33], v16 offset:4096
  ds_read_b64_tr_b16 v[34:35], v16 offset:4224
  ds_read_b64_tr_b16 v[36:37], v16 offset:4352
  ds_read_b64_tr_b16 v[38:39], v16 offset:4480
  s_nop 7
  v_exp_f32 v64, v64
  v_exp_f32 v65, v65
  v_exp_f32 v66, v66
  v_exp_f32 v67, v67
  v_exp_f32 v68, v68
  v_exp_f32 v69, v69
  v_exp_f32 v70, v70
  v_exp_f32 v71, v71
  v_exp_f32 v72, v72
  v_exp_f32 v73, v73
  v_exp_f32 v74, v74
  v_exp_f32 v75, v75
  v_exp_f32 v76, v76
  v_exp_f32 v77, v77
  v_exp_f32 v78, v78
  v_exp_f32 v79, v79
  v_cvt_pk_bf16_f32 v48, v64, v65
  v_cvt_pk_bf16_f32 v49, v66, v67
  v_cvt_pk_bf16_f32 v50, v68, v69
  v_cvt_pk_bf16_f32 v51, v70, v71
  v_cvt_pk_bf16_f32 v52, v72, v73
  v_cvt_pk_bf16_f32 v53, v74, v75
  v_cvt_pk_bf16_f32 v54, v76, v77
  v_cvt_pk_bf16_f32 v55, v78, v79
  s_waitcnt lgkmcnt(0)
  v_mfma_f32_32x32x16_bf16 v[144:159], v[32:35], v[48:51], v[144:159]
  v_mfma_f32_32x32x16_bf16 v[144:159], v[36:39], v[52:55], v[144:159]
  s_nop 11
  v_mov_b32 v5, v152
  v_mov_b32 v6, v152
  s_nop 1
  v_permlane32_swap_b32 v5, v6
  s_branch L_attn_fin
L_g2:
  s_cmp_eq_u32 s21, 0
  s_cbranch_scc0 L_g2w_63
  s_waitcnt vmcnt(0)
  s_mov_b32 s43, 0
L_wrt_65:
  v_cmp_eq_u32 vcc, 0, v248
  s_nop 0
  s_cmp_eq_u64 vcc, 0
  s_cbranch_scc1 L_wrd_66
  s_add_u32 s43, s43, 1
  s_cmp_ge_u32 s43, 200000
  s_cbranch_scc1 L_wrd_66
  s_sleep 2
  buffer_load_dword v248, v252, s[44:47], 0 offen sc1
  s_waitcnt vmcnt(0)
  s_branch L_wrt_65
L_wrd_66:
  s_add_u32 s40, s88, 0
  s_add_u32 m0, s89, 81920
  s_nop 0
  buffer_load_dwordx4 v236, s[12:15], s40 offen offset:0 sc1 lds
  s_add_u32 m0, s89, 81920
  s_nop 0
  buffer_load_dwordx4 v236, s[12:15], s40 offen offset:1024 sc1 lds
  s_add_u32 m0, s89, 81920
  s_nop 0
  buffer_load_dwordx4 v236, s[12:15], s40 offen offset:2048 sc1 lds
  s_add_u32 m0, s89, 81920
  s_nop 0
  buffer_load_dwordx4 v236, s[12:15], s40 offen offset:3072 sc1 lds
  s_add_u32 s41, s40, 4096
  s_add_u32 m0, s89, 86016
  s_nop 0
  buffer_load_dwordx4 v236, s[12:15], s41 offen sc1 lds
  s_add_u32 s40, s88, 40960
  s_add_u32 m0, s89, 122880
  s_nop 0
  buffer_load_dwordx4 v236, s[12:15], s40 offen offset:0 sc1 lds
  s_add_u32 m0, s89, 122880
  s_nop 0
  buffer_load_dwordx4 v236, s[12:15], s40 offen offset:1024 sc1 lds
  s_add_u32 m0, s89, 122880
  s_nop 0
  buffer_load_dwordx4 v236, s[12:15], s40 offen offset:2048 sc1 lds
  s_add_u32 m0, s89, 122880
  s_nop 0
  buffer_load_dwordx4 v236, s[12:15], s40 offen offset:3072 sc1 lds
  s_add_u32 s41, s40, 4096
  s_add_u32 m0, s89, 126976
  s_nop 0
  buffer_load_dwordx4 v236, s[12:15], s41 offen sc1 lds
  s_waitcnt vmcnt(5)
  s_branch L_g2w_64
L_g2w_63:
  s_waitcnt vmcnt(6)
L_g2w_64:
  v_lshlrev_b32 v16, 16, v226
  v_and_b32 v17, 0xffff0000, v226
  v_lshlrev_b32 v18, 16, v227
  v_and_b32 v19, 0xffff0000, v227
  v_lshlrev_b32 v20, 16, v228
  v_and_b32 v21, 0xffff0000, v228
  v_lshlrev_b32 v22, 16, v229
  v_and_b32 v23, 0xffff0000, v229
  v_lshlrev_b32 v24, 16, v230
  v_and_b32 v25, 0xffff0000, v230
  v_lshlrev_b32 v26, 16, v231
  v_and_b32 v27, 0xffff0000, v231
  v_lshlrev_b32 v28, 16, v232
  v_and_b32 v29, 0xffff0000, v232
  v_lshlrev_b32 v30, 16, v233
  v_and_b32 v31, 0xffff0000, v233
  v_lshlrev_b32 v32, 16, v234
  v_and_b32 v33, 0xffff0000, v234
  v_lshlrev_b32 v34, 16, v235
  v_and_b32 v35, 0xffff0000, v235
  s_cmp_eq_u32 s24, 0
  s_cbranch_scc1 L_g2z_67
  v_mov_b32 v16, 0
  v_mov_b32 v17, 0
  v_mov_b32 v18, 0
  v_mov_b32 v19, 0
  v_mov_b32 v20, 0
  v_mov_b32 v21, 0
  v_mov_b32 v22, 0
  v_mov_b32 v23, 0
  v_mov_b32 v24, 0
  v_mov_b32 v25, 0
  v_mov_b32 v26, 0
  v_mov_b32 v27, 0
  v_mov_b32 v28, 0
  v_mov_b32 v29, 0
  v_mov_b32 v30, 0
  v_mov_b32 v31, 0
  v_mov_b32 v32, 0
  v_mov_b32 v33, 0
  v_mov_b32 v34, 0
  v_mov_b32 v35, 0
L_g2z_67:
  s_barrier
  ds_read_b128 v[56:59], v240 offset:0
  ds_read_b128 v[60:63], v240 offset:1024
  ds_read_b128 v[64:67], v240 offset:2048
  ds_read_b128 v[68:71], v240 offset:3072
  ds_read_b128 v[72:75], v240 offset:4096
  ds_read_b128 v[76:79], v240 offset:10240
  ds_read_b128 v[80:83], v240 offset:11264
  ds_read_b128 v[84:87], v240 offset:12288
  ds_read_b128 v[88:91], v240 offset:13312
  ds_read_b128 v[92:95], v240 offset:14336
  s_add_u32 s40, s88, 81920
  s_add_u32 m0, s89, 0
  s_nop 0
  buffer_load_dwordx4 v236, s[12:15], s40 offen offset:0 sc1 lds
  s_add_u32 m0, s89, 0
  s_nop 0
  buffer_load_dwordx4 v236, s[12:15], s40 offen offset:1024 sc1 lds
  s_add_u32 m0, s89, 0
  s_nop 0
  buffer_load_dwordx4 v236, s[12:15], s40 offen offset:2048 sc1 lds
  s_waitcnt lgkmcnt(5)
  v_mfma_f32_16x16x32_bf16 v[16:19], v[56:59], v[160:163], v[16:19]
  v_mfma_f32_16x16x32_bf16 v[20:23], v[60:63], v[160:163], v[20:23]
  v_mfma_f32_16x16x32_bf16 v[24:27], v[64:67], v[160:163], v[24:27]
  v_mfma_f32_16x16x32_bf16 v[28:31], v[68:71], v[160:163], v[28:31]
  v_mfma_f32_16x16x32_bf16 v[32:35], v[72:75], v[160:163], v[32:35]
  ds_read_b128 v[56:59], v240 offset:20480
  ds_read_b128 v[60:63], v240 offset:21504
  ds_read_b128 v[64:67], v240 offset:22528
  ds_read_b128 v[68:71], v240 offset:23552
  ds_read_b128 v[72:75], v240 offset:24576
  s_add_u32 m0, s89, 0
  s_nop 0
  buffer_load_dwordx4 v236, s[12:15], s40 offen offset:3072 sc1 lds
  s_add_u32 s41, s40, 4096
  s_add_u32 m0, s89, 4096
  s_nop 0
  buffer_load_dwordx4 v236, s[12:15], s41 offen sc1 lds
  s_mov_b32 s41, 2097152
  buffer_load_dwordx4 v[192:195], v237, s[16:19], s41 offen sc1
  s_waitcnt lgkmcnt(5)
  v_mfma_f32_16x16x32_bf16 v[16:19], v[76:79], v[164:167], v[16:19]
  v_mfma_f32_16x16x32_bf16 v[20:23], v[80:83], v[164:167], v[20:23]
  v_mfma_f32_16x16x32_bf16 v[24:27], v[84:87], v[164:167], v[24:27]
  v_mfma_f32_16x16x32_bf16 v[28:31], v[88:91], v[164:167], v[28:31]
  v_mfma_f32_16x16x32_bf16 v[32:35], v[92:95], v[164:167], v[32:35]
  ds_read_b128 v[76:79], v240 offset:30720
  ds_read_b128 v[80:83], v240 offset:31744
  ds_read_b128 v[84:87], v240 offset:32768
  ds_read_b128 v[88:91], v240 offset:33792
  ds_read_b128 v[92:95], v240 offset:34816
  s_mov_b32 s41, 2359296
  buffer_load_dwordx4 v[196:199], v237, s[16:19], s41 offen sc1
  s_mov_b32 s41, 2621440
  buffer_load_dwordx4 v[200:203], v237, s[16:19], s41 offen sc1
  s_mov_b32 s41, 2883584
  buffer_load_dwordx4 v[204:207], v237, s[16:19], s41 offen sc1
  s_waitcnt lgkmcnt(5)
  v_mfma_f32_16x16x32_bf16 v[16:19], v[56:59], v[168:171], v[16:19]
  v_mfma_f32_16x16x32_bf16 v[20:23], v[60:63], v[168:171], v[20:23]
  v_mfma_f32_16x16x32_bf16 v[24:27], v[64:67], v[168:171], v[24:27]
  v_mfma_f32_16x16x32_bf16 v[28:31], v[68:71], v[168:171], v[28:31]
  v_mfma_f32_16x16x32_bf16 v[32:35], v[72:75], v[168:171], v[32:35]
  s_waitcnt lgkmcnt(0)
  v_mfma_f32_16x16x32_bf16 v[16:19], v[76:79], v[172:175], v[16:19]
  v_mfma_f32_16x16x32_bf16 v[20:23], v[80:83], v[172:175], v[20:23]
  v_mfma_f32_16x16x32_bf16 v[24:27], v[84:87], v[172:175], v[24:27]
  v_mfma_f32_16x16x32_bf16 v[28:31], v[88:91], v[172:175], v[28:31]
  v_mfma_f32_16x16x32_bf16 v[32:35], v[92:95], v[172:175], v[32:35]
  s_waitcnt vmcnt(9)
  s_barrier
  s_cmp_eq_u32 s3, 0
  s_cbranch_scc0 L_g2s_68
  s_lshl_b32 s42, s59, 7
  s_lshl_b32 s40, s58, 2
  s_add_u32 s42, s42, s40
  s_add_u32 s42, s42, 4096
  v_mov_b32 v6, 1
  v_mov_b32 v7, 0
  s_mov_b64 exec, 1
  buffer_store_dword v6, v7, s[44:47], s42 offen sc1
  s_mov_b64 exec, -1
L_g2s_68:
  ds_read_b128 v[56:59], v241 offset:0
  ds_read_b128 v[60:63], v241 offset:1024
  ds_read_b128 v[64:67], v241 offset:2048
  ds_read_b128 v[68:71], v241 offset:3072
  ds_read_b128 v[72:75], v241 offset:4096
  ds_read_b128 v[76:79], v241 offset:10240
  ds_read_b128 v[80:83], v241 offset:11264
  ds_read_b128 v[84:87], v241 offset:12288
  ds_read_b128 v[88:91], v241 offset:13312
  ds_read_b128 v[92:95], v241 offset:14336
  s_add_u32 s40, s88, 122880
  s_add_u32 m0, s89, 40960
  s_nop 0
  buffer_load_dwordx4 v236, s[12:15], s40 offen offset:0 sc1 lds
  s_add_u32 m0, s89, 40960
  s_nop 0
  buffer_load_dwordx4 v236, s[12:15], s40 offen offset:1024 sc1 lds
  s_add_u32 m0, s89, 40960
  s_nop 0
  buffer_load_dwordx4 v236, s[12:15], s40 offen offset:2048 sc1 lds
  s_waitcnt lgkmcnt(5)
  v_mfma_f32_16x16x32_bf16 v[16:19], v[56:59], v[176:179], v[16:19]
  v_mfma_f32_16x16x32_bf16 v[20:23], v[60:63], v[176:179], v[20:23]
  v_mfma_f32_16x16x32_bf16 v[24:27], v[64:67], v[176:179], v[24:27]
  v_mfma_f32_16x16x32_bf16 v[28:31], v[68:71], v[176:179], v[28:31]
  v_mfma_f32_16x16x32_bf16 v[32:35], v[72:75], v[176:179], v[32:35]
  ds_read_b128 v[56:59], v241 offset:20480
  ds_read_b128 v[60:63], v241 offset:21504
  ds_read_b128 v[64:67], v241 offset:22528
  ds_read_b128 v[68:71], v241 offset:23552
  ds_read_b128 v[72:75], v241 offset:24576
  s_add_u32 m0, s89, 40960
  s_nop 0
  buffer_load_dwordx4 v236, s[12:15], s40 offen offset:3072 sc1 lds
  s_add_u32 s41, s40, 4096
  s_add_u32 m0, s89, 45056
  s_nop 0
  buffer_load_dwordx4 v236, s[12:15], s41 offen sc1 lds
  s_mov_b32 s41, 3145728
  buffer_load_dwordx4 v[208:211], v237, s[16:19], s41 offen sc1
  s_waitcnt lgkmcnt(5)
  v_mfma_f32_16x16x32_bf16 v[16:19], v[76:79], v[180:183], v[16:19]
  v_mfma_f32_16x16x32_bf16 v[20:23], v[80:83], v[180:183], v[20:23]
  v_mfma_f32_16x16x32_bf16 v[24:27], v[84:87], v[180:183], v[24:27]
  v_mfma_f32_16x16x32_bf16 v[28:31], v[88:91], v[180:183], v[28:31]
  v_mfma_f32_16x16x32_bf16 v[32:35], v[92:95], v[180:183], v[32:35]
  ds_read_b128 v[76:79], v241 offset:30720
  ds_read_b128 v[80:83], v241 offset:31744
  ds_read_b128 v[84:87], v241 offset:32768
  ds_read_b128 v[88:91], v241 offset:33792
  ds_read_b128 v[92:95], v241 offset:34816
  s_mov_b32 s41, 3407872
  buffer_load_dwordx4 v[212:215], v237, s[16:19], s41 offen sc1
  s_mov_b32 s41, 3670016
  buffer_load_dwordx4 v[216:219], v237, s[16:19], s41 offen sc1
  s_mov_b32 s41, 3932160
  buffer_load_dwordx4 v[220:223], v237, s[16:19], s41 offen sc1
  s_waitcnt lgkmcnt(5)
  v_mfma_f32_16x16x32_bf16 v[16:19], v[56:59], v[184:187], v[16:19]
  v_mfma_f32_16x16x32_bf16 v[20:23], v[60:63], v[184:187], v[20:23]
  v_mfma_f32_16x16x32_bf16 v[24:27], v[64:67], v[184:187], v[24:27]
  v_mfma_f32_16x16x32_bf16 v[28:31], v[68:71], v[184:187], v[28:31]
  v_mfma_f32_16x16x32_bf16 v[32:35], v[72:75], v[184:187], v[32:35]
  s_waitcnt lgkmcnt(0)
  v_mfma_f32_16x16x32_bf16 v[16:19], v[76:79], v[188:191], v[16:19]
  v_mfma_f32_16x16x32_bf16 v[20:23], v[80:83], v[188:191], v[20:23]
  v_mfma_f32_16x16x32_bf16 v[24:27], v[84:87], v[188:191], v[24:27]
  v_mfma_f32_16x16x32_bf16 v[28:31], v[88:91], v[188:191], v[28:31]
  v_mfma_f32_16x16x32_bf16 v[32:35], v[92:95], v[188:191], v[32:35]
  s_waitcnt vmcnt(9)
  s_barrier
  ds_read_b128 v[56:59], v242 offset:0
  ds_read_b128 v[60:63], v242 offset:1024
  ds_read_b128 v[64:67], v242 offset:2048
  ds_read_b128 v[68:71], v242 offset:3072
  ds_read_b128 v[72:75], v242 offset:4096
  ds_read_b128 v[76:79], v242 offset:10240
  ds_read_b128 v[80:83], v242 offset:11264
  ds_read_b128 v[84:87], v242 offset:12288
  ds_read_b128 v[88:91], v242 offset:13312
  ds_read_b128 v[92:95], v242 offset:14336
  s_add_u32 s40, s88, 163840
  s_add_u32 m0, s89, 81920
  s_nop 0
  buffer_load_dwordx4 v236, s[12:15], s40 offen offset:0 sc1 lds
  s_add_u32 m0, s89, 81920
  s_nop 0
  buffer_load_dwordx4 v236, s[12:15], s40 offen offset:1024 sc1 lds
  s_add_u32 m0, s89, 81920
  s_nop 0
  buffer_load_dwordx4 v236, s[12:15], s40 offen offset:2048 sc1 lds
  s_waitcnt lgkmcnt(5)
  v_mfma_f32_16x16x32_bf16 v[16:19], v[56:59], v[192:195], v[16:19]
  v_mfma_f32_16x16x32_bf16 v[20:23], v[60:63], v[192:195], v[20:23]
  v_mfma_f32_16x16x32_bf16 v[24:27], v[64:67], v[192:195], v[24:27]
  v_mfma_f32_16x16x32_bf16 v[28:31], v[68:71], v[192:195], v[28:31]
  v_mfma_f32_16x16x32_bf16 v[32:35], v[72:75], v[192:195], v[32:35]
  ds_read_b128 v[56:59], v242 offset:20480
  ds_read_b128 v[60:63], v242 offset:21504
  ds_read_b128 v[64:67], v242 offset:22528
  ds_read_b128 v[68:71], v242 offset:23552
  ds_read_b128 v[72:75], v242 offset:24576
  s_add_u32 m0, s89, 81920
  s_nop 0
  buffer_load_dwordx4 v236, s[12:15], s40 offen offset:3072 sc1 lds
  s_add_u32 s41, s40, 4096
  s_add_u32 m0, s89, 86016
  s_nop 0
  buffer_load_dwordx4 v236, s[12:15], s41 offen sc1 lds
  s_mov_b32 s41, 4194304
  buffer_load_dwordx4 v[160:163], v237, s[16:19], s41 offen sc1
  s_waitcnt lgkmcnt(5)
  v_mfma_f32_16x16x32_bf16 v[16:19], v[76:79], v[196:199], v[16:19]
  v_mfma_f32_16x16x32_bf16 v[20:23], v[80:83], v[196:199], v[20:23]
  v_mfma_f32_16x16x32_bf16 v[24:27], v[84:87], v[196:199], v[24:27]
  v_mfma_f32_16x16x32_bf16 v[28:31], v[88:91], v[196:199], v[28:31]
  v_mfma_f32_16x16x32_bf16 v[32:35], v[92:95], v[196:199], v[32:35]
  ds_read_b128 v[76:79], v242 offset:30720
  ds_read_b128 v[80:83], v242 offset:31744
  ds_read_b128 v[84:87], v242 offset:32768
  ds_read_b128 v[88:91], v242 offset:33792
  ds_read_b128 v[92:95], v242 offset:34816
  s_mov_b32 s41, 4456448
  buffer_load_dwordx4 v[164:167], v237, s[16:19], s41 offen sc1
  s_mov_b32 s41, 4718592
  buffer_load_dwordx4 v[168:171], v237, s[16:19], s41 offen sc1
  s_mov_b32 s41, 4980736
  buffer_load_dwordx4 v[172:175], v237, s[16:19], s41 offen sc1
  s_waitcnt lgkmcnt(5)
  v_mfma_f32_16x16x32_bf16 v[16:19], v[56:59], v[200:203], v[16:19]
  v_mfma_f32_16x16x32_bf16 v[20:23], v[60:63], v[200:203], v[20:23]
  v_mfma_f32_16x16x32_bf16 v[24:27], v[64:67], v[200:203], v[24:27]
  v_mfma_f32_16x16x32_bf16 v[28:31], v[68:71], v[200:203], v[28:31]
  v_mfma_f32_16x16x32_bf16 v[32:35], v[72:75], v[200:203], v[32:35]
  s_waitcnt lgkmcnt(0)
  v_mfma_f32_16x16x32_bf16 v[16:19], v[76:79], v[204:207], v[16:19]
  v_mfma_f32_16x16x32_bf16 v[20:23], v[80:83], v[204:207], v[20:23]
  v_mfma_f32_16x16x32_bf16 v[24:27], v[84:87], v[204:207], v[24:27]
  v_mfma_f32_16x16x32_bf16 v[28:31], v[88:91], v[204:207], v[28:31]
  v_mfma_f32_16x16x32_bf16 v[32:35], v[92:95], v[204:207], v[32:35]
  s_waitcnt vmcnt(9)
  s_barrier
  ds_read_b128 v[56:59], v243 offset:0
  ds_read_b128 v[60:63], v243 offset:1024
  ds_read_b128 v[64:67], v243 offset:2048
  ds_read_b128 v[68:71], v243 offset:3072
  ds_read_b128 v[72:75], v243 offset:4096
  ds_read_b128 v[76:79], v243 offset:10240
  ds_read_b128 v[80:83], v243 offset:11264
  ds_read_b128 v[84:87], v243 offset:12288
  ds_read_b128 v[88:91], v243 offset:13312
  ds_read_b128 v[92:95], v243 offset:14336
  s_add_u32 s40, s88, 204800
  s_add_u32 m0, s89, 122880
  s_nop 0
  buffer_load_dwordx4 v236, s[12:15], s40 offen offset:0 sc1 lds
  s_add_u32 m0, s89, 122880
  s_nop 0
  buffer_load_dwordx4 v236, s[12:15], s40 offen offset:1024 sc1 lds
  s_add_u32 m0, s89, 122880
  s_nop 0
  buffer_load_dwordx4 v236, s[12:15], s40 offen offset:2048 sc1 lds
  s_waitcnt lgkmcnt(5)
  v_mfma_f32_16x16x32_bf16 v[16:19], v[56:59], v[208:211], v[16:19]
  v_mfma_f32_16x16x32_bf16 v[20:23], v[60:63], v[208:211], v[20:23]
  v_mfma_f32_16x16x32_bf16 v[24:27], v[64:67], v[208:211], v[24:27]
  v_mfma_f32_16x16x32_bf16 v[28:31], v[68:71], v[208:211], v[28:31]
  v_mfma_f32_16x16x32_bf16 v[32:35], v[72:75], v[208:211], v[32:35]
  ds_read_b128 v[56:59], v243 offset:20480
  ds_read_b128 v[60:63], v243 offset:21504
  ds_read_b128 v[64:67], v243 offset:22528
  ds_read_b128 v[68:71], v243 offset:23552
  ds_read_b128 v[72:75], v243 offset:24576
  s_add_u32 m0, s89, 122880
  s_nop 0
  buffer_load_dwordx4 v236, s[12:15], s40 offen offset:3072 sc1 lds
  s_add_u32 s41, s40, 4096
  s_add_u32 m0, s89, 126976
  s_nop 0
  buffer_load_dwordx4 v236, s[12:15], s41 offen sc1 lds
  s_mov_b32 s41, 5242880
  buffer_load_dwordx4 v[176:179], v237, s[16:19], s41 offen sc1
  s_waitcnt lgkmcnt(5)
  v_mfma_f32_16x16x32_bf16 v[16:19], v[76:79], v[212:215], v[16:19]
  v_mfma_f32_16x16x32_bf16 v[20:23], v[80:83], v[212:215], v[20:23]
  v_mfma_f32_16x16x32_bf16 v[24:27], v[84:87], v[212:215], v[24:27]
  v_mfma_f32_16x16x32_bf16 v[28:31], v[88:91], v[212:215], v[28:31]
  v_mfma_f32_16x16x32_bf16 v[32:35], v[92:95], v[212:215], v[32:35]
  ds_read_b128 v[76:79], v243 offset:30720
  ds_read_b128 v[80:83], v243 offset:31744
  ds_read_b128 v[84:87], v243 offset:32768
  ds_read_b128 v[88:91], v243 offset:33792
  ds_read_b128 v[92:95], v243 offset:34816
  s_mov_b32 s41, 5505024
  buffer_load_dwordx4 v[180:183], v237, s[16:19], s41 offen sc1
  s_mov_b32 s41, 5767168
  buffer_load_dwordx4 v[184:187], v237, s[16:19], s41 offen sc1
  s_mov_b32 s41, 6029312
  buffer_load_dwordx4 v[188:191], v237, s[16:19], s41 offen sc1
  s_waitcnt lgkmcnt(5)
  v_mfma_f32_16x16x32_bf16 v[16:19], v[56:59], v[216:219], v[16:19]
  v_mfma_f32_16x16x32_bf16 v[20:23], v[60:63], v[216:219], v[20:23]
  v_mfma_f32_16x16x32_bf16 v[24:27], v[64:67], v[216:219], v[24:27]
  v_mfma_f32_16x16x32_bf16 v[28:31], v[68:71], v[216:219], v[28:31]
  v_mfma_f32_16x16x32_bf16 v[32:35], v[72:75], v[216:219], v[32:35]
  s_waitcnt lgkmcnt(0)
  v_mfma_f32_16x16x32_bf16 v[16:19], v[76:79], v[220:223], v[16:19]
  v_mfma_f32_16x16x32_bf16 v[20:23], v[80:83], v[220:223], v[20:23]
  v_mfma_f32_16x16x32_bf16 v[24:27], v[84:87], v[220:223], v[24:27]
  v_mfma_f32_16x16x32_bf16 v[28:31], v[88:91], v[220:223], v[28:31]
  v_mfma_f32_16x16x32_bf16 v[32:35], v[92:95], v[220:223], v[32:35]
  s_waitcnt vmcnt(9)
  s_barrier
  s_cmp_eq_u32 s3, 0
  s_cbranch_scc0 L_g2p_69
  buffer_load_dword v238, v245, s[44:47], 0 offen sc1
L_g2p_69:
  ds_read_b128 v[56:59], v240 offset:0
  ds_read_b128 v[60:63], v240 offset:1024
  ds_read_b128 v[64:67], v240 offset:2048
  ds_read_b128 v[68:71], v240 offset:3072
  ds_read_b128 v[72:75], v240 offset:4096
  ds_read_b128 v[76:79], v240 offset:10240
  ds_read_b128 v[80:83], v240 offset:11264
  ds_read_b128 v[84:87], v240 offset:12288
  ds_read_b128 v[88:91], v240 offset:13312
  ds_read_b128 v[92:95], v240 offset:14336
  s_cmp_ge_u32 s3, 6
  s_cselect_b32 s40, 0x7ff00000, 0
  s_add_u32 s40, s40, s88
  s_add_u32 s40, s40, 245760
  s_add_u32 m0, s89, 0
  s_nop 0
  buffer_load_dwordx4 v236, s[12:15], s40 offen offset:0 sc1 lds
  s_add_u32 m0, s89, 0
  s_nop 0
  buffer_load_dwordx4 v236, s[12:15], s40 offen offset:1024 sc1 lds
  s_add_u32 m0, s89, 0
  s_nop 0
  buffer_load_dwordx4 v236, s[12:15], s40 offen offset:2048 sc1 lds
  s_waitcnt lgkmcnt(5)
  v_mfma_f32_16x16x32_bf16 v[16:19], v[56:59], v[160:163], v[16:19]
  v_mfma_f32_16x16x32_bf16 v[20:23], v[60:63], v[160:163], v[20:23]
  v_mfma_f32_16x16x32_bf16 v[24:27], v[64:67], v[160:163], v[24:27]
  v_mfma_f32_16x16x32_bf16 v[28:31], v[68:71], v[160:163], v[28:31]
  v_mfma_f32_16x16x32_bf16 v[32:35], v[72:75], v[160:163], v[32:35]
  ds_read_b128 v[56:59], v240 offset:20480
  ds_read_b128 v[60:63], v240 offset:21504
  ds_read_b128 v[64:67], v240 offset:22528
  ds_read_b128 v[68:71], v240 offset:23552
  ds_read_b128 v[72:75], v240 offset:24576
  s_add_u32 m0, s89, 0
  s_nop 0
  buffer_load_dwordx4 v236, s[12:15], s40 offen offset:3072 sc1 lds
  s_add_u32 s41, s40, 4096
  s_add_u32 m0, s89, 4096
  s_nop 0
  buffer_load_dwordx4 v236, s[12:15], s41 offen sc1 lds
  s_mov_b32 s41, 6291456
  buffer_load_dwordx4 v[192:195], v237, s[16:19], s41 offen sc1
  s_waitcnt lgkmcnt(5)
  v_mfma_f32_16x16x32_bf16 v[16:19], v[76:79], v[164:167], v[16:19]
  v_mfma_f32_16x16x32_bf16 v[20:23], v[80:83], v[164:167], v[20:23]
  v_mfma_f32_16x16x32_bf16 v[24:27], v[84:87], v[164:167], v[24:27]
  v_mfma_f32_16x16x32_bf16 v[28:31], v[88:91], v[164:167], v[28:31]
  v_mfma_f32_16x16x32_bf16 v[32:35], v[92:95], v[164:167], v[32:35]
  ds_read_b128 v[76:79], v240 offset:30720
  ds_read_b128 v[80:83], v240 offset:31744
  ds_read_b128 v[84:87], v240 offset:32768
  ds_read_b128 v[88:91], v240 offset:33792
  ds_read_b128 v[92:95], v240 offset:34816
  s_mov_b32 s41, 6553600
  buffer_load_dwordx4 v[196:199], v237, s[16:19], s41 offen sc1
  s_mov_b32 s41, 6815744
  buffer_load_dwordx4 v[200:203], v237, s[16:19], s41 offen sc1
  s_mov_b32 s41, 2146435072
  buffer_load_dwordx4 v[204:207], v237, s[16:19], s41 offen sc1
  s_waitcnt lgkmcnt(5)
  v_mfma_f32_16x16x32_bf16 v[16:19], v[56:59], v[168:171], v[16:19]
  v_mfma_f32_16x16x32_bf16 v[20:23], v[60:63], v[168:171], v[20:23]
  v_mfma_f32_16x16x32_bf16 v[24:27], v[64:67], v[168:171], v[24:27]
  v_mfma_f32_16x16x32_bf16 v[28:31], v[68:71], v[168:171], v[28:31]
  v_mfma_f32_16x16x32_bf16 v[32:35], v[72:75], v[168:171], v[32:35]
  s_waitcnt lgkmcnt(0)
  v_mfma_f32_16x16x32_bf16 v[16:19], v[76:79], v[172:175], v[16:19]
  v_mfma_f32_16x16x32_bf16 v[20:23], v[80:83], v[172:175], v[20:23]
  v_mfma_f32_16x16x32_bf16 v[24:27], v[84:87], v[172:175], v[24:27]
  v_mfma_f32_16x16x32_bf16 v[28:31], v[88:91], v[172:175], v[28:31]
  v_mfma_f32_16x16x32_bf16 v[32:35], v[92:95], v[172:175], v[32:35]
  s_waitcnt vmcnt(9)
  s_cmp_eq_u32 s3, 0
  s_cbranch_scc0 L_g2c_70
  s_waitcnt vmcnt(9)
  s_mov_b32 s43, 0
L_wct_71:
  v_cmp_eq_u32 vcc, 0, v238
  s_nop 0
  s_cmp_eq_u64 vcc, 0
  s_cbranch_scc1 L_wcd_72
  s_add_u32 s43, s43, 1
  s_cmp_ge_u32 s43, 200000
  s_cbranch_scc1 L_wcd_72
  s_sleep 2
  buffer_load_dword v238, v245, s[44:47], 0 offen sc1
  s_waitcnt vmcnt(0)
  s_branch L_wct_71
L_wcd_72:
L_g2c_70:
  s_barrier
  ds_read_b128 v[56:59], v241 offset:0
  ds_read_b128 v[60:63], v241 offset:1024
  ds_read_b128 v[64:67], v241 offset:2048
  ds_read_b128 v[68:71], v241 offset:3072
  ds_read_b128 v[72:75], v241 offset:4096
  ds_read_b128 v[76:79], v241 offset:10240
  ds_read_b128 v[80:83], v241 offset:11264
  ds_read_b128 v[84:87], v241 offset:12288
  ds_read_b128 v[88:91], v241 offset:13312
  ds_read_b128 v[92:95], v241 offset:14336
  s_add_u32 s40, s88, 276480
  s_add_u32 m0, s89, 40960
  s_nop 0
  buffer_load_dwordx4 v236, s[12:15], s40 offen offset:0 sc1 lds
  s_add_u32 m0, s89, 40960
  s_nop 0
  buffer_load_dwordx4 v236, s[12:15], s40 offen offset:1024 sc1 lds
  s_add_u32 m0, s89, 40960
  s_nop 0
  buffer_load_dwordx4 v236, s[12:15], s40 offen offset:2048 sc1 lds
  s_waitcnt lgkmcnt(5)
  v_mfma_f32_16x16x32_bf16 v[16:19], v[56:59], v[176:179], v[16:19]
  v_mfma_f32_16x16x32_bf16 v[20:23], v[60:63], v[176:179], v[20:23]
  v_mfma_f32_16x16x32_bf16 v[24:27], v[64:67], v[176:179], v[24:27]
  v_mfma_f32_16x16x32_bf16 v[28:31], v[68:71], v[176:179], v[28:31]
  v_mfma_f32_16x16x32_bf16 v[32:35], v[72:75], v[176:179], v[32:35]
  ds_read_b128 v[56:59], v241 offset:20480
  ds_read_b128 v[60:63], v241 offset:21504
  ds_read_b128 v[64:67], v241 offset:22528
  ds_read_b128 v[68:71], v241 offset:23552
  ds_read_b128 v[72:75], v241 offset:24576
  s_add_u32 m0, s89, 40960
  s_nop 0
  buffer_load_dwordx4 v236, s[12:15], s40 offen offset:3072 sc1 lds
  s_add_u32 s41, s40, 4096
  s_add_u32 m0, s89, 45056
  s_nop 0
  buffer_load_dwordx4 v236, s[12:15], s41 offen sc1 lds
  s_mov_b32 s41, 0
  buffer_load_dwordx4 v[208:211], v237, s[28:31], s41 offen sc1
  s_waitcnt lgkmcnt(5)
  v_mfma_f32_16x16x32_bf16 v[16:19], v[76:79], v[180:183], v[16:19]
  v_mfma_f32_16x16x32_bf16 v[20:23], v[80:83], v[180:183], v[20:23]
  v_mfma_f32_16x16x32_bf16 v[24:27], v[84:87], v[180:183], v[24:27]
  v_mfma_f32_16x16x32_bf16 v[28:31], v[88:91], v[180:183], v[28:31]
  v_mfma_f32_16x16x32_bf16 v[32:35], v[92:95], v[180:183], v[32:35]
  ds_read_b128 v[76:79], v241 offset:30720
  ds_read_b128 v[80:83], v241 offset:31744
  ds_read_b128 v[84:87], v241 offset:32768
  ds_read_b128 v[88:91], v241 offset:33792
  ds_read_b128 v[92:95], v241 offset:34816
  s_mov_b32 s41, 262144
  buffer_load_dwordx4 v[212:215], v237, s[28:31], s41 offen sc1
  s_mov_b32 s41, 524288
  buffer_load_dwordx4 v[216:219], v237, s[28:31], s41 offen sc1
  s_mov_b32 s41, 786432
  buffer_load_dwordx4 v[220:223], v237, s[28:31], s41 offen sc1
  s_waitcnt lgkmcnt(5)
  v_mfma_f32_16x16x32_bf16 v[16:19], v[56:59], v[184:187], v[16:19]
  v_mfma_f32_16x16x32_bf16 v[20:23], v[60:63], v[184:187], v[20:23]
  v_mfma_f32_16x16x32_bf16 v[24:27], v[64:67], v[184:187], v[24:27]
  v_mfma_f32_16x16x32_bf16 v[28:31], v[68:71], v[184:187], v[28:31]
  v_mfma_f32_16x16x32_bf16 v[32:35], v[72:75], v[184:187], v[32:35]
  s_waitcnt lgkmcnt(0)
  v_mfma_f32_16x16x32_bf16 v[16:19], v[76:79], v[188:191], v[16:19]
  v_mfma_f32_16x16x32_bf16 v[20:23], v[80:83], v[188:191], v[20:23]
  v_mfma_f32_16x16x32_bf16 v[24:27], v[84:87], v[188:191], v[24:27]
  v_mfma_f32_16x16x32_bf16 v[28:31], v[88:91], v[188:191], v[28:31]
  v_mfma_f32_16x16x32_bf16 v[32:35], v[92:95], v[188:191], v[32:35]
  s_waitcnt vmcnt(9)
  s_barrier
  ds_read_b128 v[56:59], v242 offset:0
  ds_read_b128 v[60:63], v242 offset:1024
  ds_read_b128 v[64:67], v242 offset:2048
  ds_read_b128 v[68:71], v242 offset:3072
  ds_read_b128 v[72:75], v242 offset:4096
  ds_read_b128 v[76:79], v242 offset:10240
  ds_read_b128 v[80:83], v242 offset:11264
  ds_read_b128 v[84:87], v242 offset:12288
  ds_read_b128 v[88:91], v242 offset:13312
  ds_read_b128 v[92:95], v242 offset:14336
  s_add_u32 s40, s88, 317440
  s_add_u32 m0, s89, 81920
  s_nop 0
  buffer_load_dwordx4 v236, s[12:15], s40 offen offset:0 sc1 lds
  s_add_u32 m0, s89, 81920
  s_nop 0
  buffer_load_dwordx4 v236, s[12:15], s40 offen offset:1024 sc1 lds
  s_add_u32 m0, s89, 81920
  s_nop 0
  buffer_load_dwordx4 v236, s[12:15], s40 offen offset:2048 sc1 lds
  s_waitcnt lgkmcnt(5)
  v_mfma_f32_16x16x32_bf16 v[16:19], v[56:59], v[192:195], v[16:19]
  v_mfma_f32_16x16x32_bf16 v[20:23], v[60:63], v[192:195], v[20:23]
  v_mfma_f32_16x16x32_bf16 v[24:27], v[64:67], v[192:195], v[24:27]
  v_mfma_f32_16x16x32_bf16 v[28:31], v[68:71], v[192:195], v[28:31]
  v_mfma_f32_16x16x32_bf16 v[32:35], v[72:75], v[192:195], v[32:35]
  ds_read_b128 v[56:59], v242 offset:20480
  ds_read_b128 v[60:63], v242 offset:21504
  ds_read_b128 v[64:67], v242 offset:22528
  ds_read_b128 v[68:71], v242 offset:23552
  ds_read_b128 v[72:75], v242 offset:24576
  s_add_u32 m0, s89, 81920
  s_nop 0
  buffer_load_dwordx4 v236, s[12:15], s40 offen offset:3072 sc1 lds
  s_add_u32 s41, s40, 4096
  s_add_u32 m0, s89, 86016
  s_nop 0
  buffer_load_dwordx4 v236, s[12:15], s41 offen sc1 lds
  s_mov_b32 s41, 1048576
  buffer_load_dwordx4 v[160:163], v237, s[28:31], s41 offen sc1
  s_waitcnt lgkmcnt(5)
  v_mfma_f32_16x16x32_bf16 v[16:19], v[76:79], v[196:199], v[16:19]
  v_mfma_f32_16x16x32_bf16 v[20:23], v[80:83], v[196:199], v[20:23]
  v_mfma_f32_16x16x32_bf16 v[24:27], v[84:87], v[196:199], v[24:27]
  v_mfma_f32_16x16x32_bf16 v[28:31], v[88:91], v[196:199], v[28:31]
  v_mfma_f32_16x16x32_bf16 v[32:35], v[92:95], v[196:199], v[32:35]
  s_mov_b32 s41, 1310720
  buffer_load_dwordx4 v[164:167], v237, s[28:31], s41 offen sc1
  s_mov_b32 s41, 1572864
  buffer_load_dwordx4 v[168:171], v237, s[28:31], s41 offen sc1
  s_mov_b32 s41, 1835008
  buffer_load_dwordx4 v[172:175], v237, s[28:31], s41 offen sc1
  s_waitcnt lgkmcnt(0)
  v_mfma_f32_16x16x32_bf16 v[16:19], v[56:59], v[200:203], v[16:19]
  v_mfma_f32_16x16x32_bf16 v[20:23], v[60:63], v[200:203], v[20:23]
  v_mfma_f32_16x16x32_bf16 v[24:27], v[64:67], v[200:203], v[24:27]
  v_mfma_f32_16x16x32_bf16 v[28:31], v[68:71], v[200:203], v[28:31]
  v_mfma_f32_16x16x32_bf16 v[32:35], v[72:75], v[200:203], v[32:35]
  s_waitcnt vmcnt(9)
  s_barrier
  ds_read_b128 v[56:59], v243 offset:0
  ds_read_b128 v[60:63], v243 offset:1024
  ds_read_b128 v[64:67], v243 offset:2048
  ds_read_b128 v[68:71], v243 offset:3072
  ds_read_b128 v[72:75], v243 offset:4096
  ds_read_b128 v[76:79], v243 offset:10240
  ds_read_b128 v[80:83], v243 offset:11264
  ds_read_b128 v[84:87], v243 offset:12288
  ds_read_b128 v[88:91], v243 offset:13312
  ds_read_b128 v[92:95], v243 offset:14336
  s_cmp_ge_u32 s3, 4
  s_cselect_b32 s40, 0x7ff00000, 0
  s_add_u32 s40, s40, s88
  s_add_u32 s40, s40, 358400
  s_add_u32 m0, s89, 122880
  s_nop 0
  buffer_load_dwordx4 v236, s[12:15], s40 offen offset:0 sc1 lds
  s_add_u32 m0, s89, 122880
  s_nop 0
  buffer_load_dwordx4 v236, s[12:15], s40 offen offset:1024 sc1 lds
  s_add_u32 m0, s89, 122880
  s_nop 0
  buffer_load_dwordx4 v236, s[12:15], s40 offen offset:2048 sc1 lds
  s_waitcnt lgkmcnt(5)
  v_mfma_f32_16x16x32_bf16 v[36:39], v[56:59], v[208:211], 0
  v_mfma_f32_16x16x32_bf16 v[40:43], v[60:63], v[208:211], 0
  v_mfma_f32_16x16x32_bf16 v[44:47], v[64:67], v[208:211], 0
  v_mfma_f32_16x16x32_bf16 v[48:51], v[68:71], v[208:211], 0
  v_mfma_f32_16x16x32_bf16 v[52:55], v[72:75], v[208:211], 0
  ds_read_b128 v[56:59], v243 offset:20480
  ds_read_b128 v[60:63], v243 offset:21504
  ds_read_b128 v[64:67], v243 offset:22528
  ds_read_b128 v[68:71], v243 offset:23552
  ds_read_b128 v[72:75], v243 offset:24576
  s_add_u32 m0, s89, 122880
  s_nop 0
  buffer_load_dwordx4 v236, s[12:15], s40 offen offset:3072 sc1 lds
  s_add_u32 s41, s40, 4096
  s_add_u32 m0, s89, 126976
  s_nop 0
  buffer_load_dwordx4 v236, s[12:15], s41 offen sc1 lds
  s_mov_b32 s41, 2097152
  buffer_load_dwordx4 v[176:179], v237, s[28:31], s41 offen sc1
  s_waitcnt lgkmcnt(5)
  v_mfma_f32_16x16x32_bf16 v[36:39], v[76:79], v[212:215], v[36:39]
  v_mfma_f32_16x16x32_bf16 v[40:43], v[80:83], v[212:215], v[40:43]
  v_mfma_f32_16x16x32_bf16 v[44:47], v[84:87], v[212:215], v[44:47]
  v_mfma_f32_16x16x32_bf16 v[48:51], v[88:91], v[212:215], v[48:51]
  v_mfma_f32_16x16x32_bf16 v[52:55], v[92:95], v[212:215], v[52:55]
  ds_read_b128 v[76:79], v243 offset:30720
  ds_read_b128 v[80:83], v243 offset:31744
  ds_read_b128 v[84:87], v243 offset:32768
  ds_read_b128 v[88:91], v243 offset:33792
  ds_read_b128 v[92:95], v243 offset:34816
  s_mov_b32 s41, 2359296
  buffer_load_dwordx4 v[180:183], v237, s[28:31], s41 offen sc1
  s_mov_b32 s41, 2146435072
  buffer_load_dwordx4 v[184:187], v237, s[28:31], s41 offen sc1
  s_mov_b32 s41, 2146435072
  buffer_load_dwordx4 v[188:191], v237, s[28:31], s41 offen sc1
  s_waitcnt lgkmcnt(5)
  v_mfma_f32_16x16x32_bf16 v[36:39], v[56:59], v[216:219], v[36:39]
  v_mfma_f32_16x16x32_bf16 v[40:43], v[60:63], v[216:219], v[40:43]
  v_mfma_f32_16x16x32_bf16 v[44:47], v[64:67], v[216:219], v[44:47]
  v_mfma_f32_16x16x32_bf16 v[48:51], v[68:71], v[216:219], v[48:51]
  v_mfma_f32_16x16x32_bf16 v[52:55], v[72:75], v[216:219], v[52:55]
  s_waitcnt lgkmcnt(0)
  v_mfma_f32_16x16x32_bf16 v[36:39], v[76:79], v[220:223], v[36:39]
  v_mfma_f32_16x16x32_bf16 v[40:43], v[80:83], v[220:223], v[40:43]
  v_mfma_f32_16x16x32_bf16 v[44:47], v[84:87], v[220:223], v[44:47]
  v_mfma_f32_16x16x32_bf16 v[48:51], v[88:91], v[220:223], v[48:51]
  v_mfma_f32_16x16x32_bf16 v[52:55], v[92:95], v[220:223], v[52:55]
  s_waitcnt vmcnt(9)
  s_barrier
  ds_read_b128 v[56:59], v240 offset:0
  ds_read_b128 v[60:63], v240 offset:1024
  ds_read_b128 v[64:67], v240 offset:2048
  ds_read_b128 v[68:71], v240 offset:3072
  ds_read_b128 v[72:75], v240 offset:4096
  ds_read_b128 v[76:79], v240 offset:10240
  ds_read_b128 v[80:83], v240 offset:11264
  ds_read_b128 v[84:87], v240 offset:12288
  ds_read_b128 v[88:91], v240 offset:13312
  ds_read_b128 v[92:95], v240 offset:14336
  s_waitcnt lgkmcnt(5)
  v_mfma_f32_16x16x32_bf16 v[36:39], v[56:59], v[160:163], v[36:39]
  v_mfma_f32_16x16x32_bf16 v[40:43], v[60:63], v[160:163], v[40:43]
  v_mfma_f32_16x16x32_bf16 v[44:47], v[64:67], v[160:163], v[44:47]
  v_mfma_f32_16x16x32_bf16 v[48:51], v[68:71], v[160:163], v[48:51]
  v_mfma_f32_16x16x32_bf16 v[52:55], v[72:75], v[160:163], v[52:55]
  ds_read_b128 v[56:59], v240 offset:20480
  ds_read_b128 v[60:63], v240 offset:21504
  ds_read_b128 v[64:67], v240 offset:22528
  ds_read_b128 v[68:71], v240 offset:23552
  ds_read_b128 v[72:75], v240 offset:24576
  s_waitcnt lgkmcnt(5)
  v_mfma_f32_16x16x32_bf16 v[36:39], v[76:79], v[164:167], v[36:39]
  v_mfma_f32_16x16x32_bf16 v[40:43], v[80:83], v[164:167], v[40:43]
  v_mfma_f32_16x16x32_bf16 v[44:47], v[84:87], v[164:167], v[44:47]
  v_mfma_f32_16x16x32_bf16 v[48:51], v[88:91], v[164:167], v[48:51]
  v_mfma_f32_16x16x32_bf16 v[52:55], v[92:95], v[164:167], v[52:55]
  ds_read_b128 v[76:79], v240 offset:30720
  ds_read_b128 v[80:83], v240 offset:31744
  ds_read_b128 v[84:87], v240 offset:32768
  ds_read_b128 v[88:91], v240 offset:33792
  ds_read_b128 v[92:95], v240 offset:34816
  s_waitcnt lgkmcnt(5)
  v_mfma_f32_16x16x32_bf16 v[36:39], v[56:59], v[168:171], v[36:39]
  v_mfma_f32_16x16x32_bf16 v[40:43], v[60:63], v[168:171], v[40:43]
  v_mfma_f32_16x16x32_bf16 v[44:47], v[64:67], v[168:171], v[44:47]
  v_mfma_f32_16x16x32_bf16 v[48:51], v[68:71], v[168:171], v[48:51]
  v_mfma_f32_16x16x32_bf16 v[52:55], v[72:75], v[168:171], v[52:55]
  s_waitcnt lgkmcnt(0)
  v_mfma_f32_16x16x32_bf16 v[36:39], v[76:79], v[172:175], v[36:39]
  v_mfma_f32_16x16x32_bf16 v[40:43], v[80:83], v[172:175], v[40:43]
  v_mfma_f32_16x16x32_bf16 v[44:47], v[84:87], v[172:175], v[44:47]
  v_mfma_f32_16x16x32_bf16 v[48:51], v[88:91], v[172:175], v[48:51]
  v_mfma_f32_16x16x32_bf16 v[52:55], v[92:95], v[172:175], v[52:55]
  s_waitcnt vmcnt(0)
  s_barrier
  ds_read_b128 v[56:59], v241 offset:0
  ds_read_b128 v[60:63], v241 offset:1024
  ds_read_b128 v[64:67], v241 offset:2048
  ds_read_b128 v[68:71], v241 offset:3072
  ds_read_b128 v[72:75], v241 offset:4096
  ds_read_b128 v[76:79], v241 offset:10240
  ds_read_b128 v[80:83], v241 offset:11264
  ds_read_b128 v[84:87], v241 offset:12288
  ds_read_b128 v[88:91], v241 offset:13312
  ds_read_b128 v[92:95], v241 offset:14336
  s_waitcnt lgkmcnt(5)
  v_mfma_f32_16x16x32_bf16 v[36:39], v[56:59], v[176:179], v[36:39]
  v_mfma_f32_16x16x32_bf16 v[40:43], v[60:63], v[176:179], v[40:43]
  v_mfma_f32_16x16x32_bf16 v[44:47], v[64:67], v[176:179], v[44:47]
  v_mfma_f32_16x16x32_bf16 v[48:51], v[68:71], v[176:179], v[48:51]
  v_mfma_f32_16x16x32_bf16 v[52:55], v[72:75], v[176:179], v[52:55]
  s_waitcnt lgkmcnt(0)
  v_mfma_f32_16x16x32_bf16 v[36:39], v[76:79], v[180:183], v[36:39]
  v_mfma_f32_16x16x32_bf16 v[40:43], v[80:83], v[180:183], v[40:43]
  v_mfma_f32_16x16x32_bf16 v[44:47], v[84:87], v[180:183], v[44:47]
  v_mfma_f32_16x16x32_bf16 v[48:51], v[88:91], v[180:183], v[48:51]
  v_mfma_f32_16x16x32_bf16 v[52:55], v[92:95], v[180:183], v[52:55]
  s_mov_b32 s8, s82
  s_mov_b32 s9, s83
  s_mov_b32 s10, 2621440
  s_mov_b32 s11, 0x20000
  v_and_b32 v3, 15, v2
  v_lshrrev_b32 v4, 4, v2
  s_lshl_b32 s40, s25, 4
  v_add_u32 v9, s40, v3
  v_mul_u32_u24 v9, 336, v9
  v_lshl_add_u32 v9, v4, 4, v9
  s_mul_i32 s40, s24, 21504
  v_add_u32 v9, s40, v9
  s_mov_b32 s40, 429496730
  s_lshl_b32 s41, s60, 6
  s_mul_i32 s41, s41, 1280
  s_mul_i32 s42, s61, 160
  s_add_u32 s41, s41, s42
  v_add_u32 v11, 0, v0
  v_mul_hi_u32 v12, v11, s40
  v_mul_u32_u24 v13, 10, v12
  v_sub_u32 v13, v11, v13
  v_mul_u32_u24 v14, 336, v12
  v_lshl_add_u32 v14, v13, 5, v14
  v_mul_u32_u24 v12, 1280, v12
  v_lshl_add_u32 v60, v13, 4, v12
  v_add_u32 v11, 512, v0
  v_mul_hi_u32 v12, v11, s40
  v_mul_u32_u24 v13, 10, v12
  v_sub_u32 v13, v11, v13
  v_mul_u32_u24 v15, 336, v12
  v_lshl_add_u32 v15, v13, 5, v15
  v_mul_u32_u24 v12, 1280, v12
  v_lshl_add_u32 v61, v13, 4, v12
  v_sub_f32 v36, v36, v16
  v_sub_f32 v37, v37, v17
  v_sub_f32 v38, v38, v18
  v_sub_f32 v39, v39, v19
  v_sub_f32 v40, v40, v20
  v_sub_f32 v41, v41, v21
  v_sub_f32 v42, v42, v22
  v_sub_f32 v43, v43, v23
  v_sub_f32 v44, v44, v24
  v_sub_f32 v45, v45, v25
  v_sub_f32 v46, v46, v26
  v_sub_f32 v47, v47, v27
  v_sub_f32 v48, v48, v28
  v_sub_f32 v49, v49, v29
  v_sub_f32 v50, v50, v30
  v_sub_f32 v51, v51, v31
  v_sub_f32 v52, v52, v32
  v_sub_f32 v53, v53, v33
  v_sub_f32 v54, v54, v34
  v_sub_f32 v55, v55, v35
  v_fma_f32 v16, v224, v36, v16
  v_fma_f32 v17, v224, v37, v17
  v_fma_f32 v18, v224, v38, v18
  v_fma_f32 v19, v224, v39, v19
  v_fma_f32 v20, v224, v40, v20
  v_fma_f32 v21, v224, v41, v21
  v_fma_f32 v22, v224, v42, v22
  v_fma_f32 v23, v224, v43, v23
  v_fma_f32 v24, v224, v44, v24
  v_fma_f32 v25, v224, v45, v25
  v_fma_f32 v26, v224, v46, v26
  v_fma_f32 v27, v224, v47, v27
  v_fma_f32 v28, v224, v48, v28
  v_fma_f32 v29, v224, v49, v29
  v_fma_f32 v30, v224, v50, v30
  v_fma_f32 v31, v224, v51, v31
  v_fma_f32 v32, v224, v52, v32
  v_fma_f32 v33, v224, v53, v33
  v_fma_f32 v34, v224, v54, v34
  v_fma_f32 v35, v224, v55, v35
  s_barrier
  ds_write_b128 v9, v[16:19] offset:0
  ds_write_b128 v9, v[20:23] offset:64
  ds_write_b128 v9, v[24:27] offset:128
  ds_write_b128 v9, v[28:31] offset:192
  ds_write_b128 v9, v[32:35] offset:256
  s_waitcnt lgkmcnt(0)
  s_barrier
  ds_read_b128 v[64:67], v14
  ds_read_b128 v[72:75], v14 offset:21504
  ds_read_b128 v[68:71], v14 offset:16
  ds_read_b128 v[76:79], v14 offset:21520
  s_waitcnt lgkmcnt(2)
  v_add_f32 v64, v64, v72
  v_add_f32 v65, v65, v73
  v_add_f32 v66, v66, v74
  v_add_f32 v67, v67, v75
  s_waitcnt lgkmcnt(0)
  v_add_f32 v68, v68, v76
  v_add_f32 v69, v69, v77
  v_add_f32 v70, v70, v78
  v_add_f32 v71, v71, v79
  v_cvt_pk_bf16_f32 v80, v64, v65
  v_cvt_pk_bf16_f32 v81, v66, v67
  v_cvt_pk_bf16_f32 v82, v68, v69
  v_cvt_pk_bf16_f32 v83, v70, v71
  buffer_store_dwordx4 v[80:83], v60, s[8:11], s41 offen
L_g2f_73:
  s_cmp_ge_u32 s3, 2
  s_cbranch_scc1 L_g2f_74
  ds_read_b128 v[88:91], v15
  ds_read_b128 v[96:99], v15 offset:21504
  ds_read_b128 v[92:95], v15 offset:16
  ds_read_b128 v[100:103], v15 offset:21520
  s_waitcnt lgkmcnt(2)
  v_add_f32 v88, v88, v96
  v_add_f32 v89, v89, v97
  v_add_f32 v90, v90, v98
  v_add_f32 v91, v91, v99
  s_waitcnt lgkmcnt(0)
  v_add_f32 v92, v92, v100
  v_add_f32 v93, v93, v101
  v_add_f32 v94, v94, v102
  v_add_f32 v95, v95, v103
  v_cvt_pk_bf16_f32 v104, v88, v89
  v_cvt_pk_bf16_f32 v105, v90, v91
  v_cvt_pk_bf16_f32 v106, v92, v93
  v_cvt_pk_bf16_f32 v107, v94, v95
  buffer_store_dwordx4 v[104:107], v61, s[8:11], s41 offen
L_g2f_74:
L_end:
  s_endpgm
L_code_end:

.section .rodata,"a"
.p2align 6
.amdhsa_kernel gated_mix__sliding_block__mixer_channel_mlp__prompt_kernel
  .amdhsa_next_free_vgpr 256
  .amdhsa_next_free_sgpr 102
  .amdhsa_accum_offset 256
  .amdhsa_group_segment_fixed_size 0
  .amdhsa_kernarg_size 96
  .amdhsa_user_sgpr_count 2
  .amdhsa_user_sgpr_kernarg_segment_ptr 1
  .amdhsa_system_sgpr_workgroup_id_x 1
.end_amdhsa_kernel
```
